```python
import torch

def _softmax(x, axis=-1):
    return torch.softmax(x, dim=axis)
def _gelu(x):
    return torch.nn.functional.gelu(x, approximate="tanh")
def _silu(x):
    return torch.nn.functional.silu(x)
def _sigmoid(x):
    return torch.sigmoid(x)
def _layernorm(x, axis=-1, eps=1e-5):
    m = x.mean(dim=axis, keepdim=True)
    v = x.var(dim=axis, keepdim=True, unbiased=False)
    return (x - m) / torch.sqrt(v + eps)
def _scatter_add(tgt, idx, src, axis=0):
    return tgt.clone().index_add_(axis, idx, src)
def _segment_sum(src, seg, n):
    out = torch.zeros((n,) + src.shape[1:], dtype=src.dtype)
    return out.index_add_(0, seg, src)
def _pad(x, pw):
    flat = tuple(v for pair in reversed(pw) for v in pair)
    return torch.nn.functional.pad(x, flat)

kernel_name = 'sequential_preLN__ssm_conv_h3__glu_gated_geglu__prompt'

def setup_inputs():

    _w = (lambda a: (lambda t: t.to(torch.bfloat16) if t.is_floating_point() else t)(torch.as_tensor(a)))
    def _A_setup():
        B, S, D = 1, 2048, 1024
        ks = 4
        return {
            "q": _w((lambda *s: torch.randn(*s, dtype=torch.bfloat16) * 0.05)(B, S, D)),
            "k": _w((lambda *s: torch.randn(*s, dtype=torch.bfloat16) * 0.2)(B, S, D)),
            "v": _w((lambda *s: torch.randn(*s, dtype=torch.bfloat16) * 0.2)(B, S, D)),
            "shift_k": _w((lambda *s: torch.randn(*s, dtype=torch.bfloat16) * 0.2)(D, ks) * 0.5),
            "ssm_k": _w((lambda *s: torch.randn(*s, dtype=torch.bfloat16) * 0.4)(D, S) * (1.0 / S ** 0.5)),
            "ssm_D": _w((lambda *s: torch.randn(*s, dtype=torch.bfloat16) * 0.2)(D)),
        }
    _A_in = _A_setup()

    def _B_setup():
        B, S, Dm, Df = 1, 2048, 1024, 3584
        return {
            "x": _w((lambda *s: torch.randn(*s, dtype=torch.bfloat16) * 0.05)(B, S, Dm)),
            "w_gate": _w((lambda *s: torch.randn(*s, dtype=torch.bfloat16) * 0.4)(Dm, Df) * (Dm ** -0.5)),
            "w_up": _w((lambda *s: torch.randn(*s, dtype=torch.bfloat16) * 0.4)(Dm, Df) * (Dm ** -0.5)),
            "w_down": _w((lambda *s: torch.randn(*s, dtype=torch.bfloat16) * 0.4)(Df, Dm) * (Df ** -0.5)),
        }
    _B_in = _B_setup()

    return {
        "A_q": _A_in["q"],
        "A_k": _A_in["k"],
        "A_v": _A_in["v"],
        "A_shift_k": _A_in["shift_k"],
        "A_ssm_k": _A_in["ssm_k"],
        "A_ssm_D": _A_in["ssm_D"],
        "B_x": _B_in["x"],
        "B_w_gate": _B_in["w_gate"],
        "B_w_up": _B_in["w_up"],
        "B_w_down": _B_in["w_down"],
    }

def reference(A_q, A_k, A_v, A_shift_k, A_ssm_k, A_ssm_D, B_x, B_w_gate, B_w_up, B_w_down):
    def _A_ref(q, k, v, shift_k, ssm_k, ssm_D):
        B, S, D = q.shape
        ks = shift_k.shape[-1]
        k_pad = _pad(k, ((0, 0), (ks - 1, 0), (0, 0)))
        k_shift = torch.zeros_like(k)
        for t in range(ks):
            k_shift = k_shift + k_pad[:, t:t + S, :] * shift_k[:, ks - 1 - t][None, None, :]
        kv = k_shift * v
        L = 2 * S
        kv_pad = _pad(kv, ((0, 0), (0, S), (0, 0)))
        kf_pad = _pad(ssm_k, ((0, 0), (0, S)))
        kv_f = (lambda x, axes=(-2,-1): torch.fft.rfft2(x.float(), dim=axes))(kv_pad[:, None, :, :], axes=(1, 2))
        kf_f = (lambda x, axes=(-2,-1): torch.fft.rfft2(x.float(), dim=axes))(kf_pad[:, None, :], axes=(1, 2))
        kf_f = (lambda x, *d: x.permute(*d))(kf_f, 1, 2, 0)
        y_f = kv_f * kf_f[None, :, :, :]
        y = (lambda x, s, axes=(-2,-1): torch.fft.irfft2(x, s=s, dim=axes).to(torch.bfloat16))(y_f, (1, L), axes=(1, 2))[:, 0, :S, :]
        y = y + kv * ssm_D[None, None, :]
        return q * y

    def _B_ref(x, w_gate, w_up, w_down):
        g = torch.einsum("bsd,df->bsf", x, w_gate)
        u = torch.einsum("bsd,df->bsf", x, w_up)
        h = _gelu(g) * u
        return torch.einsum("bsf,fd->bsd", h, w_down)

    x = A_q
    h = x + _A_ref(_layernorm(x, axis=-1), A_k, A_v, A_shift_k, A_ssm_k, A_ssm_D)
    h2 = h + _B_ref(_layernorm(h, axis=-1), B_w_gate, B_w_up, B_w_down)
    return h2
```

```asm
; @launch grid=(256,1,1) block=(256,1,1) lds=163840
.amdgcn_target "amdgcn-amd-amdhsa--gfx950"
.text
.globl sequential_preLN__ssm_conv_h3__glu_gated_geglu__prompt_kernel
.p2align 8
.type sequential_preLN__ssm_conv_h3__glu_gated_geglu__prompt_kernel,@function
sequential_preLN__ssm_conv_h3__glu_gated_geglu__prompt_kernel:
    s_cmp_ge_u32 s2, 256
    s_cbranch_scc1 L_end
    s_load_dwordx16 s[8:23], s[0:1], 0
    s_load_dwordx8 s[24:31], s[0:1], 64
    s_load_dwordx2 s[32:33], s[0:1], 96
    s_getpc_b64 s[6:7]
L_pc:
    v_lshrrev_b32 v2, 6, v0
    v_and_b32 v1, 63, v0
    v_readfirstlane_b32 s5, v2
    s_and_b32 s3, s2, 7
    s_lshr_b32 s4, s2, 3
    s_cmp_lg_u32 s5, 3
    s_cbranch_scc1 L_cta
    s_add_u32 s40, s6, L_pc-L_pc
    s_addc_u32 s41, s7, 0
    s_mov_b32 s42, L_code_end-L_pc
    s_mov_b32 s43, 0x20000
    s_lshl_b32 s100, s4, 7
    v_lshlrev_b32 v30, 12, v1
    buffer_load_dword v30, v30, s[40:43], s100 offen
L_cta:
    s_lshl_b32 s64, s4, 6
    s_lshl_b32 s65, s5, 4
    s_add_u32 s64, s64, s65
    v_lshrrev_b32 v12, 4, v1
    v_add_u32 v13, s64, v12
    v_lshlrev_b32 v13, 11, v13
    v_and_b32 v14, 15, v1
    s_lshl_b32 s65, s5, 2
    v_xor_b32 v15, s65, v14
    v_lshl_add_u32 v13, v15, 4, v13
    s_lshl_b32 s66, s3, 8
    v_add_u32 v13, s66, v13
    v_xor_b32 v15, 32, v13
    v_xor_b32 v14, 14, v14
    v_lshlrev_b32 v12, 11, v12
    v_lshl_add_u32 v14, v14, 4, v12
    s_lshl_b32 s67, s4, 17
    s_add_u32 s67, s67, s66
    s_sub_u32 s67, s67, 8192
    s_cmp_eq_u32 s4, 0
    s_cselect_b32 s67, 0x40000000, s67
    s_lshl_b32 s68, s5, 12
    s_mov_b32 s74, 8192
    s_mov_b32 s75, 16384
    s_mov_b32 s76, 24576
    v_lshrrev_b32 v16, 3, v0
    s_lshl_b32 s65, s3, 5
    v_add_u32 v17, s65, v16
    v_lshlrev_b32 v12, 5, v17
    s_mov_b32 s50, 0x400000
    s_mov_b32 s51, 0x20000
    s_mov_b32 s62, 0x400000
    s_mov_b32 s63, 0x20000
    s_waitcnt lgkmcnt(0)
    s_mov_b32 s48, s10
    s_mov_b32 s49, s11
    s_mov_b32 s60, s12
    s_mov_b32 s61, s13
    s_add_u32 m0, s68, 104192
    s_nop 0
    buffer_load_dwordx4 v13, s[48:51], 0 offen nt lds
    s_add_u32 m0, s68, 105216
    s_nop 0
    buffer_load_dwordx4 v13, s[48:51], s74 offen nt lds
    s_add_u32 m0, s68, 106240
    s_nop 0
    buffer_load_dwordx4 v15, s[48:51], s75 offen nt lds
    s_add_u32 m0, s68, 107264
    s_nop 0
    buffer_load_dwordx4 v15, s[48:51], s76 offen nt lds
    s_add_u32 m0, s68, 120576
    s_nop 0
    buffer_load_dwordx4 v13, s[60:63], 0 offen nt lds
    s_add_u32 m0, s68, 121600
    s_nop 0
    buffer_load_dwordx4 v13, s[60:63], s74 offen nt lds
    s_add_u32 m0, s68, 122624
    s_nop 0
    buffer_load_dwordx4 v15, s[60:63], s75 offen nt lds
    s_add_u32 m0, s68, 123648
    s_nop 0
    buffer_load_dwordx4 v15, s[60:63], s76 offen nt lds
    s_cmp_lg_u32 s5, 0
    s_cbranch_scc1 L_pre_nohalo
    s_mov_b32 m0, 103168
    s_nop 0
    buffer_load_dwordx4 v14, s[48:51], s67 offen nt lds
L_pre_nohalo:
    s_mov_b32 s36, s14
    s_mov_b32 s37, s15
    s_mov_b32 s38, 0x2000
    s_mov_b32 s39, 0x20000
    buffer_load_dwordx4 v[32:35], v12, s[36:39], 0 offen
    buffer_load_dwordx4 v[36:39], v12, s[36:39], 0 offen offset:16
    s_mov_b32 s44, s32
    s_mov_b32 s45, s33
    s_mov_b32 s46, 0x3a00000
    s_mov_b32 s47, 0x20000
    s_mov_b32 s64, 0x1700000
    buffer_load_dword v28, off, s[44:47], s64 sc0 sc1
    s_mov_b32 s52, s16
    s_mov_b32 s53, s17
    s_mov_b32 s54, 0x400000
    s_mov_b32 s55, 0x20000
    s_lshl_b32 s70, s3, 5
    s_add_u32 s70, s70, s4
    s_lshl_b32 s64, s70, 3
    s_load_dwordx2 s[30:31], s[18:19], s64
    s_lshl_b32 s71, s70, 2
    s_add_u32 s71, s71, s5
    s_lshl_b32 s64, s71, 12
    v_lshlrev_b32 v12, 4, v1
    buffer_load_dwordx4 v[42:45], v12, s[52:55], s64 offen offset:0 nt
    buffer_load_dwordx4 v[48:51], v12, s[52:55], s64 offen offset:1024 nt
    buffer_load_dwordx4 v[54:57], v12, s[52:55], s64 offen offset:2048 nt
    buffer_load_dwordx4 v[60:63], v12, s[52:55], s64 offen offset:3072 nt
    s_and_b32 s35, s4, 7
    s_lshl_b32 s35, s35, 3
    s_add_u32 s35, s35, s3
    s_lshl_b32 s35, s35, 2
    s_lshr_b32 s64, s4, 3
    s_add_u32 s35, s35, s64
    s_mov_b32 s56, s8
    s_mov_b32 s57, s9
    s_mov_b32 s58, 0x400000
    s_mov_b32 s59, 0x20000
    v_and_b32 v18, 7, v0
    v_lshlrev_b32 v12, 11, v18
    v_lshl_add_u32 v12, v16, 4, v12
    s_lshl_b32 s64, s35, 14
    v_add_u32 v248, s64, v12
    v_lshrrev_b32 v12, 1, v16
    v_lshlrev_b32 v13, 1, v18
    v_xor_b32 v19, v12, v13
    v_add_u32 v13, 14, v13
    v_and_b32 v13, 14, v13
    v_xor_b32 v20, v12, v13
    v_and_b32 v12, 1, v16
    v_lshlrev_b32 v12, 3, v12
    v_lshl_add_u32 v12, v18, 11, v12
    v_add_u32 v12, 103168, v12
    v_lshl_add_u32 v19, v19, 4, v12
    v_lshl_add_u32 v20, v20, 4, v12
    v_mul_u32_u24 v21, 20480, v17
    v_lshlrev_b32 v12, 4, v18
    v_sub_u32 v21, v21, v12
    s_sub_u32 s65, 31, s4
    s_lshr_b32 s66, s65, 3
    s_cmp_eq_u32 s66, 3
    s_cselect_b32 s66, 4, s66
    s_add_u32 s66, s66, 32
    s_and_b32 s64, s65, 7
    s_cmp_eq_u32 s64, 3
    s_cselect_b32 s64, s66, s65
    s_lshl_b32 s64, s64, 7
    s_add_u32 s64, s64, 0x2e00070
    v_add_u32 v21, s64, v21
    s_mul_i32 s69, s5, 25792
    v_lshlrev_b32 v12, 4, v1
    v_add_u32 v244, s69, v12
    v_mov_b32 v2, 0
    v_mov_b32 v3, 0
    v_bfe_u32 v12, v1, 3, 2
    v_mul_u32_u24 v12, 4160, v12
    v_and_b32 v13, 7, v1
    v_min_u32 v13, 5, v13
    v_lshl_add_u32 v12, v13, 3, v12
    v_add_u32 v12, s69, v12
    ds_write_b64 v12, v[2:3]
    v_min_u32 v13, 56, v1
    v_lshlrev_b32 v13, 3, v13
    v_add_u32 v13, s69, v13
    ds_write_b64 v13, v[2:3] offset:20728
    ds_write_b64 v13, v[2:3] offset:25312
    v_and_b32 v12, 3, v1
    v_mul_u32_u24 v12, 4160, v12
    v_bfe_u32 v13, v1, 2, 2
    v_lshrrev_b32 v14, 4, v1
    v_add_u32 v13, v13, v14
    v_lshl_add_u32 v12, v13, 4, v12
    v_add_u32 v240, s69, v12
    v_and_b32 v12, 1, v1
    v_bfe_u32 v13, v1, 1, 3
    v_mul_u32_u24 v15, 4576, v12
    v_lshlrev_b32 v13, 2, v13
    v_sub_u32 v16, v14, v13
    v_add_u32 v16, 28, v16
    v_lshl_add_u32 v15, v16, 4, v15
    v_add_u32 v241, s69, v15
    v_add_u32 v13, v13, v14
    v_lshlrev_b32 v16, 4, v13
    v_lshl_add_u32 v16, v12, 3, v16
    s_lshl_b32 s64, s5, 12
    s_add_u32 s64, s64, 103168
    v_add_u32 v242, s64, v16
    v_sub_u32 v16, 504, v16
    v_add_u32 v243, s69, v16
    v_lshlrev_b32 v12, 4, v1
    v_and_b32 v13, 0x70, v12
    v_and_b32 v8, 56, v1
    v_cmp_eq_u32 vcc, 24, v8
    v_add_u32 v8, 0, v12
    v_add_u32 v9, 1024, v12
    v_add_u32 v10, 2048, v12
    v_add_u32 v11, 3072, v12
    v_add_u32 v12, 4096, v13
    v_cndmask_b32 v8, v8, v12, vcc
    v_add_u32 v12, 4224, v13
    v_cndmask_b32 v9, v9, v12, vcc
    v_add_u32 v12, 4352, v13
    v_cndmask_b32 v10, v10, v12, vcc
    v_add_u32 v12, 4608, v13
    v_cndmask_b32 v11, v11, v12, vcc
    s_mul_i32 s83, s71, 5120
    s_add_u32 s83, s83, 0x2e00000
    s_and_b32 s64, s5, 1
    s_cmp_eq_u32 s64, 0
    s_cselect_b32 s40, s22, s24
    s_cselect_b32 s41, s23, s25
    s_mov_b32 s42, 0x700000
    s_mov_b32 s43, 0x20000
    v_lshrrev_b32 v3, 3, v1
    v_mul_u32_u24 v3, 7168, v3
    v_and_b32 v12, 7, v1
    v_min_u32 v12, 6, v12
    v_lshl_add_u32 v3, v12, 7, v3
    s_lshl_b32 s64, s4, 1
    s_lshr_b32 s65, s5, 1
    s_add_u32 s64, s64, s65
    s_mul_i32 s88, s64, 57344
    s_mul_i32 s65, s3, 896
    s_add_u32 s88, s88, s65
    v_lshrrev_b32 v12, 4, v0
    s_mul_i32 s64, s2, 14
    v_add_u32 v13, s64, v12
    v_and_b32 v15, 15, v0
    v_lshlrev_b32 v16, 11, v13
    v_lshl_add_u32 v16, v15, 4, v16
    v_lshlrev_b32 v17, 10, v13
    v_lshl_add_u32 v17, v15, 4, v17
    v_add_u32 v17, 0x1000000, v17
    v_mov_b32 v15, 0x7fff0000
    v_cmp_le_u32 vcc, 14, v12
    s_nop 1
    v_cndmask_b32 v246, v16, v15, vcc
    v_cndmask_b32 v247, v17, v15, vcc
    s_lshl_b32 s64, s5, 9
    s_add_u32 s64, s64, 103168
    v_lshlrev_b32 v12, 2, v1
    v_add_u32 v245, s64, v12
    v_lshrrev_b32 v12, 2, v1
    v_mul_u32_u24 v12, 20480, v12
    v_and_b32 v13, 3, v1
    v_lshl_add_u32 v12, v13, 4, v12
    s_bfe_u32 s65, s70, 0x50001
    s_lshr_b32 s66, s65, 3
    s_cmp_eq_u32 s66, 3
    s_cselect_b32 s66, 4, s66
    s_add_u32 s66, s66, 32
    s_and_b32 s64, s65, 7
    s_cmp_eq_u32 s64, 3
    s_cselect_b32 s64, s66, s65
    s_lshl_b32 s64, s64, 7
    s_lshr_b32 s65, s70, 6
    s_mul_i32 s65, s65, 5120
    s_add_u32 s64, s64, s65
    s_and_b32 s65, s70, 1
    s_lshl_b32 s65, s65, 6
    s_add_u32 s64, s64, s65
    s_mul_i32 s65, s5, 655360
    s_add_u32 s64, s64, s65
    v_add_u32 v4, s64, v12
    s_mov_b32 s20, 0x05040100
    s_mov_b32 s21, 0x07060302
    s_waitcnt lgkmcnt(0)
    s_cmp_ge_u32 s5, 2
    s_cselect_b32 s84, s31, s30
    s_and_b32 s85, s5, 1
    s_xor_b32 s85, s85, 1
    s_lshl_b32 s85, s85, 4
    s_lshl_b32 s84, s84, s85
    s_and_b32 s84, s84, 0xffff0000
    s_mov_b32 s85, s84
    v_and_b32 v12, 7, v0
    v_lshrrev_b32 v13, 3, v0
    s_cmp_eq_u32 s5, 3
    s_cselect_b32 s64, 4, s5
    s_add_u32 s64, s64, 32
    v_mov_b32 v15, s64
    v_and_b32 v14, 7, v13
    v_cmp_eq_u32 vcc, 3, v14
    s_nop 1
    v_cndmask_b32 v14, v13, v15, vcc
    v_lshlrev_b32 v14, 7, v14
    v_lshl_add_u32 v14, v12, 3, v14
    s_mul_i32 s64, s35, 20480
    v_add_u32 v250, s64, v14
    s_bfe_u32 s68, s35, 0x20001
    s_and_b32 s93, s35, 1
    s_lshl_b32 s64, s68, 10
    s_lshl_b32 s94, s93, 7
    s_add_u32 s64, s64, s94
    s_cmp_eq_u32 s68, 3
    s_cselect_b32 s68, 4, s68
    s_lshl_b32 s68, s68, 7
    s_add_u32 s68, s68, 4096
    s_add_u32 s94, s64, 256
    s_cmp_eq_u32 s93, 1
    s_cselect_b32 s68, s68, s94
    v_and_b32 v14, 3, v13
    v_lshlrev_b32 v15, 8, v14
    v_add_u32 v15, s64, v15
    v_cmp_eq_u32 vcc, 1, v14
    v_mov_b32 v14, s68
    s_nop 0
    v_cndmask_b32 v15, v15, v14, vcc
    v_lshl_add_u32 v15, v12, 4, v15
    v_lshrrev_b32 v14, 2, v13
    v_mul_u32_u24 v14, 5120, v14
    v_add_u32 v15, v15, v14
    s_lshr_b32 s64, s35, 3
    s_mul_i32 s64, s64, 163840
    v_add_u32 v249, s64, v15
    s_lshr_b32 s71, s4, 3
    s_lshl_b32 s64, s3, 2
    s_add_u32 s71, s71, s64
    s_and_b32 s72, s4, 7
    v_mul_u32_u24 v26, 4682, v1
    v_lshrrev_b32 v26, 16, v26
    v_mul_u32_u24 v27, 14, v26
    v_sub_u32 v27, v1, v27
    s_lshl_b32 s64, s5, 3
    v_add_u32 v26, s64, v26
    v_mul_u32_u24 v26, 7168, v26
    v_lshl_add_u32 v26, v27, 4, v26
    s_mul_i32 s64, s71, 224
    v_add_u32 v26, s64, v26
    v_mov_b32 v27, 0x7fff0000
    v_cmp_le_u32 vcc, 56, v1
    s_nop 1
    v_cndmask_b32 v26, v26, v27, vcc
    v_add_u32 v27, 28672, v26
    s_mul_i32 s86, s5, 2176
    s_mov_b32 s87, 0
    s_mov_b32 s52, s22
    s_mov_b32 s53, s23
    s_mov_b32 s54, 0x700000
    s_mov_b32 s55, 0x20000
    s_mov_b32 s56, s24
    s_mov_b32 s57, s25
    s_mov_b32 s58, 0x700000
    s_mov_b32 s59, 0x20000
    s_lshl_b32 s73, s72, 2
    s_add_u32 s73, s73, s5
    s_mul_i32 s69, s73, 163840
    s_add_u32 s69, s69, 0xa00000
    v_lshrrev_b32 v5, 4, v1
    v_mul_u32_u24 v5, 2176, v5
    v_bfe_u32 v6, v1, 2, 2
    v_mul_u32_u24 v6, 224, v6
    v_add_u32 v5, v5, v6
    v_and_b32 v6, 3, v1
    v_lshl_add_u32 v5, v6, 3, v5
    s_and_b32 s78, s71, 1
    s_xor_b32 s79, s78, 1
    s_mul_i32 s79, s79, 192
    v_add_u32 v6, s79, v5
    s_lshl_b32 s79, s78, 5
    v_add_u32 v5, s79, v5
    s_mul_i32 s77, s73, 573440
    s_add_u32 s77, s77, 0x1800000
    s_mul_i32 s75, s71, 5120
    s_add_u32 s75, s75, s77
    s_and_b32 s76, s71, 28
    s_min_u32 s76, s76, 16
    s_mul_i32 s76, s76, 5120
    s_add_u32 s76, s76, s75
    s_add_u32 s74, s75, 409600
    s_add_u32 s75, s75, 245760
    s_lshr_b32 s79, s71, 1
    s_and_b32 s78, s79, 12
    s_add_u32 s79, s79, s78
    s_add_u32 s79, s79, 4
    s_mul_i32 s79, s79, 5120
    s_add_u32 s77, s77, s79
    s_add_u32 s78, s88, 3670016
    s_lshl_b32 s80, s4, 2
    s_add_u32 s80, s80, s5
    s_mul_i32 s80, s80, 57344
    s_mul_i32 s79, s3, 896
    s_add_u32 s80, s80, s79
    s_lshr_b32 s79, s4, 2
    s_lshl_b32 s79, s79, 1
    s_xor_b32 s82, s79, 8
    s_add_u32 s82, s82, 3
    s_lshr_b32 s91, s4, 2
    s_and_b32 s94, s91, 3
    s_cmp_eq_u32 s94, 1
    s_cselect_b32 s93, 10, 11
    s_lshl_b32 s92, s91, 8
    s_lshr_b32 s94, s91, 2
    s_lshl_b32 s94, s94, 9
    s_cmp_eq_u32 s93, 10
    s_cselect_b32 s94, s94, s92
    v_lshrrev_b32 v14, 4, v1
    v_lshlrev_b32 v15, 1, v14
    v_and_b32 v16, 15, v1
    v_xor_b32 v15, v15, v16
    v_lshlrev_b32 v15, 4, v15
    v_xor_b32 v16, 128, v15
    v_add_u32 v15, s94, v15
    v_add_u32 v16, s94, v16
    v_add_u32 v22, 0, v14
    v_lshlrev_b32 v22, s93, v22
    v_add_u32 v22, v22, v15
    v_add_u32 v23, 4, v14
    v_lshlrev_b32 v23, s93, v23
    v_add_u32 v23, v23, v16
    v_add_u32 v24, 8, v14
    v_lshlrev_b32 v24, s93, v24
    v_add_u32 v24, v24, v15
    v_add_u32 v25, 12, v14
    v_lshlrev_b32 v25, s93, v25
    v_add_u32 v25, v25, v16
    s_and_b32 s92, s3, 1
    s_lshl_b32 s92, s92, 1
    s_lshr_b32 s94, s5, 1
    s_add_u32 s90, s92, s94
    v_lshlrev_b32 v14, 2, v1
    v_add_u32 v14, s90, v14
    v_subrev_u32 v15, 16, v14
    v_lshrrev_b32 v13, 1, v1
    v_lshlrev_b32 v13, 2, v13
    v_add_u32 v13, s90, v13
    v_cmp_gt_u32 vcc, 8, v1
    s_nop 1
    v_cndmask_b32 v15, v15, v13, vcc
    v_bfe_u32 v16, v15, 1, 4
    v_mul_u32_u24 v16, 7, v16
    v_and_b32 v17, 1, v15
    v_lshl_add_u32 v16, v17, 2, v16
    v_lshrrev_b32 v15, 5, v15
    v_sub_u32 v16, v16, v15
    v_add_u32 v16, 2, v16
    v_and_b32 v14, 57, v1
    v_cmp_eq_u32 vcc, 1, v14
    v_mul_u32_u24 v13, 7, v13
    v_add_u32 v13, 3, v13
    v_cndmask_b32 v2, v16, v13, vcc
    s_and_b32 s94, s5, 1
    v_lshlrev_b32 v2, 1, v2
    v_add_u32 v2, s94, v2
    s_add_u32 s92, s93, 4
    v_lshlrev_b32 v2, s92, v2
    s_lshl_b32 s89, s5, 12
    s_add_u32 s94, s32, 0x1000000
    s_addc_u32 s95, s33, 0
    s_cmp_eq_u32 s93, 10
    s_cselect_b32 s36, s94, s26
    s_cselect_b32 s37, s95, s27
    s_mov_b32 s94, 0x700000
    s_cselect_b32 s38, 0x380000, s94
    s_mov_b32 s39, 0x20000
    s_lshr_b32 s92, s3, 1
    s_lshl_b32 s92, s92, 2
    s_and_b32 s94, s4, 3
    s_add_u32 s92, s92, s94
    s_and_b32 s93, s5, 1
    s_lshl_b32 s94, s92, 1
    s_add_u32 s94, s94, s93
    s_mul_i32 s30, s94, 112
    s_add_u32 s30, s30, s90
    s_mul_i32 s30, s30, 5120
    s_add_u32 s30, s30, 0x1800000
    s_and_b32 s31, s92, 1
    s_lshl_b32 s31, s31, 3
    s_add_u32 s31, s31, s91
    s_lshl_b32 s31, s31, 1
    s_and_b32 s94, s3, 1
    s_add_u32 s31, s31, s94
    s_waitcnt vmcnt(5)
    s_barrier
    ds_read_b64 v[64:65], v20 offset:256
    ds_read_b64 v[66:67], v20 offset:512
    ds_read_b64 v[68:69], v20 offset:768
    ds_read_b64 v[70:71], v19 offset:1024
    ds_read_b64 v[72:73], v19 offset:1280
    ds_read_b64 v[74:75], v19 offset:1536
    ds_read_b64 v[76:77], v19 offset:1792
    ds_read_b64 v[78:79], v19 offset:2048
    ds_read_b64 v[80:81], v19 offset:2304
    ds_read_b64 v[82:83], v19 offset:2560
    ds_read_b64 v[84:85], v19 offset:2816
    ds_read_b64 v[86:87], v19 offset:17408
    ds_read_b64 v[88:89], v19 offset:17664
    ds_read_b64 v[90:91], v19 offset:17920
    v_lshlrev_b32 v102, 16, v32
    v_and_b32 v106, 0xffff0000, v32
    v_lshlrev_b32 v110, 16, v33
    v_and_b32 v114, 0xffff0000, v33
    v_lshlrev_b32 v103, 16, v34
    v_and_b32 v107, 0xffff0000, v34
    v_lshlrev_b32 v111, 16, v35
    v_and_b32 v115, 0xffff0000, v35
    v_lshlrev_b32 v104, 16, v36
    v_and_b32 v108, 0xffff0000, v36
    v_lshlrev_b32 v112, 16, v37
    v_and_b32 v116, 0xffff0000, v37
    v_lshlrev_b32 v105, 16, v38
    v_and_b32 v109, 0xffff0000, v38
    v_lshlrev_b32 v113, 16, v39
    v_and_b32 v117, 0xffff0000, v39
    s_waitcnt lgkmcnt(3)
    ds_read_b64 v[92:93], v19 offset:18176
    ds_read_b64 v[94:95], v19 offset:18432
    ds_read_b64 v[96:97], v19 offset:18688
    ds_read_b64 v[98:99], v19 offset:18944
    ds_read_b64 v[100:101], v19 offset:19200
    v_lshlrev_b32 v118, 16, v64
    v_and_b32 v119, 0xffff0000, v64
    v_lshlrev_b32 v122, 16, v66
    v_and_b32 v123, 0xffff0000, v66
    v_lshlrev_b32 v126, 16, v68
    v_and_b32 v127, 0xffff0000, v68
    v_lshlrev_b32 v130, 16, v70
    v_and_b32 v131, 0xffff0000, v70
    v_lshlrev_b32 v134, 16, v72
    v_and_b32 v135, 0xffff0000, v72
    v_lshlrev_b32 v138, 16, v74
    v_and_b32 v139, 0xffff0000, v74
    v_lshlrev_b32 v142, 16, v76
    v_and_b32 v143, 0xffff0000, v76
    v_lshlrev_b32 v146, 16, v78
    v_and_b32 v147, 0xffff0000, v78
    v_lshlrev_b32 v150, 16, v80
    v_and_b32 v151, 0xffff0000, v80
    v_lshlrev_b32 v154, 16, v82
    v_and_b32 v155, 0xffff0000, v82
    v_lshlrev_b32 v158, 16, v84
    v_and_b32 v159, 0xffff0000, v84
    s_waitcnt lgkmcnt(0)
    v_lshlrev_b32 v162, 16, v86
    v_and_b32 v163, 0xffff0000, v86
    v_lshlrev_b32 v166, 16, v88
    v_and_b32 v167, 0xffff0000, v88
    v_lshlrev_b32 v170, 16, v90
    v_and_b32 v171, 0xffff0000, v90
    v_lshlrev_b32 v174, 16, v92
    v_and_b32 v175, 0xffff0000, v92
    v_pk_mul_f32 v[194:195], v[118:119], v[114:115]
    v_pk_mul_f32 v[196:197], v[122:123], v[114:115]
    v_pk_mul_f32 v[198:199], v[126:127], v[114:115]
    v_pk_mul_f32 v[200:201], v[130:131], v[114:115]
    v_pk_fma_f32 v[194:195], v[122:123], v[110:111], v[194:195]
    v_pk_fma_f32 v[196:197], v[126:127], v[110:111], v[196:197]
    v_pk_fma_f32 v[198:199], v[130:131], v[110:111], v[198:199]
    v_pk_fma_f32 v[200:201], v[134:135], v[110:111], v[200:201]
    v_pk_fma_f32 v[194:195], v[126:127], v[106:107], v[194:195]
    v_pk_fma_f32 v[196:197], v[130:131], v[106:107], v[196:197]
    v_pk_fma_f32 v[198:199], v[134:135], v[106:107], v[198:199]
    v_pk_fma_f32 v[200:201], v[138:139], v[106:107], v[200:201]
    v_pk_fma_f32 v[194:195], v[130:131], v[102:103], v[194:195]
    v_pk_fma_f32 v[196:197], v[134:135], v[102:103], v[196:197]
    v_pk_fma_f32 v[198:199], v[138:139], v[102:103], v[198:199]
    v_pk_fma_f32 v[200:201], v[142:143], v[102:103], v[200:201]
    v_pk_mul_f32 v[162:163], v[194:195], v[162:163]
    v_pk_mul_f32 v[166:167], v[196:197], v[166:167]
    v_pk_mul_f32 v[170:171], v[198:199], v[170:171]
    v_pk_mul_f32 v[174:175], v[200:201], v[174:175]
    v_lshlrev_b32 v178, 16, v94
    v_and_b32 v179, 0xffff0000, v94
    v_lshlrev_b32 v182, 16, v96
    v_and_b32 v183, 0xffff0000, v96
    v_lshlrev_b32 v186, 16, v98
    v_and_b32 v187, 0xffff0000, v98
    v_lshlrev_b32 v190, 16, v100
    v_and_b32 v191, 0xffff0000, v100
    v_pk_mul_f32 v[194:195], v[134:135], v[114:115]
    v_pk_mul_f32 v[196:197], v[138:139], v[114:115]
    v_pk_mul_f32 v[198:199], v[142:143], v[114:115]
    v_pk_mul_f32 v[200:201], v[146:147], v[114:115]
    v_pk_fma_f32 v[194:195], v[138:139], v[110:111], v[194:195]
    v_pk_fma_f32 v[196:197], v[142:143], v[110:111], v[196:197]
    v_pk_fma_f32 v[198:199], v[146:147], v[110:111], v[198:199]
    v_pk_fma_f32 v[200:201], v[150:151], v[110:111], v[200:201]
    v_pk_fma_f32 v[194:195], v[142:143], v[106:107], v[194:195]
    v_pk_fma_f32 v[196:197], v[146:147], v[106:107], v[196:197]
    v_pk_fma_f32 v[198:199], v[150:151], v[106:107], v[198:199]
    v_pk_fma_f32 v[200:201], v[154:155], v[106:107], v[200:201]
    v_pk_fma_f32 v[194:195], v[146:147], v[102:103], v[194:195]
    v_pk_fma_f32 v[196:197], v[150:151], v[102:103], v[196:197]
    v_pk_fma_f32 v[198:199], v[154:155], v[102:103], v[198:199]
    v_pk_fma_f32 v[200:201], v[158:159], v[102:103], v[200:201]
    v_pk_mul_f32 v[178:179], v[194:195], v[178:179]
    v_pk_mul_f32 v[182:183], v[196:197], v[182:183]
    v_pk_mul_f32 v[186:187], v[198:199], v[186:187]
    v_pk_mul_f32 v[190:191], v[200:201], v[190:191]
    v_cvt_pk_bf16_f32 v204, v190, v186
    v_cvt_pk_bf16_f32 v205, v182, v178
    v_cvt_pk_bf16_f32 v206, v174, v170
    v_cvt_pk_bf16_f32 v207, v166, v162
    s_mov_b32 s64, 0
    buffer_store_dwordx4 v[204:207], v21, s[44:47], s64 offen sc1
    v_cvt_pk_bf16_f32 v208, v191, v187
    v_cvt_pk_bf16_f32 v209, v183, v179
    v_cvt_pk_bf16_f32 v210, v175, v171
    v_cvt_pk_bf16_f32 v211, v167, v163
    s_mov_b32 s64, 5120
    buffer_store_dwordx4 v[208:211], v21, s[44:47], s64 offen sc1
    v_lshlrev_b32 v120, 16, v65
    v_and_b32 v121, 0xffff0000, v65
    v_lshlrev_b32 v124, 16, v67
    v_and_b32 v125, 0xffff0000, v67
    v_lshlrev_b32 v128, 16, v69
    v_and_b32 v129, 0xffff0000, v69
    v_lshlrev_b32 v132, 16, v71
    v_and_b32 v133, 0xffff0000, v71
    v_lshlrev_b32 v136, 16, v73
    v_and_b32 v137, 0xffff0000, v73
    v_lshlrev_b32 v140, 16, v75
    v_and_b32 v141, 0xffff0000, v75
    v_lshlrev_b32 v144, 16, v77
    v_and_b32 v145, 0xffff0000, v77
    v_lshlrev_b32 v148, 16, v79
    v_and_b32 v149, 0xffff0000, v79
    v_lshlrev_b32 v152, 16, v81
    v_and_b32 v153, 0xffff0000, v81
    v_lshlrev_b32 v156, 16, v83
    v_and_b32 v157, 0xffff0000, v83
    v_lshlrev_b32 v160, 16, v85
    v_and_b32 v161, 0xffff0000, v85
    v_lshlrev_b32 v164, 16, v87
    v_and_b32 v165, 0xffff0000, v87
    v_lshlrev_b32 v168, 16, v89
    v_and_b32 v169, 0xffff0000, v89
    v_lshlrev_b32 v172, 16, v91
    v_and_b32 v173, 0xffff0000, v91
    v_lshlrev_b32 v176, 16, v93
    v_and_b32 v177, 0xffff0000, v93
    v_pk_mul_f32 v[194:195], v[120:121], v[116:117]
    v_pk_mul_f32 v[196:197], v[124:125], v[116:117]
    v_pk_mul_f32 v[198:199], v[128:129], v[116:117]
    v_pk_mul_f32 v[200:201], v[132:133], v[116:117]
    v_pk_fma_f32 v[194:195], v[124:125], v[112:113], v[194:195]
    v_pk_fma_f32 v[196:197], v[128:129], v[112:113], v[196:197]
    v_pk_fma_f32 v[198:199], v[132:133], v[112:113], v[198:199]
    v_pk_fma_f32 v[200:201], v[136:137], v[112:113], v[200:201]
    v_pk_fma_f32 v[194:195], v[128:129], v[108:109], v[194:195]
    v_pk_fma_f32 v[196:197], v[132:133], v[108:109], v[196:197]
    v_pk_fma_f32 v[198:199], v[136:137], v[108:109], v[198:199]
    v_pk_fma_f32 v[200:201], v[140:141], v[108:109], v[200:201]
    v_pk_fma_f32 v[194:195], v[132:133], v[104:105], v[194:195]
    v_pk_fma_f32 v[196:197], v[136:137], v[104:105], v[196:197]
    v_pk_fma_f32 v[198:199], v[140:141], v[104:105], v[198:199]
    v_pk_fma_f32 v[200:201], v[144:145], v[104:105], v[200:201]
    v_pk_mul_f32 v[164:165], v[194:195], v[164:165]
    v_pk_mul_f32 v[168:169], v[196:197], v[168:169]
    v_pk_mul_f32 v[172:173], v[198:199], v[172:173]
    v_pk_mul_f32 v[176:177], v[200:201], v[176:177]
    v_lshlrev_b32 v180, 16, v95
    v_and_b32 v181, 0xffff0000, v95
    v_lshlrev_b32 v184, 16, v97
    v_and_b32 v185, 0xffff0000, v97
    v_lshlrev_b32 v188, 16, v99
    v_and_b32 v189, 0xffff0000, v99
    v_lshlrev_b32 v192, 16, v101
    v_and_b32 v193, 0xffff0000, v101
    v_pk_mul_f32 v[194:195], v[136:137], v[116:117]
    v_pk_mul_f32 v[196:197], v[140:141], v[116:117]
    v_pk_mul_f32 v[198:199], v[144:145], v[116:117]
    v_pk_mul_f32 v[200:201], v[148:149], v[116:117]
    v_pk_fma_f32 v[194:195], v[140:141], v[112:113], v[194:195]
    v_pk_fma_f32 v[196:197], v[144:145], v[112:113], v[196:197]
    v_pk_fma_f32 v[198:199], v[148:149], v[112:113], v[198:199]
    v_pk_fma_f32 v[200:201], v[152:153], v[112:113], v[200:201]
    v_pk_fma_f32 v[194:195], v[144:145], v[108:109], v[194:195]
    v_pk_fma_f32 v[196:197], v[148:149], v[108:109], v[196:197]
    v_pk_fma_f32 v[198:199], v[152:153], v[108:109], v[198:199]
    v_pk_fma_f32 v[200:201], v[156:157], v[108:109], v[200:201]
    v_pk_fma_f32 v[194:195], v[148:149], v[104:105], v[194:195]
    v_pk_fma_f32 v[196:197], v[152:153], v[104:105], v[196:197]
    v_pk_fma_f32 v[198:199], v[156:157], v[104:105], v[198:199]
    v_pk_fma_f32 v[200:201], v[160:161], v[104:105], v[200:201]
    v_pk_mul_f32 v[180:181], v[194:195], v[180:181]
    v_pk_mul_f32 v[184:185], v[196:197], v[184:185]
    v_pk_mul_f32 v[188:189], v[198:199], v[188:189]
    v_pk_mul_f32 v[192:193], v[200:201], v[192:193]
    v_cvt_pk_bf16_f32 v212, v192, v188
    v_cvt_pk_bf16_f32 v213, v184, v180
    v_cvt_pk_bf16_f32 v214, v176, v172
    v_cvt_pk_bf16_f32 v215, v168, v164
    s_mov_b32 s64, 10240
    buffer_store_dwordx4 v[212:215], v21, s[44:47], s64 offen sc1
    v_cvt_pk_bf16_f32 v216, v193, v189
    v_cvt_pk_bf16_f32 v217, v185, v181
    v_cvt_pk_bf16_f32 v218, v177, v173
    v_cvt_pk_bf16_f32 v219, v169, v165
    s_mov_b32 s64, 15360
    buffer_store_dwordx4 v[216:219], v21, s[44:47], s64 offen sc1
    s_waitcnt vmcnt(4)
    v_readfirstlane_b32 s64, v28
    s_nop 0
    s_mul_i32 s34, s64, 0x9e3779b1
    s_add_u32 s34, s34, 0x7f4a7c15
    v_mov_b32 v28, s34
    ds_write_b128 v244, v[42:45] offset:12528
    v_mov_b32_dpp v40, v44 wave_shr:1 row_mask:0xf bank_mask:0xf bound_ctrl:0
    v_mov_b32_dpp v41, v45 wave_shr:1 row_mask:0xf bank_mask:0xf bound_ctrl:0
    ds_write_b128 v244, v[48:51] offset:13552
    v_mov_b32_dpp v46, v50 wave_shr:1 row_mask:0xf bank_mask:0xf bound_ctrl:0
    v_mov_b32_dpp v47, v51 wave_shr:1 row_mask:0xf bank_mask:0xf bound_ctrl:0
    v_readlane_b32 s64, v44, 63
    v_readlane_b32 s65, v45, 63
    s_nop 2
    v_writelane_b32 v46, s64, 0
    v_writelane_b32 v47, s65, 0
    ds_write_b128 v244, v[54:57] offset:14576
    v_mov_b32_dpp v52, v56 wave_shr:1 row_mask:0xf bank_mask:0xf bound_ctrl:0
    v_mov_b32_dpp v53, v57 wave_shr:1 row_mask:0xf bank_mask:0xf bound_ctrl:0
    v_readlane_b32 s64, v50, 63
    v_readlane_b32 s65, v51, 63
    s_nop 2
    v_writelane_b32 v52, s64, 0
    v_writelane_b32 v53, s65, 0
    ds_write_b128 v244, v[60:63] offset:15600
    v_mov_b32_dpp v58, v62 wave_shr:1 row_mask:0xf bank_mask:0xf bound_ctrl:0
    v_mov_b32_dpp v59, v63 wave_shr:1 row_mask:0xf bank_mask:0xf bound_ctrl:0
    v_readlane_b32 s64, v56, 63
    v_readlane_b32 s65, v57, 63
    s_nop 2
    v_writelane_b32 v58, s64, 0
    v_writelane_b32 v59, s65, 0
    s_mul_i32 s64, s4, 57344
    s_mul_i32 s68, s3, 896
    s_add_u32 s64, s64, s68
    s_add_u32 s64, s64, 0
    s_cmp_ge_u32 s5, 2
    s_cselect_b32 s64, s64, 0x40000000
    buffer_load_dword v30, v3, s[40:43], s64 offen
    s_waitcnt vmcnt(1)
    s_barrier
    s_cmp_lg_u32 s5, 1
    s_cbranch_scc1 L_sig1
    s_lshl_b32 s100, s3, 13
    s_lshl_b32 s101, s4, 2
    s_add_u32 s100, s100, s101
    s_add_u32 s100, s100, 0x1710000
    v_lshlrev_b32 v29, 8, v1
    s_mov_b32 exec_lo, 0xffffffff
    s_mov_b32 exec_hi, 0
    buffer_store_dword v28, v29, s[44:47], s100 offen sc1
    s_mov_b64 exec, -1
    v_and_b32 v29, 31, v1
    v_lshlrev_b32 v29, 2, v29
L_sig1:
    v_alignbit_b32 v112, v41, v40, 16
    v_alignbit_b32 v113, v42, v41, 16
    v_alignbit_b32 v114, v43, v42, 16
    v_alignbit_b32 v115, v44, v43, 16
    ds_write_b128 v244, v[112:115] offset:48
    v_mov_b32 v116, v41
    v_mov_b32 v117, v42
    v_mov_b32 v118, v43
    v_mov_b32 v119, v44
    ds_write_b128 v244, v[116:119] offset:4208
    v_alignbit_b32 v120, v42, v41, 16
    v_alignbit_b32 v121, v43, v42, 16
    v_alignbit_b32 v122, v44, v43, 16
    v_alignbit_b32 v123, v45, v44, 16
    ds_write_b128 v244, v[120:123] offset:8368
    v_alignbit_b32 v124, v47, v46, 16
    v_alignbit_b32 v125, v48, v47, 16
    v_alignbit_b32 v126, v49, v48, 16
    v_alignbit_b32 v127, v50, v49, 16
    ds_write_b128 v244, v[124:127] offset:1072
    v_mov_b32 v128, v47
    v_mov_b32 v129, v48
    v_mov_b32 v130, v49
    v_mov_b32 v131, v50
    ds_write_b128 v244, v[128:131] offset:5232
    v_alignbit_b32 v132, v48, v47, 16
    v_alignbit_b32 v133, v49, v48, 16
    v_alignbit_b32 v134, v50, v49, 16
    v_alignbit_b32 v135, v51, v50, 16
    ds_write_b128 v244, v[132:135] offset:9392
    v_alignbit_b32 v136, v53, v52, 16
    v_alignbit_b32 v137, v54, v53, 16
    v_alignbit_b32 v138, v55, v54, 16
    v_alignbit_b32 v139, v56, v55, 16
    ds_write_b128 v244, v[136:139] offset:2096
    v_mov_b32 v140, v53
    v_mov_b32 v141, v54
    v_mov_b32 v142, v55
    v_mov_b32 v143, v56
    ds_write_b128 v244, v[140:143] offset:6256
    v_alignbit_b32 v144, v54, v53, 16
    v_alignbit_b32 v145, v55, v54, 16
    v_alignbit_b32 v146, v56, v55, 16
    v_alignbit_b32 v147, v57, v56, 16
    ds_write_b128 v244, v[144:147] offset:10416
    v_alignbit_b32 v148, v59, v58, 16
    v_alignbit_b32 v149, v60, v59, 16
    v_alignbit_b32 v150, v61, v60, 16
    v_alignbit_b32 v151, v62, v61, 16
    ds_write_b128 v244, v[148:151] offset:3120
    v_mov_b32 v152, v59
    v_mov_b32 v153, v60
    v_mov_b32 v154, v61
    v_mov_b32 v155, v62
    ds_write_b128 v244, v[152:155] offset:7280
    v_alignbit_b32 v156, v60, v59, 16
    v_alignbit_b32 v157, v61, v60, 16
    v_alignbit_b32 v158, v62, v61, 16
    v_alignbit_b32 v159, v63, v62, 16
    ds_write_b128 v244, v[156:159] offset:11440
    s_cmp_lg_u32 s5, 0
    s_cbranch_scc1 L_got1
    v_and_b32 v29, 31, v1
    v_lshlrev_b32 v29, 2, v29
    s_lshl_b32 s100, s3, 5
    s_add_u32 s100, s100, s4
    s_lshl_b32 s100, s100, 8
    s_add_u32 s100, s100, 0x1710000
    s_mov_b32 s101, 0
L_poll1:
    buffer_load_dword v30, v29, s[44:47], s100 offen sc1
    s_waitcnt vmcnt(0)
    v_cmp_ne_u32 vcc, s34, v30
    s_nop 4
    s_cbranch_vccz L_got1
    s_add_u32 s101, s101, 1
    s_cmp_lt_u32 s101, 0x8000
    s_cbranch_scc1 L_poll1
L_got1:
    s_barrier
    buffer_load_dwordx4 v[64:67], v8, s[44:47], s83 offen sc1
    buffer_load_dwordx4 v[68:71], v9, s[44:47], s83 offen sc1
    buffer_load_dwordx4 v[72:75], v10, s[44:47], s83 offen sc1
    buffer_load_dwordx4 v[76:79], v11, s[44:47], s83 offen sc1
    s_mov_b32 s48, s26
    s_mov_b32 s49, s27
    s_mov_b32 s50, 0x700000
    s_mov_b32 s51, 0x20000
    ds_read_b128 v[32:35], v240 offset:0
    ds_read_b128 v[36:39], v240 offset:512
    ds_read_b128 v[40:43], v240 offset:1024
    ds_read_b128 v[44:47], v240 offset:1536
    ds_read_b128 v[48:51], v240 offset:2048
    ds_read_b128 v[52:55], v240 offset:2560
    ds_read_b128 v[56:59], v240 offset:3072
    ds_read_b128 v[60:63], v240 offset:3584
    s_waitcnt vmcnt(3)
    ds_write_b128 v244, v[64:67] offset:21216
    ds_write_b64 v244, v[64:65] offset:16632
    ds_write_b64 v244, v[66:67] offset:16640
    s_waitcnt vmcnt(2)
    ds_write_b128 v244, v[68:71] offset:22240
    ds_write_b64 v244, v[68:69] offset:17656
    ds_write_b64 v244, v[70:71] offset:17664
    s_waitcnt vmcnt(1)
    ds_write_b128 v244, v[72:75] offset:23264
    ds_write_b64 v244, v[72:73] offset:18680
    ds_write_b64 v244, v[74:75] offset:18688
    s_waitcnt vmcnt(0)
    ds_write_b128 v244, v[76:79] offset:24288
    ds_write_b64 v244, v[76:77] offset:19704
    ds_write_b64 v244, v[78:79] offset:19712
    ds_read_b128 v[124:127], v241 offset:16640
    ds_read_b128 v[120:123], v241 offset:17152
    ds_read_b128 v[116:119], v241 offset:17664
    ds_read_b128 v[112:115], v241 offset:18176
    ds_read_b128 v[108:111], v241 offset:18688
    ds_read_b128 v[104:107], v241 offset:19200
    ds_read_b128 v[100:103], v241 offset:19712
    ds_read_b128 v[96:99], v241 offset:20224
    s_mov_b32 s60, s8
    s_mov_b32 s61, s9
    s_mov_b32 s62, 0x400000
    s_mov_b32 s63, 0x20000
L_conv:
    s_waitcnt lgkmcnt(7)
    v_mfma_f32_16x16x32_bf16 v[188:191], v[32:35], v[124:127], 0
    s_waitcnt lgkmcnt(6)
    v_mfma_f32_16x16x32_bf16 v[184:187], v[32:35], v[120:123], 0
    s_waitcnt lgkmcnt(5)
    v_mfma_f32_16x16x32_bf16 v[180:183], v[32:35], v[116:119], 0
    s_waitcnt lgkmcnt(4)
    v_mfma_f32_16x16x32_bf16 v[176:179], v[32:35], v[112:115], 0
    s_waitcnt lgkmcnt(3)
    v_mfma_f32_16x16x32_bf16 v[172:175], v[32:35], v[108:111], 0
    s_waitcnt lgkmcnt(2)
    v_mfma_f32_16x16x32_bf16 v[168:171], v[32:35], v[104:107], 0
    s_waitcnt lgkmcnt(1)
    v_mfma_f32_16x16x32_bf16 v[164:167], v[32:35], v[100:103], 0
    s_waitcnt lgkmcnt(0)
    v_mfma_f32_16x16x32_bf16 v[160:163], v[32:35], v[96:99], 0
    v_mfma_f32_16x16x32_bf16 v[164:167], v[36:39], v[96:99], v[164:167]
    ds_read_b128 v[64:67], v240 offset:64
    v_mfma_f32_16x16x32_bf16 v[168:171], v[36:39], v[100:103], v[168:171]
    ds_read_b128 v[156:159], v241 offset:16704
    v_mfma_f32_16x16x32_bf16 v[172:175], v[36:39], v[104:107], v[172:175]
    ds_read_b128 v[152:155], v241 offset:17216
    v_mfma_f32_16x16x32_bf16 v[176:179], v[36:39], v[108:111], v[176:179]
    v_mfma_f32_16x16x32_bf16 v[180:183], v[36:39], v[112:115], v[180:183]
    ds_read_b128 v[148:151], v241 offset:17728
    v_mfma_f32_16x16x32_bf16 v[184:187], v[36:39], v[116:119], v[184:187]
    ds_read_b128 v[144:147], v241 offset:18240
    v_mfma_f32_16x16x32_bf16 v[188:191], v[36:39], v[120:123], v[188:191]
    ds_read_b128 v[140:143], v241 offset:18752
    v_mfma_f32_16x16x32_bf16 v[188:191], v[40:43], v[116:119], v[188:191]
    v_mfma_f32_16x16x32_bf16 v[184:187], v[40:43], v[112:115], v[184:187]
    ds_read_b128 v[136:139], v241 offset:19264
    v_mfma_f32_16x16x32_bf16 v[180:183], v[40:43], v[108:111], v[180:183]
    ds_read_b128 v[132:135], v241 offset:19776
    v_mfma_f32_16x16x32_bf16 v[176:179], v[40:43], v[104:107], v[176:179]
    ds_read_b128 v[128:131], v241 offset:20288
    v_mfma_f32_16x16x32_bf16 v[172:175], v[40:43], v[100:103], v[172:175]
    v_mfma_f32_16x16x32_bf16 v[168:171], v[40:43], v[96:99], v[168:171]
    ds_read_b128 v[68:71], v240 offset:576
    buffer_load_dwordx4 a[192:195], v248, s[60:63], 0 offen offset:0 nt
    v_mfma_f32_16x16x32_bf16 v[172:175], v[44:47], v[96:99], v[172:175]
    ds_read_b128 v[72:75], v240 offset:1088
    v_mfma_f32_16x16x32_bf16 v[176:179], v[44:47], v[100:103], v[176:179]
    ds_read_b128 v[76:79], v240 offset:1600
    v_mfma_f32_16x16x32_bf16 v[180:183], v[44:47], v[104:107], v[180:183]
    v_mfma_f32_16x16x32_bf16 v[184:187], v[44:47], v[108:111], v[184:187]
    ds_read_b128 v[80:83], v240 offset:2112
    v_mfma_f32_16x16x32_bf16 v[188:191], v[44:47], v[112:115], v[188:191]
    ds_read_b128 v[84:87], v240 offset:2624
    v_mfma_f32_16x16x32_bf16 v[188:191], v[48:51], v[108:111], v[188:191]
    ds_read_b128 v[88:91], v240 offset:3136
    v_mfma_f32_16x16x32_bf16 v[184:187], v[48:51], v[104:107], v[184:187]
    v_mfma_f32_16x16x32_bf16 v[180:183], v[48:51], v[100:103], v[180:183]
    ds_read_b128 v[92:95], v240 offset:3648
    buffer_load_dwordx4 a[196:199], v248, s[60:63], 0 offen offset:512 nt
    v_mfma_f32_16x16x32_bf16 v[176:179], v[48:51], v[96:99], v[176:179]
    v_mfma_f32_16x16x32_bf16 v[180:183], v[52:55], v[96:99], v[180:183]
    v_mfma_f32_16x16x32_bf16 v[184:187], v[52:55], v[100:103], v[184:187]
    v_mfma_f32_16x16x32_bf16 v[188:191], v[52:55], v[104:107], v[188:191]
    v_mfma_f32_16x16x32_bf16 v[188:191], v[56:59], v[100:103], v[188:191]
    v_mfma_f32_16x16x32_bf16 v[184:187], v[56:59], v[96:99], v[184:187]
    v_mfma_f32_16x16x32_bf16 v[188:191], v[60:63], v[96:99], v[188:191]
    s_waitcnt lgkmcnt(0)
    v_mfma_f32_16x16x32_bf16 v[188:191], v[64:67], v[156:159], v[188:191]
    ds_read_b128 a[0:3], v240 offset:128
    buffer_load_dwordx4 a[200:203], v248, s[60:63], 0 offen offset:1024 nt
    v_mfma_f32_16x16x32_bf16 v[184:187], v[64:67], v[152:155], v[184:187]
    ds_read_b128 v[124:127], v241 offset:16768
    v_mfma_f32_16x16x32_bf16 v[180:183], v[64:67], v[148:151], v[180:183]
    ds_read_b128 v[120:123], v241 offset:17280
    v_mfma_f32_16x16x32_bf16 v[176:179], v[64:67], v[144:147], v[176:179]
    v_mfma_f32_16x16x32_bf16 v[172:175], v[64:67], v[140:143], v[172:175]
    ds_read_b128 v[116:119], v241 offset:17792
    v_mfma_f32_16x16x32_bf16 v[168:171], v[64:67], v[136:139], v[168:171]
    ds_read_b128 v[112:115], v241 offset:18304
    v_mfma_f32_16x16x32_bf16 v[164:167], v[64:67], v[132:135], v[164:167]
    ds_read_b128 a[28:31], v241 offset:18816
    v_mfma_f32_16x16x32_bf16 v[160:163], v[64:67], v[128:131], v[160:163]
    v_mfma_f32_16x16x32_bf16 v[164:167], v[68:71], v[128:131], v[164:167]
    ds_read_b128 a[24:27], v241 offset:19328
    buffer_load_dwordx4 a[204:207], v248, s[60:63], 0 offen offset:1536 nt
    v_mfma_f32_16x16x32_bf16 v[168:171], v[68:71], v[132:135], v[168:171]
    ds_read_b128 a[20:23], v241 offset:19840
    v_mfma_f32_16x16x32_bf16 v[172:175], v[68:71], v[136:139], v[172:175]
    ds_read_b128 a[16:19], v241 offset:20352
    v_mfma_f32_16x16x32_bf16 v[176:179], v[68:71], v[140:143], v[176:179]
    v_mfma_f32_16x16x32_bf16 v[180:183], v[68:71], v[144:147], v[180:183]
    ds_read_b128 a[4:7], v240 offset:640
    v_mfma_f32_16x16x32_bf16 v[184:187], v[68:71], v[148:151], v[184:187]
    ds_read_b128 a[8:11], v240 offset:1152
    v_mfma_f32_16x16x32_bf16 v[188:191], v[68:71], v[152:155], v[188:191]
    ds_read_b128 a[12:15], v240 offset:1664
    v_mfma_f32_16x16x32_bf16 v[188:191], v[72:75], v[148:151], v[188:191]
    v_mfma_f32_16x16x32_bf16 v[184:187], v[72:75], v[144:147], v[184:187]
    ds_read_b128 v[48:51], v240 offset:2176
    v_mfma_f32_16x16x32_bf16 v[180:183], v[72:75], v[140:143], v[180:183]
    ds_read_b128 v[52:55], v240 offset:2688
    v_mfma_f32_16x16x32_bf16 v[176:179], v[72:75], v[136:139], v[176:179]
    ds_read_b128 v[56:59], v240 offset:3200
    v_mfma_f32_16x16x32_bf16 v[172:175], v[72:75], v[132:135], v[172:175]
    v_mfma_f32_16x16x32_bf16 v[168:171], v[72:75], v[128:131], v[168:171]
    ds_read_b128 v[60:63], v240 offset:3712
    v_mfma_f32_16x16x32_bf16 v[172:175], v[76:79], v[128:131], v[172:175]
    v_mfma_f32_16x16x32_bf16 v[176:179], v[76:79], v[132:135], v[176:179]
    buffer_load_dwordx4 a[224:227], v246, s[48:51], 0 offen offset:256 nt
    v_mfma_f32_16x16x32_bf16 v[180:183], v[76:79], v[136:139], v[180:183]
    v_mfma_f32_16x16x32_bf16 v[184:187], v[76:79], v[140:143], v[184:187]
    v_mfma_f32_16x16x32_bf16 v[188:191], v[76:79], v[144:147], v[188:191]
    v_mfma_f32_16x16x32_bf16 v[188:191], v[80:83], v[140:143], v[188:191]
    v_mfma_f32_16x16x32_bf16 v[184:187], v[80:83], v[136:139], v[184:187]
    v_mfma_f32_16x16x32_bf16 v[180:183], v[80:83], v[132:135], v[180:183]
    v_mfma_f32_16x16x32_bf16 v[176:179], v[80:83], v[128:131], v[176:179]
    v_mfma_f32_16x16x32_bf16 v[180:183], v[84:87], v[128:131], v[180:183]
    buffer_load_dwordx4 a[228:231], v246, s[48:51], 0 offen offset:1280 nt
    v_mfma_f32_16x16x32_bf16 v[184:187], v[84:87], v[132:135], v[184:187]
    v_mfma_f32_16x16x32_bf16 v[188:191], v[84:87], v[136:139], v[188:191]
    v_mfma_f32_16x16x32_bf16 v[188:191], v[88:91], v[132:135], v[188:191]
    v_mfma_f32_16x16x32_bf16 v[184:187], v[88:91], v[128:131], v[184:187]
    v_mfma_f32_16x16x32_bf16 v[188:191], v[92:95], v[128:131], v[188:191]
    s_waitcnt lgkmcnt(0)
    v_mfma_f32_16x16x32_bf16 v[188:191], a[0:3], v[124:127], v[188:191]
    ds_read_b128 a[32:35], v240 offset:192
    v_mfma_f32_16x16x32_bf16 v[184:187], a[0:3], v[120:123], v[184:187]
    ds_read_b128 v[156:159], v241 offset:16832
    v_mfma_f32_16x16x32_bf16 v[180:183], a[0:3], v[116:119], v[180:183]
    ds_read_b128 v[152:155], v241 offset:17344
    v_mfma_f32_16x16x32_bf16 v[176:179], a[0:3], v[112:115], v[176:179]
    v_mfma_f32_16x16x32_bf16 v[176:179], a[4:7], a[28:31], v[176:179]
    ds_read_b128 v[148:151], v241 offset:17856
    v_mfma_f32_16x16x32_bf16 v[180:183], a[4:7], v[112:115], v[180:183]
    ds_read_b128 v[144:147], v241 offset:18368
    v_mfma_f32_16x16x32_bf16 v[184:187], a[4:7], v[116:119], v[184:187]
    ds_read_b128 a[60:63], v241 offset:18880
    v_mfma_f32_16x16x32_bf16 v[188:191], a[4:7], v[120:123], v[188:191]
    v_mfma_f32_16x16x32_bf16 v[188:191], a[8:11], v[116:119], v[188:191]
    ds_read_b128 a[56:59], v241 offset:19392
    v_mfma_f32_16x16x32_bf16 v[184:187], a[8:11], v[112:115], v[184:187]
    ds_read_b128 a[52:55], v241 offset:19904
    v_mfma_f32_16x16x32_bf16 v[180:183], a[8:11], a[28:31], v[180:183]
    ds_read_b128 a[48:51], v241 offset:20416
    v_mfma_f32_16x16x32_bf16 v[176:179], a[8:11], a[24:27], v[176:179]
    v_mfma_f32_16x16x32_bf16 v[176:179], a[12:15], a[20:23], v[176:179]
    ds_read_b128 a[36:39], v240 offset:704
    v_mfma_f32_16x16x32_bf16 v[180:183], a[12:15], a[24:27], v[180:183]
    ds_read_b128 a[40:43], v240 offset:1216
    v_mfma_f32_16x16x32_bf16 v[184:187], a[12:15], a[28:31], v[184:187]
    ds_read_b128 a[44:47], v240 offset:1728
    v_mfma_f32_16x16x32_bf16 v[188:191], a[12:15], v[112:115], v[188:191]
    v_mfma_f32_16x16x32_bf16 v[188:191], v[48:51], a[28:31], v[188:191]
    ds_read_b128 v[80:83], v240 offset:2240
    v_mfma_f32_16x16x32_bf16 v[184:187], v[48:51], a[24:27], v[184:187]
    ds_read_b128 v[84:87], v240 offset:2752
    v_mfma_f32_16x16x32_bf16 v[180:183], v[48:51], a[20:23], v[180:183]
    ds_read_b128 v[88:91], v240 offset:3264
    v_mfma_f32_16x16x32_bf16 v[176:179], v[48:51], a[16:19], v[176:179]
    v_mfma_f32_16x16x32_bf16 v[180:183], v[52:55], a[16:19], v[180:183]
    ds_read_b128 v[92:95], v240 offset:3776
    v_mfma_f32_16x16x32_bf16 v[184:187], v[52:55], a[20:23], v[184:187]
    v_mfma_f32_16x16x32_bf16 v[188:191], v[52:55], a[24:27], v[188:191]
    v_mfma_f32_16x16x32_bf16 v[188:191], v[56:59], a[20:23], v[188:191]
    v_mfma_f32_16x16x32_bf16 v[184:187], v[56:59], a[16:19], v[184:187]
    v_mfma_f32_16x16x32_bf16 v[188:191], v[60:63], a[16:19], v[188:191]
    s_waitcnt lgkmcnt(0)
    v_mfma_f32_16x16x32_bf16 v[188:191], a[32:35], v[156:159], v[188:191]
    ds_read_b128 a[64:67], v240 offset:256
    v_mfma_f32_16x16x32_bf16 v[184:187], a[32:35], v[152:155], v[184:187]
    ds_read_b128 v[124:127], v241 offset:16896
    v_mfma_f32_16x16x32_bf16 v[180:183], a[32:35], v[148:151], v[180:183]
    ds_read_b128 v[120:123], v241 offset:17408
    v_mfma_f32_16x16x32_bf16 v[176:179], a[32:35], v[144:147], v[176:179]
    v_mfma_f32_16x16x32_bf16 v[176:179], a[36:39], a[60:63], v[176:179]
    ds_read_b128 v[116:119], v241 offset:17920
    v_mfma_f32_16x16x32_bf16 v[180:183], a[36:39], v[144:147], v[180:183]
    ds_read_b128 v[112:115], v241 offset:18432
    v_mfma_f32_16x16x32_bf16 v[184:187], a[36:39], v[148:151], v[184:187]
    ds_read_b128 a[92:95], v241 offset:18944
    v_mfma_f32_16x16x32_bf16 v[188:191], a[36:39], v[152:155], v[188:191]
    v_mfma_f32_16x16x32_bf16 v[188:191], a[40:43], v[148:151], v[188:191]
    ds_read_b128 a[88:91], v241 offset:19456
    v_mfma_f32_16x16x32_bf16 v[184:187], a[40:43], v[144:147], v[184:187]
    ds_read_b128 a[84:87], v241 offset:19968
    v_mfma_f32_16x16x32_bf16 v[180:183], a[40:43], a[60:63], v[180:183]
    ds_read_b128 a[80:83], v241 offset:20480
    v_mfma_f32_16x16x32_bf16 v[176:179], a[40:43], a[56:59], v[176:179]
    v_mfma_f32_16x16x32_bf16 v[176:179], a[44:47], a[52:55], v[176:179]
    ds_read_b128 a[68:71], v240 offset:768
    v_mfma_f32_16x16x32_bf16 v[180:183], a[44:47], a[56:59], v[180:183]
    ds_read_b128 a[72:75], v240 offset:1280
    v_mfma_f32_16x16x32_bf16 v[184:187], a[44:47], a[60:63], v[184:187]
    ds_read_b128 a[76:79], v240 offset:1792
    v_mfma_f32_16x16x32_bf16 v[188:191], a[44:47], v[144:147], v[188:191]
    v_mfma_f32_16x16x32_bf16 v[188:191], v[80:83], a[60:63], v[188:191]
    ds_read_b128 v[48:51], v240 offset:2304
    v_mfma_f32_16x16x32_bf16 v[184:187], v[80:83], a[56:59], v[184:187]
    ds_read_b128 v[52:55], v240 offset:2816
    v_mfma_f32_16x16x32_bf16 v[180:183], v[80:83], a[52:55], v[180:183]
    ds_read_b128 v[56:59], v240 offset:3328
    v_mfma_f32_16x16x32_bf16 v[176:179], v[80:83], a[48:51], v[176:179]
    v_mfma_f32_16x16x32_bf16 v[180:183], v[84:87], a[48:51], v[180:183]
    ds_read_b128 v[60:63], v240 offset:3840
    v_mfma_f32_16x16x32_bf16 v[184:187], v[84:87], a[52:55], v[184:187]
    v_mfma_f32_16x16x32_bf16 v[188:191], v[84:87], a[56:59], v[188:191]
    v_mfma_f32_16x16x32_bf16 v[188:191], v[88:91], a[52:55], v[188:191]
    v_mfma_f32_16x16x32_bf16 v[184:187], v[88:91], a[48:51], v[184:187]
    v_mfma_f32_16x16x32_bf16 v[188:191], v[92:95], a[48:51], v[188:191]
    s_waitcnt lgkmcnt(0)
    v_mfma_f32_16x16x32_bf16 v[188:191], a[64:67], v[124:127], v[188:191]
    ds_read_b128 a[96:99], v240 offset:320
    v_mfma_f32_16x16x32_bf16 v[184:187], a[64:67], v[120:123], v[184:187]
    ds_read_b128 v[156:159], v241 offset:16960
    v_mfma_f32_16x16x32_bf16 v[180:183], a[64:67], v[116:119], v[180:183]
    ds_read_b128 v[152:155], v241 offset:17472
    v_mfma_f32_16x16x32_bf16 v[176:179], a[64:67], v[112:115], v[176:179]
    v_mfma_f32_16x16x32_bf16 v[176:179], a[68:71], a[92:95], v[176:179]
    ds_read_b128 v[148:151], v241 offset:17984
    v_mfma_f32_16x16x32_bf16 v[180:183], a[68:71], v[112:115], v[180:183]
    ds_read_b128 v[144:147], v241 offset:18496
    v_mfma_f32_16x16x32_bf16 v[184:187], a[68:71], v[116:119], v[184:187]
    ds_read_b128 a[124:127], v241 offset:19008
    v_mfma_f32_16x16x32_bf16 v[188:191], a[68:71], v[120:123], v[188:191]
    v_mfma_f32_16x16x32_bf16 v[188:191], a[72:75], v[116:119], v[188:191]
    ds_read_b128 a[120:123], v241 offset:19520
    v_mfma_f32_16x16x32_bf16 v[184:187], a[72:75], v[112:115], v[184:187]
    ds_read_b128 a[116:119], v241 offset:20032
    v_mfma_f32_16x16x32_bf16 v[180:183], a[72:75], a[92:95], v[180:183]
    ds_read_b128 a[112:115], v241 offset:20544
    v_mfma_f32_16x16x32_bf16 v[176:179], a[72:75], a[88:91], v[176:179]
    v_mfma_f32_16x16x32_bf16 v[176:179], a[76:79], a[84:87], v[176:179]
    ds_read_b128 a[100:103], v240 offset:832
    v_mfma_f32_16x16x32_bf16 v[180:183], a[76:79], a[88:91], v[180:183]
    ds_read_b128 a[104:107], v240 offset:1344
    v_mfma_f32_16x16x32_bf16 v[184:187], a[76:79], a[92:95], v[184:187]
    ds_read_b128 a[108:111], v240 offset:1856
    v_mfma_f32_16x16x32_bf16 v[188:191], a[76:79], v[112:115], v[188:191]
    v_mfma_f32_16x16x32_bf16 v[188:191], v[48:51], a[92:95], v[188:191]
    ds_read_b128 v[80:83], v240 offset:2368
    v_mfma_f32_16x16x32_bf16 v[184:187], v[48:51], a[88:91], v[184:187]
    ds_read_b128 v[84:87], v240 offset:2880
    v_mfma_f32_16x16x32_bf16 v[180:183], v[48:51], a[84:87], v[180:183]
    ds_read_b128 v[88:91], v240 offset:3392
    v_mfma_f32_16x16x32_bf16 v[176:179], v[48:51], a[80:83], v[176:179]
    v_mfma_f32_16x16x32_bf16 v[180:183], v[52:55], a[80:83], v[180:183]
    ds_read_b128 v[92:95], v240 offset:3904
    v_mfma_f32_16x16x32_bf16 v[184:187], v[52:55], a[84:87], v[184:187]
    v_mfma_f32_16x16x32_bf16 v[188:191], v[52:55], a[88:91], v[188:191]
    v_mfma_f32_16x16x32_bf16 v[188:191], v[56:59], a[84:87], v[188:191]
    v_mfma_f32_16x16x32_bf16 v[184:187], v[56:59], a[80:83], v[184:187]
    v_mfma_f32_16x16x32_bf16 v[188:191], v[60:63], a[80:83], v[188:191]
    s_waitcnt lgkmcnt(0)
    v_mfma_f32_16x16x32_bf16 v[188:191], a[96:99], v[156:159], v[188:191]
    ds_read_b128 a[128:131], v240 offset:384
    v_mfma_f32_16x16x32_bf16 v[184:187], a[96:99], v[152:155], v[184:187]
    ds_read_b128 v[124:127], v241 offset:17024
    v_mfma_f32_16x16x32_bf16 v[180:183], a[96:99], v[148:151], v[180:183]
    ds_read_b128 v[120:123], v241 offset:17536
    v_mfma_f32_16x16x32_bf16 v[176:179], a[96:99], v[144:147], v[176:179]
    v_mfma_f32_16x16x32_bf16 v[176:179], a[100:103], a[124:127], v[176:179]
    ds_read_b128 v[116:119], v241 offset:18048
    v_mfma_f32_16x16x32_bf16 v[180:183], a[100:103], v[144:147], v[180:183]
    ds_read_b128 v[112:115], v241 offset:18560
    v_mfma_f32_16x16x32_bf16 v[184:187], a[100:103], v[148:151], v[184:187]
    ds_read_b128 a[156:159], v241 offset:19072
    v_mfma_f32_16x16x32_bf16 v[188:191], a[100:103], v[152:155], v[188:191]
    v_mfma_f32_16x16x32_bf16 v[188:191], a[104:107], v[148:151], v[188:191]
    ds_read_b128 a[152:155], v241 offset:19584
    v_mfma_f32_16x16x32_bf16 v[184:187], a[104:107], v[144:147], v[184:187]
    ds_read_b128 a[148:151], v241 offset:20096
    v_mfma_f32_16x16x32_bf16 v[180:183], a[104:107], a[124:127], v[180:183]
    ds_read_b128 a[144:147], v241 offset:20608
    v_mfma_f32_16x16x32_bf16 v[176:179], a[104:107], a[120:123], v[176:179]
    v_mfma_f32_16x16x32_bf16 v[176:179], a[108:111], a[116:119], v[176:179]
    ds_read_b128 a[132:135], v240 offset:896
    v_mfma_f32_16x16x32_bf16 v[180:183], a[108:111], a[120:123], v[180:183]
    ds_read_b128 a[136:139], v240 offset:1408
    v_mfma_f32_16x16x32_bf16 v[184:187], a[108:111], a[124:127], v[184:187]
    ds_read_b128 a[140:143], v240 offset:1920
    v_mfma_f32_16x16x32_bf16 v[188:191], a[108:111], v[144:147], v[188:191]
    v_mfma_f32_16x16x32_bf16 v[188:191], v[80:83], a[124:127], v[188:191]
    ds_read_b128 v[48:51], v240 offset:2432
    v_mfma_f32_16x16x32_bf16 v[184:187], v[80:83], a[120:123], v[184:187]
    ds_read_b128 v[52:55], v240 offset:2944
    v_mfma_f32_16x16x32_bf16 v[180:183], v[80:83], a[116:119], v[180:183]
    ds_read_b128 v[56:59], v240 offset:3456
    v_mfma_f32_16x16x32_bf16 v[176:179], v[80:83], a[112:115], v[176:179]
    v_mfma_f32_16x16x32_bf16 v[180:183], v[84:87], a[112:115], v[180:183]
    ds_read_b128 v[60:63], v240 offset:3968
    v_mfma_f32_16x16x32_bf16 v[184:187], v[84:87], a[116:119], v[184:187]
    v_mfma_f32_16x16x32_bf16 v[188:191], v[84:87], a[120:123], v[188:191]
    v_mfma_f32_16x16x32_bf16 v[188:191], v[88:91], a[116:119], v[188:191]
    v_mfma_f32_16x16x32_bf16 v[184:187], v[88:91], a[112:115], v[184:187]
    v_mfma_f32_16x16x32_bf16 v[188:191], v[92:95], a[112:115], v[188:191]
    s_waitcnt lgkmcnt(0)
    v_mfma_f32_16x16x32_bf16 v[188:191], a[128:131], v[124:127], v[188:191]
    ds_read_b128 a[160:163], v240 offset:448
    ds_read_b64 v[232:233], v243 offset:22752
    v_mfma_f32_16x16x32_bf16 v[184:187], a[128:131], v[120:123], v[184:187]
    ds_read_b128 v[156:159], v241 offset:17088
    ds_read_b64 v[234:235], v243 offset:22240
    v_mfma_f32_16x16x32_bf16 v[180:183], a[128:131], v[116:119], v[180:183]
    ds_read_b128 v[152:155], v241 offset:17600
    ds_read_b64 v[236:237], v243 offset:21728
    v_mfma_f32_16x16x32_bf16 v[176:179], a[128:131], v[112:115], v[176:179]
    ds_read_b64 v[238:239], v243 offset:21216
    v_mfma_f32_16x16x32_bf16 v[176:179], a[132:135], a[156:159], v[176:179]
    ds_read_b128 v[148:151], v241 offset:18112
    v_mfma_f32_16x16x32_bf16 v[180:183], a[132:135], v[112:115], v[180:183]
    ds_read_b128 v[144:147], v241 offset:18624
    v_mfma_f32_16x16x32_bf16 v[184:187], a[132:135], v[116:119], v[184:187]
    ds_read_b128 a[188:191], v241 offset:19136
    v_mfma_f32_16x16x32_bf16 v[188:191], a[132:135], v[120:123], v[188:191]
    v_mfma_f32_16x16x32_bf16 v[188:191], a[136:139], v[116:119], v[188:191]
    ds_read_b128 a[184:187], v241 offset:19648
    v_mfma_f32_16x16x32_bf16 v[184:187], a[136:139], v[112:115], v[184:187]
    ds_read_b128 a[180:183], v241 offset:20160
    v_mfma_f32_16x16x32_bf16 v[180:183], a[136:139], a[156:159], v[180:183]
    ds_read_b128 a[176:179], v241 offset:20672
    v_mfma_f32_16x16x32_bf16 v[176:179], a[136:139], a[152:155], v[176:179]
    v_mfma_f32_16x16x32_bf16 v[176:179], a[140:143], a[148:151], v[176:179]
    ds_read_b128 a[164:167], v240 offset:960
    v_mfma_f32_16x16x32_bf16 v[180:183], a[140:143], a[152:155], v[180:183]
    ds_read_b128 a[168:171], v240 offset:1472
    s_waitcnt vmcnt(0)
    buffer_store_dwordx4 a[224:227], v247, s[44:47], 0 offen offset:0 sc1
    v_mfma_f32_16x16x32_bf16 v[184:187], a[140:143], a[156:159], v[184:187]
    ds_read_b128 a[172:175], v240 offset:1984
    v_mfma_f32_16x16x32_bf16 v[188:191], a[140:143], v[112:115], v[188:191]
    v_mfma_f32_16x16x32_bf16 v[188:191], v[48:51], a[156:159], v[188:191]
    ds_read_b128 v[80:83], v240 offset:2496
    v_mfma_f32_16x16x32_bf16 v[184:187], v[48:51], a[152:155], v[184:187]
    ds_read_b128 v[84:87], v240 offset:3008
    v_mfma_f32_16x16x32_bf16 v[180:183], v[48:51], a[148:151], v[180:183]
    ds_read_b128 v[88:91], v240 offset:3520
    v_mfma_f32_16x16x32_bf16 v[176:179], v[48:51], a[144:147], v[176:179]
    v_mfma_f32_16x16x32_bf16 v[180:183], v[52:55], a[144:147], v[180:183]
    ds_read_b128 v[92:95], v240 offset:4032
    v_mfma_f32_16x16x32_bf16 v[184:187], v[52:55], a[148:151], v[184:187]
    v_mfma_f32_16x16x32_bf16 v[188:191], v[52:55], a[152:155], v[188:191]
    v_mfma_f32_16x16x32_bf16 v[188:191], v[56:59], a[148:151], v[188:191]
    v_mfma_f32_16x16x32_bf16 v[184:187], v[56:59], a[144:147], v[184:187]
    v_mfma_f32_16x16x32_bf16 v[188:191], v[60:63], a[144:147], v[188:191]
    s_waitcnt vmcnt(1)
    buffer_store_dwordx4 a[228:231], v247, s[44:47], 0 offen offset:512 sc1
    s_waitcnt lgkmcnt(0)
    v_mfma_f32_16x16x32_bf16 v[188:191], a[160:163], v[156:159], v[188:191]
    v_and_b32 v208, 0xffff0000, v233
    v_lshlrev_b32 v209, 16, v233
    v_mfma_f32_16x16x32_bf16 v[184:187], a[160:163], v[152:155], v[184:187]
    v_and_b32 v210, 0xffff0000, v232
    v_lshlrev_b32 v211, 16, v232
    v_mfma_f32_16x16x32_bf16 v[180:183], a[160:163], v[148:151], v[180:183]
    v_and_b32 v212, 0xffff0000, v235
    v_lshlrev_b32 v213, 16, v235
    v_mfma_f32_16x16x32_bf16 v[176:179], a[160:163], v[144:147], v[176:179]
    v_and_b32 v214, 0xffff0000, v234
    v_lshlrev_b32 v215, 16, v234
    v_mfma_f32_16x16x32_bf16 v[176:179], a[164:167], a[188:191], v[176:179]
    v_and_b32 v216, 0xffff0000, v237
    v_lshlrev_b32 v217, 16, v237
    v_mfma_f32_16x16x32_bf16 v[180:183], a[164:167], v[144:147], v[180:183]
    v_and_b32 v218, 0xffff0000, v236
    v_lshlrev_b32 v219, 16, v236
    v_mfma_f32_16x16x32_bf16 v[184:187], a[164:167], v[148:151], v[184:187]
    v_and_b32 v220, 0xffff0000, v239
    v_lshlrev_b32 v221, 16, v239
    v_mfma_f32_16x16x32_bf16 v[188:191], a[164:167], v[152:155], v[188:191]
    v_and_b32 v222, 0xffff0000, v238
    v_lshlrev_b32 v223, 16, v238
    v_mfma_f32_16x16x32_bf16 v[188:191], a[168:171], v[148:151], v[188:191]
    v_mfma_f32_16x16x32_bf16 v[184:187], a[168:171], v[144:147], v[184:187]
    v_mfma_f32_16x16x32_bf16 v[180:183], a[168:171], a[188:191], v[180:183]
    v_mfma_f32_16x16x32_bf16 v[176:179], a[168:171], a[184:187], v[176:179]
    v_mfma_f32_16x16x32_bf16 v[176:179], a[172:175], a[180:183], v[176:179]
    v_mfma_f32_16x16x32_bf16 v[180:183], a[172:175], a[184:187], v[180:183]
    v_mfma_f32_16x16x32_bf16 v[184:187], a[172:175], a[188:191], v[184:187]
    v_mfma_f32_16x16x32_bf16 v[188:191], a[172:175], v[144:147], v[188:191]
    v_mfma_f32_16x16x32_bf16 v[188:191], v[80:83], a[188:191], v[188:191]
    v_mfma_f32_16x16x32_bf16 v[184:187], v[80:83], a[184:187], v[184:187]
    v_mfma_f32_16x16x32_bf16 v[180:183], v[80:83], a[180:183], v[180:183]
    v_mfma_f32_16x16x32_bf16 v[176:179], v[80:83], a[176:179], v[176:179]
    v_mfma_f32_16x16x32_bf16 v[180:183], v[84:87], a[176:179], v[180:183]
    v_mfma_f32_16x16x32_bf16 v[184:187], v[84:87], a[180:183], v[184:187]
    v_mfma_f32_16x16x32_bf16 v[188:191], v[84:87], a[184:187], v[188:191]
    v_mfma_f32_16x16x32_bf16 v[188:191], v[88:91], a[180:183], v[188:191]
    v_mfma_f32_16x16x32_bf16 v[184:187], v[88:91], a[176:179], v[184:187]
    v_mfma_f32_16x16x32_bf16 v[188:191], v[92:95], a[176:179], v[188:191]
    s_waitcnt lgkmcnt(0)
    v_mfma_f32_16x16x32_bf16 v[172:175], a[0:3], a[28:31], v[172:175]
    v_mfma_f32_16x16x32_bf16 v[168:171], a[0:3], a[24:27], v[168:171]
    v_mfma_f32_16x16x32_bf16 v[164:167], a[0:3], a[20:23], v[164:167]
    v_mfma_f32_16x16x32_bf16 v[160:163], a[0:3], a[16:19], v[160:163]
    v_fmac_f32 v176, s84, v208
    v_fmac_f32 v177, s84, v209
    v_mfma_f32_16x16x32_bf16 v[164:167], a[4:7], a[16:19], v[164:167]
    v_fmac_f32 v178, s84, v210
    v_fmac_f32 v179, s84, v211
    v_mfma_f32_16x16x32_bf16 v[168:171], a[4:7], a[20:23], v[168:171]
    v_cvt_pk_bf16_f32 v224, v176, v177
    v_cvt_pk_bf16_f32 v225, v178, v179
    v_mfma_f32_16x16x32_bf16 v[172:175], a[4:7], a[24:27], v[172:175]
    ds_write_b64 v242, v[224:225] offset:2048
    v_fmac_f32 v180, s84, v212
    v_mfma_f32_16x16x32_bf16 v[172:175], a[8:11], a[20:23], v[172:175]
    v_fmac_f32 v181, s84, v213
    v_fmac_f32 v182, s84, v214
    v_mfma_f32_16x16x32_bf16 v[168:171], a[8:11], a[16:19], v[168:171]
    v_fmac_f32 v183, s84, v215
    v_cvt_pk_bf16_f32 v226, v180, v181
    v_mfma_f32_16x16x32_bf16 v[172:175], a[12:15], a[16:19], v[172:175]
    v_cvt_pk_bf16_f32 v227, v182, v183
    ds_write_b64 v242, v[226:227] offset:2560
    v_mfma_f32_16x16x32_bf16 v[172:175], a[32:35], a[60:63], v[172:175]
    v_fmac_f32 v184, s84, v216
    v_fmac_f32 v185, s84, v217
    v_mfma_f32_16x16x32_bf16 v[168:171], a[32:35], a[56:59], v[168:171]
    v_fmac_f32 v186, s84, v218
    v_fmac_f32 v187, s84, v219
    v_mfma_f32_16x16x32_bf16 v[164:167], a[32:35], a[52:55], v[164:167]
    v_cvt_pk_bf16_f32 v228, v184, v185
    v_cvt_pk_bf16_f32 v229, v186, v187
    v_mfma_f32_16x16x32_bf16 v[160:163], a[32:35], a[48:51], v[160:163]
    ds_write_b64 v242, v[228:229] offset:3072
    v_fmac_f32 v188, s84, v220
    v_mfma_f32_16x16x32_bf16 v[164:167], a[36:39], a[48:51], v[164:167]
    v_fmac_f32 v189, s84, v221
    v_fmac_f32 v190, s84, v222
    v_mfma_f32_16x16x32_bf16 v[168:171], a[36:39], a[52:55], v[168:171]
    v_fmac_f32 v191, s84, v223
    v_cvt_pk_bf16_f32 v230, v188, v189
    v_mfma_f32_16x16x32_bf16 v[172:175], a[36:39], a[56:59], v[172:175]
    v_cvt_pk_bf16_f32 v231, v190, v191
    ds_write_b64 v242, v[230:231] offset:3584
    v_mfma_f32_16x16x32_bf16 v[172:175], a[40:43], a[52:55], v[172:175]
    v_mfma_f32_16x16x32_bf16 v[168:171], a[40:43], a[48:51], v[168:171]
    v_mfma_f32_16x16x32_bf16 v[172:175], a[44:47], a[48:51], v[172:175]
    v_mfma_f32_16x16x32_bf16 v[172:175], a[64:67], a[92:95], v[172:175]
    v_mfma_f32_16x16x32_bf16 v[168:171], a[64:67], a[88:91], v[168:171]
    s_waitcnt lgkmcnt(0)
    s_barrier
    v_mfma_f32_16x16x32_bf16 v[164:167], a[64:67], a[84:87], v[164:167]
    ds_read_b32 v192, v245 offset:2048
    ds_read_b32 v193, v245 offset:6144
    v_mfma_f32_16x16x32_bf16 v[160:163], a[64:67], a[80:83], v[160:163]
    ds_read_b32 v194, v245 offset:10240
    ds_read_b32 v195, v245 offset:14336
    v_mfma_f32_16x16x32_bf16 v[164:167], a[68:71], a[80:83], v[164:167]
    ds_read_b32 v196, v245 offset:2304
    ds_read_b32 v197, v245 offset:6400
    v_mfma_f32_16x16x32_bf16 v[168:171], a[68:71], a[84:87], v[168:171]
    ds_read_b32 v198, v245 offset:10496
    ds_read_b32 v199, v245 offset:14592
    v_mfma_f32_16x16x32_bf16 v[172:175], a[68:71], a[88:91], v[172:175]
    ds_read_b64 v[232:233], v243 offset:24800
    ds_read_b64 v[234:235], v243 offset:24288
    v_mfma_f32_16x16x32_bf16 v[172:175], a[72:75], a[84:87], v[172:175]
    ds_read_b64 v[236:237], v243 offset:23776
    ds_read_b64 v[238:239], v243 offset:23264
    v_mfma_f32_16x16x32_bf16 v[168:171], a[72:75], a[80:83], v[168:171]
    v_mfma_f32_16x16x32_bf16 v[172:175], a[76:79], a[80:83], v[172:175]
    v_mfma_f32_16x16x32_bf16 v[172:175], a[96:99], a[124:127], v[172:175]
    v_mfma_f32_16x16x32_bf16 v[168:171], a[96:99], a[120:123], v[168:171]
    v_mfma_f32_16x16x32_bf16 v[164:167], a[96:99], a[116:119], v[164:167]
    v_mfma_f32_16x16x32_bf16 v[160:163], a[96:99], a[112:115], v[160:163]
    s_waitcnt lgkmcnt(0)
    v_mfma_f32_16x16x32_bf16 v[164:167], a[100:103], a[112:115], v[164:167]
    s_mov_b32 s64, 0x280000
    v_perm_b32 v200, v193, v192, s20
    v_mfma_f32_16x16x32_bf16 v[168:171], a[100:103], a[116:119], v[168:171]
    v_perm_b32 v201, v195, v194, s20
    v_perm_b32 v202, v193, v192, s21
    v_mfma_f32_16x16x32_bf16 v[172:175], a[100:103], a[120:123], v[172:175]
    v_perm_b32 v203, v195, v194, s21
    buffer_store_dwordx4 v[200:203], v4, s[44:47], s64 offen sc1
    v_mfma_f32_16x16x32_bf16 v[172:175], a[104:107], a[116:119], v[172:175]
    s_mov_b32 s64, 0x2d0000
    v_perm_b32 v204, v197, v196, s20
    v_mfma_f32_16x16x32_bf16 v[168:171], a[104:107], a[112:115], v[168:171]
    v_perm_b32 v205, v199, v198, s20
    v_perm_b32 v206, v197, v196, s21
    v_mfma_f32_16x16x32_bf16 v[172:175], a[108:111], a[112:115], v[172:175]
    v_perm_b32 v207, v199, v198, s21
    buffer_store_dwordx4 v[204:207], v4, s[44:47], s64 offen sc1
    v_mfma_f32_16x16x32_bf16 v[172:175], a[128:131], a[156:159], v[172:175]
    v_and_b32 v208, 0xffff0000, v233
    v_lshlrev_b32 v209, 16, v233
    v_mfma_f32_16x16x32_bf16 v[168:171], a[128:131], a[152:155], v[168:171]
    v_and_b32 v210, 0xffff0000, v232
    v_lshlrev_b32 v211, 16, v232
    v_mfma_f32_16x16x32_bf16 v[164:167], a[128:131], a[148:151], v[164:167]
    v_and_b32 v212, 0xffff0000, v235
    v_lshlrev_b32 v213, 16, v235
    v_mfma_f32_16x16x32_bf16 v[160:163], a[128:131], a[144:147], v[160:163]
    v_and_b32 v214, 0xffff0000, v234
    v_lshlrev_b32 v215, 16, v234
    v_mfma_f32_16x16x32_bf16 v[164:167], a[132:135], a[144:147], v[164:167]
    v_and_b32 v216, 0xffff0000, v237
    v_lshlrev_b32 v217, 16, v237
    v_mfma_f32_16x16x32_bf16 v[168:171], a[132:135], a[148:151], v[168:171]
    v_and_b32 v218, 0xffff0000, v236
    v_lshlrev_b32 v219, 16, v236
    v_mfma_f32_16x16x32_bf16 v[172:175], a[132:135], a[152:155], v[172:175]
    v_and_b32 v220, 0xffff0000, v239
    v_lshlrev_b32 v221, 16, v239
    v_mfma_f32_16x16x32_bf16 v[172:175], a[136:139], a[148:151], v[172:175]
    v_and_b32 v222, 0xffff0000, v238
    v_lshlrev_b32 v223, 16, v238
    v_mfma_f32_16x16x32_bf16 v[168:171], a[136:139], a[144:147], v[168:171]
    v_mfma_f32_16x16x32_bf16 v[172:175], a[140:143], a[144:147], v[172:175]
    v_mfma_f32_16x16x32_bf16 v[172:175], a[160:163], a[188:191], v[172:175]
    v_mfma_f32_16x16x32_bf16 v[168:171], a[160:163], a[184:187], v[168:171]
    v_mfma_f32_16x16x32_bf16 v[164:167], a[160:163], a[180:183], v[164:167]
    v_mfma_f32_16x16x32_bf16 v[160:163], a[160:163], a[176:179], v[160:163]
    v_mfma_f32_16x16x32_bf16 v[164:167], a[164:167], a[176:179], v[164:167]
    v_mfma_f32_16x16x32_bf16 v[168:171], a[164:167], a[180:183], v[168:171]
    v_mfma_f32_16x16x32_bf16 v[172:175], a[164:167], a[184:187], v[172:175]
    v_mfma_f32_16x16x32_bf16 v[172:175], a[168:171], a[180:183], v[172:175]
    v_mfma_f32_16x16x32_bf16 v[168:171], a[168:171], a[176:179], v[168:171]
    v_mfma_f32_16x16x32_bf16 v[172:175], a[172:175], a[176:179], v[172:175]
    s_nop 1
    v_pk_fma_f32 v[160:161], v[208:209], s[84:85], v[160:161]
    v_pk_fma_f32 v[162:163], v[210:211], s[84:85], v[162:163]
    v_cvt_pk_bf16_f32 v224, v160, v161
    v_cvt_pk_bf16_f32 v225, v162, v163
    ds_write_b64 v242, v[224:225] offset:0
    v_pk_fma_f32 v[164:165], v[212:213], s[84:85], v[164:165]
    v_pk_fma_f32 v[166:167], v[214:215], s[84:85], v[166:167]
    v_cvt_pk_bf16_f32 v226, v164, v165
    v_cvt_pk_bf16_f32 v227, v166, v167
    ds_write_b64 v242, v[226:227] offset:512
    v_pk_fma_f32 v[168:169], v[216:217], s[84:85], v[168:169]
    v_pk_fma_f32 v[170:171], v[218:219], s[84:85], v[170:171]
    v_cvt_pk_bf16_f32 v228, v168, v169
    v_cvt_pk_bf16_f32 v229, v170, v171
    ds_write_b64 v242, v[228:229] offset:1024
    v_pk_fma_f32 v[172:173], v[220:221], s[84:85], v[172:173]
    v_pk_fma_f32 v[174:175], v[222:223], s[84:85], v[174:175]
    v_cvt_pk_bf16_f32 v230, v172, v173
    v_cvt_pk_bf16_f32 v231, v174, v175
    ds_write_b64 v242, v[230:231] offset:1536
    s_waitcnt lgkmcnt(0)
    s_barrier
    ds_read_b32 v192, v245 offset:0
    ds_read_b32 v193, v245 offset:4096
    ds_read_b32 v194, v245 offset:8192
    ds_read_b32 v195, v245 offset:12288
    ds_read_b32 v196, v245 offset:256
    ds_read_b32 v197, v245 offset:4352
    ds_read_b32 v198, v245 offset:8448
    ds_read_b32 v199, v245 offset:12544
    s_waitcnt lgkmcnt(4)
    s_mov_b32 s64, 0x0
    v_perm_b32 v200, v193, v192, s20
    v_perm_b32 v201, v195, v194, s20
    v_perm_b32 v202, v193, v192, s21
    v_perm_b32 v203, v195, v194, s21
    buffer_store_dwordx4 v[200:203], v4, s[44:47], s64 offen sc1
    s_waitcnt lgkmcnt(0)
    s_mov_b32 s64, 0x50000
    v_perm_b32 v204, v197, v196, s20
    v_perm_b32 v205, v199, v198, s20
    v_perm_b32 v206, v197, v196, s21
    v_perm_b32 v207, v199, v198, s21
    buffer_store_dwordx4 v[204:207], v4, s[44:47], s64 offen sc1
    v_accvgpr_read_b32 v32, a192
    v_accvgpr_read_b32 v33, a193
    v_accvgpr_read_b32 v34, a194
    v_accvgpr_read_b32 v35, a195
    v_accvgpr_read_b32 v36, a196
    v_accvgpr_read_b32 v37, a197
    v_accvgpr_read_b32 v38, a198
    v_accvgpr_read_b32 v39, a199
    v_accvgpr_read_b32 v40, a200
    v_accvgpr_read_b32 v41, a201
    v_accvgpr_read_b32 v42, a202
    v_accvgpr_read_b32 v43, a203
    v_accvgpr_read_b32 v44, a204
    v_accvgpr_read_b32 v45, a205
    v_accvgpr_read_b32 v46, a206
    v_accvgpr_read_b32 v47, a207
    v_lshlrev_b32 v64, 16, v32
    v_and_b32 v65, 0xffff0000, v32
    v_lshlrev_b32 v66, 16, v33
    v_and_b32 v67, 0xffff0000, v33
    v_lshlrev_b32 v68, 16, v34
    v_and_b32 v69, 0xffff0000, v34
    v_lshlrev_b32 v70, 16, v35
    v_and_b32 v71, 0xffff0000, v35
    v_lshlrev_b32 v72, 16, v36
    v_and_b32 v73, 0xffff0000, v36
    v_lshlrev_b32 v74, 16, v37
    v_and_b32 v75, 0xffff0000, v37
    v_lshlrev_b32 v76, 16, v38
    v_and_b32 v77, 0xffff0000, v38
    v_lshlrev_b32 v78, 16, v39
    v_and_b32 v79, 0xffff0000, v39
    v_lshlrev_b32 v80, 16, v40
    v_and_b32 v81, 0xffff0000, v40
    v_lshlrev_b32 v82, 16, v41
    v_and_b32 v83, 0xffff0000, v41
    v_lshlrev_b32 v84, 16, v42
    v_and_b32 v85, 0xffff0000, v42
    v_lshlrev_b32 v86, 16, v43
    v_and_b32 v87, 0xffff0000, v43
    v_lshlrev_b32 v88, 16, v44
    v_and_b32 v89, 0xffff0000, v44
    v_lshlrev_b32 v90, 16, v45
    v_and_b32 v91, 0xffff0000, v45
    v_lshlrev_b32 v92, 16, v46
    v_and_b32 v93, 0xffff0000, v46
    v_lshlrev_b32 v94, 16, v47
    v_and_b32 v95, 0xffff0000, v47
    v_and_b32 v16, 7, v0
    v_lshlrev_b32 v16, 5, v16
    v_add_u32 v16, 139264, v16
    s_lshl_b32 s64, s5, 3
    v_add_u32 v17, s64, v16
    v_pk_add_f32 v[128:129], v[64:65], v[72:73]
    v_pk_mul_f32 v[136:137], v[64:65], v[64:65]
    v_pk_add_f32 v[130:131], v[66:67], v[74:75]
    v_pk_mul_f32 v[138:139], v[66:67], v[66:67]
    v_pk_add_f32 v[132:133], v[68:69], v[76:77]
    v_pk_mul_f32 v[140:141], v[68:69], v[68:69]
    v_pk_add_f32 v[134:135], v[70:71], v[78:79]
    v_pk_mul_f32 v[142:143], v[70:71], v[70:71]
    v_pk_fma_f32 v[136:137], v[72:73], v[72:73], v[136:137]
    v_pk_fma_f32 v[138:139], v[74:75], v[74:75], v[138:139]
    v_pk_fma_f32 v[140:141], v[76:77], v[76:77], v[140:141]
    v_pk_fma_f32 v[142:143], v[78:79], v[78:79], v[142:143]
    v_pk_add_f32 v[128:129], v[128:129], v[80:81]
    v_pk_fma_f32 v[136:137], v[80:81], v[80:81], v[136:137]
    v_pk_add_f32 v[130:131], v[130:131], v[82:83]
    v_pk_fma_f32 v[138:139], v[82:83], v[82:83], v[138:139]
    v_pk_add_f32 v[132:133], v[132:133], v[84:85]
    v_pk_fma_f32 v[140:141], v[84:85], v[84:85], v[140:141]
    v_pk_add_f32 v[134:135], v[134:135], v[86:87]
    v_pk_fma_f32 v[142:143], v[86:87], v[86:87], v[142:143]
    v_pk_add_f32 v[128:129], v[128:129], v[88:89]
    v_pk_fma_f32 v[136:137], v[88:89], v[88:89], v[136:137]
    v_pk_add_f32 v[130:131], v[130:131], v[90:91]
    v_pk_fma_f32 v[138:139], v[90:91], v[90:91], v[138:139]
    v_pk_add_f32 v[132:133], v[132:133], v[92:93]
    v_pk_fma_f32 v[140:141], v[92:93], v[92:93], v[140:141]
    v_pk_add_f32 v[134:135], v[134:135], v[94:95]
    v_pk_fma_f32 v[142:143], v[94:95], v[94:95], v[142:143]
    v_pk_add_f32 v[128:129], v[128:129], v[130:131]
    v_pk_add_f32 v[132:133], v[132:133], v[134:135]
    v_pk_add_f32 v[136:137], v[136:137], v[138:139]
    v_pk_add_f32 v[140:141], v[140:141], v[142:143]
    v_pk_add_f32 v[128:129], v[128:129], v[132:133]
    v_pk_add_f32 v[136:137], v[136:137], v[140:141]
    v_add_f32 v12, v128, v129
    v_add_f32 v13, v136, v137
    s_nop 0
    v_add_f32_dpp v12, v12, v12 row_ror:8 row_mask:0xf bank_mask:0xf
    v_add_f32_dpp v13, v13, v13 row_ror:8 row_mask:0xf bank_mask:0xf
    v_mov_b32 v14, v12
    v_mov_b32 v15, v13
    s_nop 0
    v_permlane16_swap_b32 v12, v14
    v_permlane16_swap_b32 v13, v15
    v_pk_add_f32 v[12:13], v[12:13], v[14:15]
    v_mov_b32 v14, v12
    v_mov_b32 v15, v13
    s_nop 0
    v_permlane32_swap_b32 v12, v14
    v_permlane32_swap_b32 v13, v15
    v_pk_add_f32 v[12:13], v[12:13], v[14:15]
    ds_write_b64 v17, v[12:13]
    s_waitcnt lgkmcnt(0)
    s_mul_i32 s64, s4, 57344
    s_mul_i32 s68, s3, 896
    s_add_u32 s64, s64, s68
    s_add_u32 s64, s64, 1835008
    s_cmp_ge_u32 s5, 2
    s_cselect_b32 s64, s64, 0x40000000
    buffer_load_dword v30, v3, s[40:43], s64 offen
    s_waitcnt vmcnt(1)
    s_barrier
    s_cmp_lg_u32 s5, 1
    s_cbranch_scc1 L_sig2
    s_lshl_b32 s100, s3, 8
    s_lshl_b32 s101, s4, 2
    s_add_u32 s100, s100, s101
    s_add_u32 s100, s100, 0x1720000
    v_lshlrev_b32 v29, 11, v1
    s_mov_b32 exec_lo, 0xff
    s_mov_b32 exec_hi, 0
    buffer_store_dword v28, v29, s[44:47], s100 offen sc1
    s_mov_b64 exec, -1
    v_and_b32 v29, 31, v1
    v_lshlrev_b32 v29, 2, v29
L_sig2:
    ds_read_b128 v[128:131], v16
    ds_read_b128 v[132:135], v16 offset:16
    s_waitcnt lgkmcnt(0)
    v_pk_add_f32 v[128:129], v[128:129], v[130:131]
    v_pk_add_f32 v[132:133], v[132:133], v[134:135]
    v_pk_add_f32 v[12:13], v[128:129], v[132:133]
    v_mul_f32 v12, 0x3a800000, v12
    v_mul_f32 v13, 0x3a800000, v13
    v_fma_f32 v13, -v12, v12, v13
    v_max_f32 v13, 0, v13
    v_cvt_pk_bf16_f32 v12, v12, v13
    v_and_b32 v13, 0xffff0000, v12
    v_lshlrev_b32 v12, 16, v12
    v_add_f32 v13, 0x3727c5ac, v13
    v_cvt_pk_bf16_f32 v13, v13, v13
    v_lshlrev_b32 v13, 16, v13
    v_sqrt_f32 v13, v13
    s_nop 0
    v_cvt_pk_bf16_f32 v13, v13, v13
    v_lshlrev_b32 v13, 16, v13
    v_rcp_f32 v18, v13
    v_rcp_f32 v19, v13
    v_mul_f32_e64 v20, -v12, v18
    v_mul_f32_e64 v21, -v12, v18
    v_pk_fma_f32 v[144:145], v[64:65], v[18:19], v[20:21]
    v_pk_fma_f32 v[146:147], v[66:67], v[18:19], v[20:21]
    v_pk_fma_f32 v[148:149], v[68:69], v[18:19], v[20:21]
    v_pk_fma_f32 v[150:151], v[70:71], v[18:19], v[20:21]
    v_pk_fma_f32 v[152:153], v[72:73], v[18:19], v[20:21]
    v_pk_fma_f32 v[154:155], v[74:75], v[18:19], v[20:21]
    v_pk_fma_f32 v[156:157], v[76:77], v[18:19], v[20:21]
    v_pk_fma_f32 v[158:159], v[78:79], v[18:19], v[20:21]
    v_pk_fma_f32 v[160:161], v[80:81], v[18:19], v[20:21]
    v_pk_fma_f32 v[162:163], v[82:83], v[18:19], v[20:21]
    v_pk_fma_f32 v[164:165], v[84:85], v[18:19], v[20:21]
    v_pk_fma_f32 v[166:167], v[86:87], v[18:19], v[20:21]
    v_pk_fma_f32 v[168:169], v[88:89], v[18:19], v[20:21]
    v_pk_fma_f32 v[170:171], v[90:91], v[18:19], v[20:21]
    v_pk_fma_f32 v[172:173], v[92:93], v[18:19], v[20:21]
    v_pk_fma_f32 v[174:175], v[94:95], v[18:19], v[20:21]
    s_cmp_lg_u32 s5, 0
    s_cbranch_scc1 L_got2
    v_lshrrev_b32 v29, 3, v1
    v_lshlrev_b32 v29, 8, v29
    v_and_b32 v30, 7, v1
    v_lshl_add_u32 v29, v30, 4, v29
    s_and_b32 s100, s2, 7
    s_lshl_b32 s100, s100, 11
    s_add_u32 s100, s100, 0x1720000
    s_mov_b32 s101, 0
L_poll2:
    buffer_load_dwordx4 v[244:247], v29, s[44:47], s100 offen sc1
    s_waitcnt vmcnt(0)
    v_xor_b32 v244, s34, v244
    v_xor_b32 v245, s34, v245
    v_xor_b32 v246, s34, v246
    v_xor_b32 v247, s34, v247
    v_or_b32 v244, v244, v245
    v_or3_b32 v244, v244, v246, v247
    v_cmp_ne_u32 vcc, 0, v244
    s_nop 4
    s_cbranch_vccz L_got2
    s_add_u32 s101, s101, 1
    s_cmp_lt_u32 s101, 0x8000
    s_cbranch_scc1 L_poll2
L_got2:
    s_barrier
    s_mov_b32 s64, 0x0
    buffer_load_dwordx2 v[48:49], v250, s[44:47], s64 offen offset:0 sc1
    buffer_load_dwordx2 v[50:51], v250, s[44:47], s64 offen offset:64 sc1
    s_mov_b32 s64, 0x1400
    buffer_load_dwordx2 v[52:53], v250, s[44:47], s64 offen offset:0 sc1
    buffer_load_dwordx2 v[54:55], v250, s[44:47], s64 offen offset:64 sc1
    s_mov_b32 s64, 0x2800
    buffer_load_dwordx2 v[56:57], v250, s[44:47], s64 offen offset:0 sc1
    buffer_load_dwordx2 v[58:59], v250, s[44:47], s64 offen offset:64 sc1
    s_mov_b32 s64, 0x3c00
    buffer_load_dwordx2 v[60:61], v250, s[44:47], s64 offen offset:0 sc1
    buffer_load_dwordx2 v[62:63], v250, s[44:47], s64 offen offset:64 sc1
    s_add_u32 m0, s86, 0
    s_nop 0
    buffer_load_dwordx4 v26, s[52:55], s87 offen  lds
    s_add_u32 m0, s86, 1088
    s_nop 0
    buffer_load_dwordx4 v27, s[52:55], s87 offen  lds
    s_add_u32 m0, s86, 8704
    s_nop 0
    buffer_load_dwordx4 v26, s[56:59], s87 offen  lds
    s_add_u32 m0, s86, 9792
    s_nop 0
    buffer_load_dwordx4 v27, s[56:59], s87 offen  lds
    s_waitcnt vmcnt(10)
    v_lshlrev_b32 v96, 16, v48
    v_and_b32 v97, 0xffff0000, v48
    v_lshlrev_b32 v98, 16, v49
    v_and_b32 v99, 0xffff0000, v49
    v_lshlrev_b32 v100, 16, v50
    v_and_b32 v101, 0xffff0000, v50
    v_lshlrev_b32 v102, 16, v51
    v_and_b32 v103, 0xffff0000, v51
    v_pk_fma_f32 v[96:97], v[144:145], v[96:97], v[64:65]
    v_pk_fma_f32 v[98:99], v[146:147], v[98:99], v[66:67]
    v_pk_fma_f32 v[100:101], v[148:149], v[100:101], v[68:69]
    v_pk_fma_f32 v[102:103], v[150:151], v[102:103], v[70:71]
    v_cvt_pk_bf16_f32 v32, v96, v97
    v_cvt_pk_bf16_f32 v33, v98, v99
    v_cvt_pk_bf16_f32 v34, v100, v101
    v_cvt_pk_bf16_f32 v35, v102, v103
    v_lshlrev_b32 v64, 16, v32
    v_and_b32 v65, 0xffff0000, v32
    v_lshlrev_b32 v66, 16, v33
    v_and_b32 v67, 0xffff0000, v33
    v_lshlrev_b32 v68, 16, v34
    v_and_b32 v69, 0xffff0000, v34
    v_lshlrev_b32 v70, 16, v35
    v_and_b32 v71, 0xffff0000, v35
    s_waitcnt vmcnt(8)
    v_lshlrev_b32 v104, 16, v52
    v_and_b32 v105, 0xffff0000, v52
    v_lshlrev_b32 v106, 16, v53
    v_and_b32 v107, 0xffff0000, v53
    v_lshlrev_b32 v108, 16, v54
    v_and_b32 v109, 0xffff0000, v54
    v_lshlrev_b32 v110, 16, v55
    v_and_b32 v111, 0xffff0000, v55
    v_pk_fma_f32 v[104:105], v[152:153], v[104:105], v[72:73]
    v_pk_fma_f32 v[106:107], v[154:155], v[106:107], v[74:75]
    v_pk_fma_f32 v[108:109], v[156:157], v[108:109], v[76:77]
    v_pk_fma_f32 v[110:111], v[158:159], v[110:111], v[78:79]
    v_cvt_pk_bf16_f32 v36, v104, v105
    v_cvt_pk_bf16_f32 v37, v106, v107
    v_cvt_pk_bf16_f32 v38, v108, v109
    v_cvt_pk_bf16_f32 v39, v110, v111
    v_lshlrev_b32 v72, 16, v36
    v_and_b32 v73, 0xffff0000, v36
    v_lshlrev_b32 v74, 16, v37
    v_and_b32 v75, 0xffff0000, v37
    v_lshlrev_b32 v76, 16, v38
    v_and_b32 v77, 0xffff0000, v38
    v_lshlrev_b32 v78, 16, v39
    v_and_b32 v79, 0xffff0000, v39
    s_waitcnt vmcnt(6)
    v_lshlrev_b32 v112, 16, v56
    v_and_b32 v113, 0xffff0000, v56
    v_lshlrev_b32 v114, 16, v57
    v_and_b32 v115, 0xffff0000, v57
    v_lshlrev_b32 v116, 16, v58
    v_and_b32 v117, 0xffff0000, v58
    v_lshlrev_b32 v118, 16, v59
    v_and_b32 v119, 0xffff0000, v59
    v_pk_fma_f32 v[112:113], v[160:161], v[112:113], v[80:81]
    v_pk_fma_f32 v[114:115], v[162:163], v[114:115], v[82:83]
    v_pk_fma_f32 v[116:117], v[164:165], v[116:117], v[84:85]
    v_pk_fma_f32 v[118:119], v[166:167], v[118:119], v[86:87]
    v_cvt_pk_bf16_f32 v40, v112, v113
    v_cvt_pk_bf16_f32 v41, v114, v115
    v_cvt_pk_bf16_f32 v42, v116, v117
    v_cvt_pk_bf16_f32 v43, v118, v119
    v_lshlrev_b32 v80, 16, v40
    v_and_b32 v81, 0xffff0000, v40
    v_lshlrev_b32 v82, 16, v41
    v_and_b32 v83, 0xffff0000, v41
    v_lshlrev_b32 v84, 16, v42
    v_and_b32 v85, 0xffff0000, v42
    v_lshlrev_b32 v86, 16, v43
    v_and_b32 v87, 0xffff0000, v43
    s_waitcnt vmcnt(4)
    v_lshlrev_b32 v120, 16, v60
    v_and_b32 v121, 0xffff0000, v60
    v_lshlrev_b32 v122, 16, v61
    v_and_b32 v123, 0xffff0000, v61
    v_lshlrev_b32 v124, 16, v62
    v_and_b32 v125, 0xffff0000, v62
    v_lshlrev_b32 v126, 16, v63
    v_and_b32 v127, 0xffff0000, v63
    v_pk_fma_f32 v[120:121], v[168:169], v[120:121], v[88:89]
    v_pk_fma_f32 v[122:123], v[170:171], v[122:123], v[90:91]
    v_pk_fma_f32 v[124:125], v[172:173], v[124:125], v[92:93]
    v_pk_fma_f32 v[126:127], v[174:175], v[126:127], v[94:95]
    v_cvt_pk_bf16_f32 v44, v120, v121
    v_cvt_pk_bf16_f32 v45, v122, v123
    v_cvt_pk_bf16_f32 v46, v124, v125
    v_cvt_pk_bf16_f32 v47, v126, v127
    v_lshlrev_b32 v88, 16, v44
    v_and_b32 v89, 0xffff0000, v44
    v_lshlrev_b32 v90, 16, v45
    v_and_b32 v91, 0xffff0000, v45
    v_lshlrev_b32 v92, 16, v46
    v_and_b32 v93, 0xffff0000, v46
    v_lshlrev_b32 v94, 16, v47
    v_and_b32 v95, 0xffff0000, v47
    v_and_b32 v16, 7, v0
    v_lshlrev_b32 v16, 5, v16
    v_add_u32 v16, 139520, v16
    s_lshl_b32 s64, s5, 3
    v_add_u32 v17, s64, v16
    v_pk_add_f32 v[128:129], v[64:65], v[72:73]
    v_pk_mul_f32 v[136:137], v[64:65], v[64:65]
    v_pk_add_f32 v[130:131], v[66:67], v[74:75]
    v_pk_mul_f32 v[138:139], v[66:67], v[66:67]
    v_pk_add_f32 v[132:133], v[68:69], v[76:77]
    v_pk_mul_f32 v[140:141], v[68:69], v[68:69]
    v_pk_add_f32 v[134:135], v[70:71], v[78:79]
    v_pk_mul_f32 v[142:143], v[70:71], v[70:71]
    v_pk_fma_f32 v[136:137], v[72:73], v[72:73], v[136:137]
    v_pk_fma_f32 v[138:139], v[74:75], v[74:75], v[138:139]
    v_pk_fma_f32 v[140:141], v[76:77], v[76:77], v[140:141]
    v_pk_fma_f32 v[142:143], v[78:79], v[78:79], v[142:143]
    v_pk_add_f32 v[128:129], v[128:129], v[80:81]
    v_pk_fma_f32 v[136:137], v[80:81], v[80:81], v[136:137]
    v_pk_add_f32 v[130:131], v[130:131], v[82:83]
    v_pk_fma_f32 v[138:139], v[82:83], v[82:83], v[138:139]
    v_pk_add_f32 v[132:133], v[132:133], v[84:85]
    v_pk_fma_f32 v[140:141], v[84:85], v[84:85], v[140:141]
    v_pk_add_f32 v[134:135], v[134:135], v[86:87]
    v_pk_fma_f32 v[142:143], v[86:87], v[86:87], v[142:143]
    v_pk_add_f32 v[128:129], v[128:129], v[88:89]
    v_pk_fma_f32 v[136:137], v[88:89], v[88:89], v[136:137]
    v_pk_add_f32 v[130:131], v[130:131], v[90:91]
    v_pk_fma_f32 v[138:139], v[90:91], v[90:91], v[138:139]
    v_pk_add_f32 v[132:133], v[132:133], v[92:93]
    v_pk_fma_f32 v[140:141], v[92:93], v[92:93], v[140:141]
    v_pk_add_f32 v[134:135], v[134:135], v[94:95]
    v_pk_fma_f32 v[142:143], v[94:95], v[94:95], v[142:143]
    v_pk_add_f32 v[128:129], v[128:129], v[130:131]
    v_pk_add_f32 v[132:133], v[132:133], v[134:135]
    v_pk_add_f32 v[136:137], v[136:137], v[138:139]
    v_pk_add_f32 v[140:141], v[140:141], v[142:143]
    v_pk_add_f32 v[128:129], v[128:129], v[132:133]
    v_pk_add_f32 v[136:137], v[136:137], v[140:141]
    v_add_f32 v12, v128, v129
    v_add_f32 v13, v136, v137
    s_nop 0
    v_add_f32_dpp v12, v12, v12 row_ror:8 row_mask:0xf bank_mask:0xf
    v_add_f32_dpp v13, v13, v13 row_ror:8 row_mask:0xf bank_mask:0xf
    v_mov_b32 v14, v12
    v_mov_b32 v15, v13
    s_nop 0
    v_permlane16_swap_b32 v12, v14
    v_permlane16_swap_b32 v13, v15
    v_pk_add_f32 v[12:13], v[12:13], v[14:15]
    v_mov_b32 v14, v12
    v_mov_b32 v15, v13
    s_nop 0
    v_permlane32_swap_b32 v12, v14
    v_permlane32_swap_b32 v13, v15
    v_pk_add_f32 v[12:13], v[12:13], v[14:15]
    ds_write_b64 v17, v[12:13]
    s_waitcnt lgkmcnt(0)
    s_barrier
    ds_read_b128 v[128:131], v16
    ds_read_b128 v[132:135], v16 offset:16
    s_waitcnt lgkmcnt(0)
    v_pk_add_f32 v[128:129], v[128:129], v[130:131]
    v_pk_add_f32 v[132:133], v[132:133], v[134:135]
    v_pk_add_f32 v[12:13], v[128:129], v[132:133]
    v_mul_f32 v12, 0x3a800000, v12
    v_mul_f32 v13, 0x3a800000, v13
    v_fma_f32 v13, -v12, v12, v13
    v_max_f32 v13, 0, v13
    v_cvt_pk_bf16_f32 v12, v12, v13
    v_and_b32 v13, 0xffff0000, v12
    v_lshlrev_b32 v12, 16, v12
    v_add_f32 v13, 0x3727c5ac, v13
    v_cvt_pk_bf16_f32 v13, v13, v13
    v_lshlrev_b32 v13, 16, v13
    v_sqrt_f32 v13, v13
    s_nop 0
    v_cvt_pk_bf16_f32 v13, v13, v13
    v_lshlrev_b32 v13, 16, v13
    v_rcp_f32 v18, v13
    v_rcp_f32 v19, v13
    v_mul_f32_e64 v20, -v12, v18
    v_mul_f32_e64 v21, -v12, v18
    s_mov_b32 s64, 0xa00000
    v_pk_fma_f32 v[64:65], v[64:65], v[18:19], v[20:21]
    v_pk_fma_f32 v[66:67], v[66:67], v[18:19], v[20:21]
    v_pk_fma_f32 v[68:69], v[68:69], v[18:19], v[20:21]
    v_pk_fma_f32 v[70:71], v[70:71], v[18:19], v[20:21]
    v_cvt_pk_bf16_f32 v48, v64, v65
    v_cvt_pk_bf16_f32 v49, v66, v67
    v_cvt_pk_bf16_f32 v50, v68, v69
    v_cvt_pk_bf16_f32 v51, v70, v71
    buffer_store_dwordx4 v[48:51], v249, s[44:47], s64 offen sc1
    s_mov_b32 s64, 0xa0a000
    v_pk_fma_f32 v[72:73], v[72:73], v[18:19], v[20:21]
    v_pk_fma_f32 v[74:75], v[74:75], v[18:19], v[20:21]
    v_pk_fma_f32 v[76:77], v[76:77], v[18:19], v[20:21]
    v_pk_fma_f32 v[78:79], v[78:79], v[18:19], v[20:21]
    v_cvt_pk_bf16_f32 v52, v72, v73
    v_cvt_pk_bf16_f32 v53, v74, v75
    v_cvt_pk_bf16_f32 v54, v76, v77
    v_cvt_pk_bf16_f32 v55, v78, v79
    buffer_store_dwordx4 v[52:55], v249, s[44:47], s64 offen sc1
    s_mov_b32 s64, 0xa14000
    v_pk_fma_f32 v[80:81], v[80:81], v[18:19], v[20:21]
    v_pk_fma_f32 v[82:83], v[82:83], v[18:19], v[20:21]
    v_pk_fma_f32 v[84:85], v[84:85], v[18:19], v[20:21]
    v_pk_fma_f32 v[86:87], v[86:87], v[18:19], v[20:21]
    v_cvt_pk_bf16_f32 v56, v80, v81
    v_cvt_pk_bf16_f32 v57, v82, v83
    v_cvt_pk_bf16_f32 v58, v84, v85
    v_cvt_pk_bf16_f32 v59, v86, v87
    buffer_store_dwordx4 v[56:59], v249, s[44:47], s64 offen sc1
    s_mov_b32 s64, 0xa1e000
    v_pk_fma_f32 v[88:89], v[88:89], v[18:19], v[20:21]
    v_pk_fma_f32 v[90:91], v[90:91], v[18:19], v[20:21]
    v_pk_fma_f32 v[92:93], v[92:93], v[18:19], v[20:21]
    v_pk_fma_f32 v[94:95], v[94:95], v[18:19], v[20:21]
    v_cvt_pk_bf16_f32 v60, v88, v89
    v_cvt_pk_bf16_f32 v61, v90, v91
    v_cvt_pk_bf16_f32 v62, v92, v93
    v_cvt_pk_bf16_f32 v63, v94, v95
    buffer_store_dwordx4 v[60:63], v249, s[44:47], s64 offen sc1
    s_waitcnt vmcnt(0)
    s_barrier
    s_cmp_lg_u32 s5, 1
    s_cbranch_scc1 L_sig3
    s_lshl_b32 s100, s72, 13
    s_lshl_b32 s101, s71, 2
    s_add_u32 s100, s100, s101
    s_add_u32 s100, s100, 0x1730000
    v_lshlrev_b32 v29, 8, v1
    s_mov_b32 exec_lo, 0xffffffff
    s_mov_b32 exec_hi, 0
    buffer_store_dword v28, v29, s[44:47], s100 offen sc1
    s_mov_b64 exec, -1
    v_and_b32 v29, 31, v1
    v_lshlrev_b32 v29, 2, v29
L_sig3:
    s_add_u32 s87, s87, 229376
    s_add_u32 m0, s86, 17408
    s_nop 0
    buffer_load_dwordx4 v26, s[52:55], s87 offen  lds
    s_add_u32 m0, s86, 18496
    s_nop 0
    buffer_load_dwordx4 v27, s[52:55], s87 offen  lds
    s_add_u32 m0, s86, 26112
    s_nop 0
    buffer_load_dwordx4 v26, s[56:59], s87 offen  lds
    s_add_u32 m0, s86, 27200
    s_nop 0
    buffer_load_dwordx4 v27, s[56:59], s87 offen  lds
    s_add_u32 s87, s87, 229376
    s_add_u32 m0, s86, 34816
    s_nop 0
    buffer_load_dwordx4 v26, s[52:55], s87 offen  lds
    s_add_u32 m0, s86, 35904
    s_nop 0
    buffer_load_dwordx4 v27, s[52:55], s87 offen  lds
    s_add_u32 m0, s86, 43520
    s_nop 0
    buffer_load_dwordx4 v26, s[56:59], s87 offen  lds
    s_add_u32 m0, s86, 44608
    s_nop 0
    buffer_load_dwordx4 v27, s[56:59], s87 offen  lds
    s_add_u32 s87, s87, 229376
    s_add_u32 m0, s86, 52224
    s_nop 0
    buffer_load_dwordx4 v26, s[52:55], s87 offen  lds
    s_add_u32 m0, s86, 53312
    s_nop 0
    buffer_load_dwordx4 v27, s[52:55], s87 offen  lds
    s_add_u32 m0, s86, 60928
    s_nop 0
    buffer_load_dwordx4 v26, s[56:59], s87 offen  lds
    s_add_u32 m0, s86, 62016
    s_nop 0
    buffer_load_dwordx4 v27, s[56:59], s87 offen  lds
    v_accvgpr_write_b32 a240, v32
    v_accvgpr_write_b32 a241, v33
    v_accvgpr_write_b32 a242, v34
    v_accvgpr_write_b32 a243, v35
    v_accvgpr_write_b32 a244, v36
    v_accvgpr_write_b32 a245, v37
    v_accvgpr_write_b32 a246, v38
    v_accvgpr_write_b32 a247, v39
    v_accvgpr_write_b32 a248, v40
    v_accvgpr_write_b32 a249, v41
    v_accvgpr_write_b32 a250, v42
    v_accvgpr_write_b32 a251, v43
    v_accvgpr_write_b32 a252, v44
    v_accvgpr_write_b32 a253, v45
    v_accvgpr_write_b32 a254, v46
    v_accvgpr_write_b32 a255, v47
    v_mov_b32 v4, v249
    ds_read_b64_tr_b16 a[0:1], v5 offset:0
    ds_read_b64_tr_b16 a[2:3], v5 offset:1088
    ds_read_b64_tr_b16 a[4:5], v5 offset:8704
    ds_read_b64_tr_b16 a[6:7], v5 offset:9792
    ds_read_b64_tr_b16 a[8:9], v5 offset:32
    ds_read_b64_tr_b16 a[10:11], v5 offset:1120
    ds_read_b64_tr_b16 a[12:13], v5 offset:8736
    ds_read_b64_tr_b16 a[14:15], v5 offset:9824
    ds_read_b64_tr_b16 a[16:17], v5 offset:64
    ds_read_b64_tr_b16 a[18:19], v5 offset:1152
    ds_read_b64_tr_b16 a[20:21], v5 offset:8768
    ds_read_b64_tr_b16 a[22:23], v5 offset:9856
    ds_read_b64_tr_b16 a[24:25], v5 offset:96
    ds_read_b64_tr_b16 a[26:27], v5 offset:1184
    s_cmp_lg_u32 s5, 0
    s_cbranch_scc1 L_got3
    v_and_b32 v29, 31, v1
    v_lshlrev_b32 v29, 2, v29
    s_lshl_b32 s100, s72, 5
    s_add_u32 s100, s100, s71
    s_lshl_b32 s100, s100, 8
    s_add_u32 s100, s100, 0x1730000
    s_mov_b32 s101, 0
L_poll3:
    buffer_load_dword v30, v29, s[44:47], s100 offen sc1
    s_waitcnt vmcnt(0)
    v_cmp_ne_u32 vcc, s34, v30
    s_nop 4
    s_cbranch_vccz L_got3
    s_add_u32 s101, s101, 1
    s_cmp_lt_u32 s101, 0x8000
    s_cbranch_scc1 L_poll3
L_got3:
    s_barrier
    buffer_load_dwordx4 a[32:35], v8, s[44:47], s69 offen sc1
    buffer_load_dwordx4 a[36:39], v9, s[44:47], s69 offen sc1
    buffer_load_dwordx4 a[40:43], v10, s[44:47], s69 offen sc1
    buffer_load_dwordx4 a[44:47], v11, s[44:47], s69 offen sc1
    s_add_u32 s69, s69, 5120
    buffer_load_dwordx4 a[48:51], v8, s[44:47], s69 offen sc1
    buffer_load_dwordx4 a[52:55], v9, s[44:47], s69 offen sc1
    buffer_load_dwordx4 a[56:59], v10, s[44:47], s69 offen sc1
    buffer_load_dwordx4 a[60:63], v11, s[44:47], s69 offen sc1
L_align_from:
    s_waitcnt vmcnt(4) lgkmcnt(10)
    s_barrier
    v_mfma_f32_16x16x32_bf16 v[32:35], a[0:3], a[32:35], 0
    ds_read_b64_tr_b16 a[28:29], v5 offset:8800
    v_mfma_f32_16x16x32_bf16 v[36:39], a[0:3], a[36:39], 0
    ds_read_b64_tr_b16 a[30:31], v5 offset:9888
    v_mfma_f32_16x16x32_bf16 v[40:43], a[0:3], a[40:43], 0
    v_mfma_f32_16x16x32_bf16 v[44:47], a[0:3], a[44:47], 0
    v_mfma_f32_16x16x32_bf16 v[60:63], a[4:7], a[44:47], 0
    ds_read_b64_tr_b16 a[0:1], v5 offset:128
    v_mfma_f32_16x16x32_bf16 v[56:59], a[4:7], a[40:43], 0
    s_add_u32 s69, s69, 5120
    ds_read_b64_tr_b16 a[2:3], v5 offset:1216
    v_mfma_f32_16x16x32_bf16 v[52:55], a[4:7], a[36:39], 0
    buffer_load_dwordx4 a[64:67], v8, s[44:47], s69 offen sc1
    v_mfma_f32_16x16x32_bf16 v[48:51], a[4:7], a[32:35], 0
    s_waitcnt lgkmcnt(6)
    v_mfma_f32_16x16x32_bf16 v[64:67], a[8:11], a[32:35], 0
    ds_read_b64_tr_b16 a[4:5], v5 offset:8832
    v_mfma_f32_16x16x32_bf16 v[68:71], a[8:11], a[36:39], 0
    ds_read_b64_tr_b16 a[6:7], v5 offset:9920
    v_mfma_f32_16x16x32_bf16 v[72:75], a[8:11], a[40:43], 0
    buffer_load_dwordx4 a[68:71], v9, s[44:47], s69 offen sc1
    v_mfma_f32_16x16x32_bf16 v[76:79], a[8:11], a[44:47], 0
    v_mfma_f32_16x16x32_bf16 v[92:95], a[12:15], a[44:47], 0
    ds_read_b64_tr_b16 a[8:9], v5 offset:160
    v_mfma_f32_16x16x32_bf16 v[88:91], a[12:15], a[40:43], 0
    ds_read_b64_tr_b16 a[10:11], v5 offset:1248
    v_mfma_f32_16x16x32_bf16 v[84:87], a[12:15], a[36:39], 0
    buffer_load_dwordx4 a[72:75], v10, s[44:47], s69 offen sc1
    v_mfma_f32_16x16x32_bf16 v[80:83], a[12:15], a[32:35], 0
    v_mfma_f32_16x16x32_bf16 v[96:99], a[16:19], a[32:35], 0
    ds_read_b64_tr_b16 a[12:13], v5 offset:8864
    v_mfma_f32_16x16x32_bf16 v[100:103], a[16:19], a[36:39], 0
    ds_read_b64_tr_b16 a[14:15], v5 offset:9952
    v_mfma_f32_16x16x32_bf16 v[104:107], a[16:19], a[40:43], 0
    buffer_load_dwordx4 a[76:79], v11, s[44:47], s69 offen sc1
    v_mfma_f32_16x16x32_bf16 v[108:111], a[16:19], a[44:47], 0
    v_mfma_f32_16x16x32_bf16 v[124:127], a[20:23], a[44:47], 0
    ds_read_b64_tr_b16 a[16:17], v6 offset:0
    v_mfma_f32_16x16x32_bf16 v[120:123], a[20:23], a[40:43], 0
    s_add_u32 s69, s69, 5120
    ds_read_b64_tr_b16 a[18:19], v6 offset:1088
    v_mfma_f32_16x16x32_bf16 v[116:119], a[20:23], a[36:39], 0
    buffer_load_dwordx4 a[80:83], v8, s[44:47], s69 offen sc1
    v_mfma_f32_16x16x32_bf16 v[112:115], a[20:23], a[32:35], 0
    s_waitcnt lgkmcnt(6)
    v_mfma_f32_16x16x32_bf16 v[128:131], a[24:27], a[32:35], 0
    ds_read_b64_tr_b16 a[20:21], v6 offset:8704
    v_mfma_f32_16x16x32_bf16 v[132:135], a[24:27], a[36:39], 0
    ds_read_b64_tr_b16 a[22:23], v6 offset:9792
    v_mfma_f32_16x16x32_bf16 v[136:139], a[24:27], a[40:43], 0
    buffer_load_dwordx4 a[84:87], v9, s[44:47], s69 offen sc1
    v_mfma_f32_16x16x32_bf16 v[140:143], a[24:27], a[44:47], 0
    v_mfma_f32_16x16x32_bf16 v[156:159], a[28:31], a[44:47], 0
    ds_read_b64_tr_b16 a[24:25], v5 offset:17408
    v_mfma_f32_16x16x32_bf16 v[152:155], a[28:31], a[40:43], 0
    ds_read_b64_tr_b16 a[26:27], v5 offset:18496
    v_mfma_f32_16x16x32_bf16 v[148:151], a[28:31], a[36:39], 0
    buffer_load_dwordx4 a[88:91], v10, s[44:47], s69 offen sc1
    v_mfma_f32_16x16x32_bf16 v[144:147], a[28:31], a[32:35], 0
    v_mfma_f32_16x16x32_bf16 v[160:163], a[0:3], a[32:35], 0
    ds_read_b64_tr_b16 a[28:29], v5 offset:26112
    v_mfma_f32_16x16x32_bf16 v[164:167], a[0:3], a[36:39], 0
    ds_read_b64_tr_b16 a[30:31], v5 offset:27200
    v_mfma_f32_16x16x32_bf16 v[168:171], a[0:3], a[40:43], 0
    buffer_load_dwordx4 a[92:95], v11, s[44:47], s69 offen sc1
    v_mfma_f32_16x16x32_bf16 v[172:175], a[0:3], a[44:47], 0
    v_mfma_f32_16x16x32_bf16 v[188:191], a[4:7], a[44:47], 0
    s_add_u32 s87, s87, 229376
    ds_read_b64_tr_b16 a[0:1], v5 offset:17440
    v_mfma_f32_16x16x32_bf16 v[184:187], a[4:7], a[40:43], 0
    s_add_u32 m0, s86, 69632
    ds_read_b64_tr_b16 a[2:3], v5 offset:18528
    v_mfma_f32_16x16x32_bf16 v[180:183], a[4:7], a[36:39], 0
    buffer_load_dwordx4 v26, s[52:55], s87 offen  lds
    v_mfma_f32_16x16x32_bf16 v[176:179], a[4:7], a[32:35], 0
    s_waitcnt lgkmcnt(6)
    v_mfma_f32_16x16x32_bf16 v[192:195], a[8:11], a[32:35], 0
    ds_read_b64_tr_b16 a[4:5], v5 offset:26144
    v_mfma_f32_16x16x32_bf16 v[196:199], a[8:11], a[36:39], 0
    s_add_u32 m0, s86, 70720
    ds_read_b64_tr_b16 a[6:7], v5 offset:27232
    v_mfma_f32_16x16x32_bf16 v[200:203], a[8:11], a[40:43], 0
    buffer_load_dwordx4 v27, s[52:55], s87 offen  lds
    v_mfma_f32_16x16x32_bf16 v[204:207], a[8:11], a[44:47], 0
    v_mfma_f32_16x16x32_bf16 v[220:223], a[12:15], a[44:47], 0
    ds_read_b64_tr_b16 a[8:9], v5 offset:17472
    v_mfma_f32_16x16x32_bf16 v[216:219], a[12:15], a[40:43], 0
    s_add_u32 m0, s86, 78336
    ds_read_b64_tr_b16 a[10:11], v5 offset:18560
    v_mfma_f32_16x16x32_bf16 v[212:215], a[12:15], a[36:39], 0
    buffer_load_dwordx4 v26, s[56:59], s87 offen  lds
    v_mfma_f32_16x16x32_bf16 v[208:211], a[12:15], a[32:35], 0
    v_mfma_f32_16x16x32_bf16 v[224:227], a[16:19], a[32:35], 0
    ds_read_b64_tr_b16 a[12:13], v5 offset:26176
    v_mfma_f32_16x16x32_bf16 v[228:231], a[16:19], a[36:39], 0
    s_add_u32 m0, s86, 79424
    ds_read_b64_tr_b16 a[14:15], v5 offset:27264
    v_mfma_f32_16x16x32_bf16 v[232:235], a[16:19], a[40:43], 0
    buffer_load_dwordx4 v27, s[56:59], s87 offen  lds
    v_mfma_f32_16x16x32_bf16 v[236:239], a[16:19], a[44:47], 0
    v_mfma_f32_16x16x32_bf16 v[252:255], a[20:23], a[44:47], 0
    ds_read_b64_tr_b16 a[16:17], v5 offset:17504
    v_mfma_f32_16x16x32_bf16 v[248:251], a[20:23], a[40:43], 0
    s_cmp_eq_u32 s79, 0
    s_cselect_b32 s81, s78, 0x40000000
    ds_read_b64_tr_b16 a[18:19], v5 offset:18592
    v_mfma_f32_16x16x32_bf16 v[244:247], a[20:23], a[36:39], 0
    buffer_load_dword v7, v3, s[40:43], s81 offen
    v_mfma_f32_16x16x32_bf16 v[240:243], a[20:23], a[32:35], 0
    s_waitcnt vmcnt(13) lgkmcnt(10)
    v_mfma_f32_16x16x32_bf16 v[32:35], a[24:27], a[48:51], v[32:35]
    ds_read_b64_tr_b16 a[20:21], v5 offset:26208
    v_mfma_f32_16x16x32_bf16 v[36:39], a[24:27], a[52:55], v[36:39]
    ds_read_b64_tr_b16 a[22:23], v5 offset:27296
    v_mfma_f32_16x16x32_bf16 v[40:43], a[24:27], a[56:59], v[40:43]
    v_mfma_f32_16x16x32_bf16 v[44:47], a[24:27], a[60:63], v[44:47]
    v_mfma_f32_16x16x32_bf16 v[60:63], a[28:31], a[60:63], v[60:63]
    ds_read_b64_tr_b16 a[24:25], v5 offset:17536
    v_mfma_f32_16x16x32_bf16 v[56:59], a[28:31], a[56:59], v[56:59]
    s_add_u32 s69, s69, 5120
    ds_read_b64_tr_b16 a[26:27], v5 offset:18624
    v_mfma_f32_16x16x32_bf16 v[52:55], a[28:31], a[52:55], v[52:55]
    buffer_load_dwordx4 a[32:35], v8, s[44:47], s69 offen sc1
    v_mfma_f32_16x16x32_bf16 v[48:51], a[28:31], a[48:51], v[48:51]
    s_waitcnt lgkmcnt(6)
    v_mfma_f32_16x16x32_bf16 v[64:67], a[0:3], a[48:51], v[64:67]
    ds_read_b64_tr_b16 a[28:29], v5 offset:26240
    v_mfma_f32_16x16x32_bf16 v[68:71], a[0:3], a[52:55], v[68:71]
    ds_read_b64_tr_b16 a[30:31], v5 offset:27328
    v_mfma_f32_16x16x32_bf16 v[72:75], a[0:3], a[56:59], v[72:75]
    buffer_load_dwordx4 a[36:39], v9, s[44:47], s69 offen sc1
    v_mfma_f32_16x16x32_bf16 v[76:79], a[0:3], a[60:63], v[76:79]
    v_mfma_f32_16x16x32_bf16 v[92:95], a[4:7], a[60:63], v[92:95]
    ds_read_b64_tr_b16 a[0:1], v5 offset:17568
    v_mfma_f32_16x16x32_bf16 v[88:91], a[4:7], a[56:59], v[88:91]
    ds_read_b64_tr_b16 a[2:3], v5 offset:18656
    v_mfma_f32_16x16x32_bf16 v[84:87], a[4:7], a[52:55], v[84:87]
    buffer_load_dwordx4 a[40:43], v10, s[44:47], s69 offen sc1
    v_mfma_f32_16x16x32_bf16 v[80:83], a[4:7], a[48:51], v[80:83]
    v_mfma_f32_16x16x32_bf16 v[96:99], a[8:11], a[48:51], v[96:99]
    ds_read_b64_tr_b16 a[4:5], v5 offset:26272
    v_mfma_f32_16x16x32_bf16 v[100:103], a[8:11], a[52:55], v[100:103]
    ds_read_b64_tr_b16 a[6:7], v5 offset:27360
    v_mfma_f32_16x16x32_bf16 v[104:107], a[8:11], a[56:59], v[104:107]
    buffer_load_dwordx4 a[44:47], v11, s[44:47], s69 offen sc1
    v_mfma_f32_16x16x32_bf16 v[108:111], a[8:11], a[60:63], v[108:111]
    v_mfma_f32_16x16x32_bf16 v[124:127], a[12:15], a[60:63], v[124:127]
    s_add_u32 s87, s87, 229376
    ds_read_b64_tr_b16 a[8:9], v6 offset:17408
    v_mfma_f32_16x16x32_bf16 v[120:123], a[12:15], a[56:59], v[120:123]
    s_add_u32 m0, s86, 87040
    ds_read_b64_tr_b16 a[10:11], v6 offset:18496
    v_mfma_f32_16x16x32_bf16 v[116:119], a[12:15], a[52:55], v[116:119]
    buffer_load_dwordx4 v26, s[52:55], s87 offen  lds
    v_mfma_f32_16x16x32_bf16 v[112:115], a[12:15], a[48:51], v[112:115]
    s_waitcnt lgkmcnt(6)
    v_mfma_f32_16x16x32_bf16 v[128:131], a[16:19], a[48:51], v[128:131]
    ds_read_b64_tr_b16 a[12:13], v6 offset:26112
    v_mfma_f32_16x16x32_bf16 v[132:135], a[16:19], a[52:55], v[132:135]
    s_add_u32 m0, s86, 88128
    ds_read_b64_tr_b16 a[14:15], v6 offset:27200
    v_mfma_f32_16x16x32_bf16 v[136:139], a[16:19], a[56:59], v[136:139]
    buffer_load_dwordx4 v27, s[52:55], s87 offen  lds
    v_mfma_f32_16x16x32_bf16 v[140:143], a[16:19], a[60:63], v[140:143]
    v_mfma_f32_16x16x32_bf16 v[156:159], a[20:23], a[60:63], v[156:159]
    ds_read_b64_tr_b16 a[16:17], v5 offset:34816
    v_mfma_f32_16x16x32_bf16 v[152:155], a[20:23], a[56:59], v[152:155]
    s_add_u32 m0, s86, 95744
    ds_read_b64_tr_b16 a[18:19], v5 offset:35904
    v_mfma_f32_16x16x32_bf16 v[148:151], a[20:23], a[52:55], v[148:151]
    buffer_load_dwordx4 v26, s[56:59], s87 offen  lds
    v_mfma_f32_16x16x32_bf16 v[144:147], a[20:23], a[48:51], v[144:147]
    v_mfma_f32_16x16x32_bf16 v[160:163], a[24:27], a[48:51], v[160:163]
    ds_read_b64_tr_b16 a[20:21], v5 offset:43520
    v_mfma_f32_16x16x32_bf16 v[164:167], a[24:27], a[52:55], v[164:167]
    s_add_u32 m0, s86, 96832
    ds_read_b64_tr_b16 a[22:23], v5 offset:44608
    v_mfma_f32_16x16x32_bf16 v[168:171], a[24:27], a[56:59], v[168:171]
    buffer_load_dwordx4 v27, s[56:59], s87 offen  lds
    v_mfma_f32_16x16x32_bf16 v[172:175], a[24:27], a[60:63], v[172:175]
    v_mfma_f32_16x16x32_bf16 v[188:191], a[28:31], a[60:63], v[188:191]
    s_add_u32 s87, s87, 229376
    ds_read_b64_tr_b16 a[24:25], v5 offset:34848
    v_mfma_f32_16x16x32_bf16 v[184:187], a[28:31], a[56:59], v[184:187]
    s_add_u32 m0, s86, 104448
    ds_read_b64_tr_b16 a[26:27], v5 offset:35936
    v_mfma_f32_16x16x32_bf16 v[180:183], a[28:31], a[52:55], v[180:183]
    buffer_load_dwordx4 v26, s[52:55], s87 offen  lds
    v_mfma_f32_16x16x32_bf16 v[176:179], a[28:31], a[48:51], v[176:179]
    s_waitcnt lgkmcnt(6)
    v_mfma_f32_16x16x32_bf16 v[192:195], a[0:3], a[48:51], v[192:195]
    ds_read_b64_tr_b16 a[28:29], v5 offset:43552
    v_mfma_f32_16x16x32_bf16 v[196:199], a[0:3], a[52:55], v[196:199]
    s_add_u32 m0, s86, 105536
    ds_read_b64_tr_b16 a[30:31], v5 offset:44640
    v_mfma_f32_16x16x32_bf16 v[200:203], a[0:3], a[56:59], v[200:203]
    buffer_load_dwordx4 v27, s[52:55], s87 offen  lds
    v_mfma_f32_16x16x32_bf16 v[204:207], a[0:3], a[60:63], v[204:207]
    v_mfma_f32_16x16x32_bf16 v[220:223], a[4:7], a[60:63], v[220:223]
    ds_read_b64_tr_b16 a[0:1], v5 offset:34880
    v_mfma_f32_16x16x32_bf16 v[216:219], a[4:7], a[56:59], v[216:219]
    s_add_u32 m0, s86, 113152
    ds_read_b64_tr_b16 a[2:3], v5 offset:35968
    v_mfma_f32_16x16x32_bf16 v[212:215], a[4:7], a[52:55], v[212:215]
    buffer_load_dwordx4 v26, s[56:59], s87 offen  lds
    v_mfma_f32_16x16x32_bf16 v[208:211], a[4:7], a[48:51], v[208:211]
    v_mfma_f32_16x16x32_bf16 v[224:227], a[8:11], a[48:51], v[224:227]
    ds_read_b64_tr_b16 a[4:5], v5 offset:43584
    v_mfma_f32_16x16x32_bf16 v[228:231], a[8:11], a[52:55], v[228:231]
    s_add_u32 m0, s86, 114240
    ds_read_b64_tr_b16 a[6:7], v5 offset:44672
    v_mfma_f32_16x16x32_bf16 v[232:235], a[8:11], a[56:59], v[232:235]
    buffer_load_dwordx4 v27, s[56:59], s87 offen  lds
    v_mfma_f32_16x16x32_bf16 v[236:239], a[8:11], a[60:63], v[236:239]
    v_mfma_f32_16x16x32_bf16 v[252:255], a[12:15], a[60:63], v[252:255]
    ds_read_b64_tr_b16 a[8:9], v5 offset:34912
    v_mfma_f32_16x16x32_bf16 v[248:251], a[12:15], a[56:59], v[248:251]
    ds_read_b64_tr_b16 a[10:11], v5 offset:36000
    v_mfma_f32_16x16x32_bf16 v[244:247], a[12:15], a[52:55], v[244:247]
    v_mfma_f32_16x16x32_bf16 v[240:243], a[12:15], a[48:51], v[240:243]
    s_waitcnt vmcnt(13) lgkmcnt(10)
    s_barrier
    v_mfma_f32_16x16x32_bf16 v[32:35], a[16:19], a[64:67], v[32:35]
    ds_read_b64_tr_b16 a[12:13], v5 offset:43616
    v_mfma_f32_16x16x32_bf16 v[36:39], a[16:19], a[68:71], v[36:39]
    ds_read_b64_tr_b16 a[14:15], v5 offset:44704
    v_mfma_f32_16x16x32_bf16 v[40:43], a[16:19], a[72:75], v[40:43]
    v_mfma_f32_16x16x32_bf16 v[44:47], a[16:19], a[76:79], v[44:47]
    v_mfma_f32_16x16x32_bf16 v[60:63], a[20:23], a[76:79], v[60:63]
    ds_read_b64_tr_b16 a[16:17], v5 offset:34944
    v_mfma_f32_16x16x32_bf16 v[56:59], a[20:23], a[72:75], v[56:59]
    s_add_u32 s69, s69, 5120
    ds_read_b64_tr_b16 a[18:19], v5 offset:36032
    v_mfma_f32_16x16x32_bf16 v[52:55], a[20:23], a[68:71], v[52:55]
    buffer_load_dwordx4 a[48:51], v8, s[44:47], s69 offen sc1
    v_mfma_f32_16x16x32_bf16 v[48:51], a[20:23], a[64:67], v[48:51]
    s_waitcnt lgkmcnt(6)
    v_mfma_f32_16x16x32_bf16 v[64:67], a[24:27], a[64:67], v[64:67]
    ds_read_b64_tr_b16 a[20:21], v5 offset:43648
    v_mfma_f32_16x16x32_bf16 v[68:71], a[24:27], a[68:71], v[68:71]
    ds_read_b64_tr_b16 a[22:23], v5 offset:44736
    v_mfma_f32_16x16x32_bf16 v[72:75], a[24:27], a[72:75], v[72:75]
    buffer_load_dwordx4 a[52:55], v9, s[44:47], s69 offen sc1
    v_mfma_f32_16x16x32_bf16 v[76:79], a[24:27], a[76:79], v[76:79]
    v_mfma_f32_16x16x32_bf16 v[92:95], a[28:31], a[76:79], v[92:95]
    ds_read_b64_tr_b16 a[24:25], v5 offset:34976
    v_mfma_f32_16x16x32_bf16 v[88:91], a[28:31], a[72:75], v[88:91]
    ds_read_b64_tr_b16 a[26:27], v5 offset:36064
    v_mfma_f32_16x16x32_bf16 v[84:87], a[28:31], a[68:71], v[84:87]
    buffer_load_dwordx4 a[56:59], v10, s[44:47], s69 offen sc1
    v_mfma_f32_16x16x32_bf16 v[80:83], a[28:31], a[64:67], v[80:83]
    v_mfma_f32_16x16x32_bf16 v[96:99], a[0:3], a[64:67], v[96:99]
    ds_read_b64_tr_b16 a[28:29], v5 offset:43680
    v_mfma_f32_16x16x32_bf16 v[100:103], a[0:3], a[68:71], v[100:103]
    ds_read_b64_tr_b16 a[30:31], v5 offset:44768
    v_mfma_f32_16x16x32_bf16 v[104:107], a[0:3], a[72:75], v[104:107]
    buffer_load_dwordx4 a[60:63], v11, s[44:47], s69 offen sc1
    v_mfma_f32_16x16x32_bf16 v[108:111], a[0:3], a[76:79], v[108:111]
    v_mfma_f32_16x16x32_bf16 v[124:127], a[4:7], a[76:79], v[124:127]
    s_add_u32 s87, s87, 229376
    ds_read_b64_tr_b16 a[0:1], v6 offset:34816
    v_mfma_f32_16x16x32_bf16 v[120:123], a[4:7], a[72:75], v[120:123]
    s_add_u32 m0, s86, 121856
    ds_read_b64_tr_b16 a[2:3], v6 offset:35904
    v_mfma_f32_16x16x32_bf16 v[116:119], a[4:7], a[68:71], v[116:119]
    buffer_load_dwordx4 v26, s[52:55], s87 offen  lds
    v_mfma_f32_16x16x32_bf16 v[112:115], a[4:7], a[64:67], v[112:115]
    s_waitcnt lgkmcnt(6)
    v_mfma_f32_16x16x32_bf16 v[128:131], a[8:11], a[64:67], v[128:131]
    ds_read_b64_tr_b16 a[4:5], v6 offset:43520
    v_mfma_f32_16x16x32_bf16 v[132:135], a[8:11], a[68:71], v[132:135]
    s_add_u32 m0, s86, 122944
    ds_read_b64_tr_b16 a[6:7], v6 offset:44608
    v_mfma_f32_16x16x32_bf16 v[136:139], a[8:11], a[72:75], v[136:139]
    buffer_load_dwordx4 v27, s[52:55], s87 offen  lds
    v_mfma_f32_16x16x32_bf16 v[140:143], a[8:11], a[76:79], v[140:143]
    v_mfma_f32_16x16x32_bf16 v[156:159], a[12:15], a[76:79], v[156:159]
    ds_read_b64_tr_b16 a[8:9], v5 offset:52224
    v_mfma_f32_16x16x32_bf16 v[152:155], a[12:15], a[72:75], v[152:155]
    s_add_u32 m0, s86, 130560
    ds_read_b64_tr_b16 a[10:11], v5 offset:53312
    v_mfma_f32_16x16x32_bf16 v[148:151], a[12:15], a[68:71], v[148:151]
    buffer_load_dwordx4 v26, s[56:59], s87 offen  lds
    v_mfma_f32_16x16x32_bf16 v[144:147], a[12:15], a[64:67], v[144:147]
    v_mfma_f32_16x16x32_bf16 v[160:163], a[16:19], a[64:67], v[160:163]
    ds_read_b64_tr_b16 a[12:13], v5 offset:60928
    v_mfma_f32_16x16x32_bf16 v[164:167], a[16:19], a[68:71], v[164:167]
    s_add_u32 m0, s86, 131648
    ds_read_b64_tr_b16 a[14:15], v5 offset:62016
    v_mfma_f32_16x16x32_bf16 v[168:171], a[16:19], a[72:75], v[168:171]
    buffer_load_dwordx4 v27, s[56:59], s87 offen  lds
    v_mfma_f32_16x16x32_bf16 v[172:175], a[16:19], a[76:79], v[172:175]
    v_mfma_f32_16x16x32_bf16 v[188:191], a[20:23], a[76:79], v[188:191]
    s_add_u32 s87, s87, 229376
    ds_read_b64_tr_b16 a[16:17], v5 offset:52256
    v_mfma_f32_16x16x32_bf16 v[184:187], a[20:23], a[72:75], v[184:187]
    s_add_u32 m0, s86, 0
    ds_read_b64_tr_b16 a[18:19], v5 offset:53344
    v_mfma_f32_16x16x32_bf16 v[180:183], a[20:23], a[68:71], v[180:183]
    buffer_load_dwordx4 v26, s[52:55], s87 offen  lds
    v_mfma_f32_16x16x32_bf16 v[176:179], a[20:23], a[64:67], v[176:179]
    s_waitcnt lgkmcnt(6)
    v_mfma_f32_16x16x32_bf16 v[192:195], a[24:27], a[64:67], v[192:195]
    ds_read_b64_tr_b16 a[20:21], v5 offset:60960
    v_mfma_f32_16x16x32_bf16 v[196:199], a[24:27], a[68:71], v[196:199]
    s_add_u32 m0, s86, 1088
    ds_read_b64_tr_b16 a[22:23], v5 offset:62048
    v_mfma_f32_16x16x32_bf16 v[200:203], a[24:27], a[72:75], v[200:203]
    buffer_load_dwordx4 v27, s[52:55], s87 offen  lds
    v_mfma_f32_16x16x32_bf16 v[204:207], a[24:27], a[76:79], v[204:207]
    v_mfma_f32_16x16x32_bf16 v[220:223], a[28:31], a[76:79], v[220:223]
    ds_read_b64_tr_b16 a[24:25], v5 offset:52288
    v_mfma_f32_16x16x32_bf16 v[216:219], a[28:31], a[72:75], v[216:219]
    s_add_u32 m0, s86, 8704
    ds_read_b64_tr_b16 a[26:27], v5 offset:53376
    v_mfma_f32_16x16x32_bf16 v[212:215], a[28:31], a[68:71], v[212:215]
    buffer_load_dwordx4 v26, s[56:59], s87 offen  lds
    v_mfma_f32_16x16x32_bf16 v[208:211], a[28:31], a[64:67], v[208:211]
    v_mfma_f32_16x16x32_bf16 v[224:227], a[0:3], a[64:67], v[224:227]
    ds_read_b64_tr_b16 a[28:29], v5 offset:60992
    v_mfma_f32_16x16x32_bf16 v[228:231], a[0:3], a[68:71], v[228:231]
    s_add_u32 m0, s86, 9792
    ds_read_b64_tr_b16 a[30:31], v5 offset:62080
    v_mfma_f32_16x16x32_bf16 v[232:235], a[0:3], a[72:75], v[232:235]
    buffer_load_dwordx4 v27, s[56:59], s87 offen  lds
    v_mfma_f32_16x16x32_bf16 v[236:239], a[0:3], a[76:79], v[236:239]
    v_mfma_f32_16x16x32_bf16 v[252:255], a[4:7], a[76:79], v[252:255]
    ds_read_b64_tr_b16 a[0:1], v5 offset:52320
    v_mfma_f32_16x16x32_bf16 v[248:251], a[4:7], a[72:75], v[248:251]
    s_cmp_eq_u32 s79, 2
    s_cselect_b32 s81, s78, 0x40000000
    ds_read_b64_tr_b16 a[2:3], v5 offset:53408
    v_mfma_f32_16x16x32_bf16 v[244:247], a[4:7], a[68:71], v[244:247]
    buffer_load_dword v7, v3, s[40:43], s81 offen
    v_mfma_f32_16x16x32_bf16 v[240:243], a[4:7], a[64:67], v[240:243]
    s_waitcnt vmcnt(30) lgkmcnt(10)
    v_mfma_f32_16x16x32_bf16 v[32:35], a[8:11], a[80:83], v[32:35]
    ds_read_b64_tr_b16 a[4:5], v5 offset:61024
    v_mfma_f32_16x16x32_bf16 v[36:39], a[8:11], a[84:87], v[36:39]
    ds_read_b64_tr_b16 a[6:7], v5 offset:62112
    v_mfma_f32_16x16x32_bf16 v[40:43], a[8:11], a[88:91], v[40:43]
    v_mfma_f32_16x16x32_bf16 v[44:47], a[8:11], a[92:95], v[44:47]
    v_mfma_f32_16x16x32_bf16 v[60:63], a[12:15], a[92:95], v[60:63]
    ds_read_b64_tr_b16 a[8:9], v5 offset:52352
    v_mfma_f32_16x16x32_bf16 v[56:59], a[12:15], a[88:91], v[56:59]
    s_add_u32 s69, s69, 5120
    ds_read_b64_tr_b16 a[10:11], v5 offset:53440
    v_mfma_f32_16x16x32_bf16 v[52:55], a[12:15], a[84:87], v[52:55]
    buffer_load_dwordx4 a[64:67], v8, s[44:47], s69 offen sc1
    v_mfma_f32_16x16x32_bf16 v[48:51], a[12:15], a[80:83], v[48:51]
    s_waitcnt lgkmcnt(6)
    v_mfma_f32_16x16x32_bf16 v[64:67], a[16:19], a[80:83], v[64:67]
    s_add_u32 s87, s87, 229376
    ds_read_b64_tr_b16 a[12:13], v5 offset:61056
    v_mfma_f32_16x16x32_bf16 v[68:71], a[16:19], a[84:87], v[68:71]
    s_add_u32 m0, s86, 17408
    ds_read_b64_tr_b16 a[14:15], v5 offset:62144
    v_mfma_f32_16x16x32_bf16 v[72:75], a[16:19], a[88:91], v[72:75]
    buffer_load_dwordx4 v26, s[52:55], s87 offen  lds
    v_mfma_f32_16x16x32_bf16 v[76:79], a[16:19], a[92:95], v[76:79]
    v_mfma_f32_16x16x32_bf16 v[92:95], a[20:23], a[92:95], v[92:95]
    ds_read_b64_tr_b16 a[16:17], v5 offset:52384
    v_mfma_f32_16x16x32_bf16 v[88:91], a[20:23], a[88:91], v[88:91]
    ds_read_b64_tr_b16 a[18:19], v5 offset:53472
    v_mfma_f32_16x16x32_bf16 v[84:87], a[20:23], a[84:87], v[84:87]
    buffer_load_dwordx4 a[68:71], v9, s[44:47], s69 offen sc1
    v_mfma_f32_16x16x32_bf16 v[80:83], a[20:23], a[80:83], v[80:83]
    v_mfma_f32_16x16x32_bf16 v[96:99], a[24:27], a[80:83], v[96:99]
    ds_read_b64_tr_b16 a[20:21], v5 offset:61088
    v_mfma_f32_16x16x32_bf16 v[100:103], a[24:27], a[84:87], v[100:103]
    ds_read_b64_tr_b16 a[22:23], v5 offset:62176
    v_mfma_f32_16x16x32_bf16 v[104:107], a[24:27], a[88:91], v[104:107]
    v_mfma_f32_16x16x32_bf16 v[108:111], a[24:27], a[92:95], v[108:111]
    v_mfma_f32_16x16x32_bf16 v[124:127], a[28:31], a[92:95], v[124:127]
    ds_read_b64_tr_b16 a[24:25], v6 offset:52224
    v_mfma_f32_16x16x32_bf16 v[120:123], a[28:31], a[88:91], v[120:123]
    s_add_u32 m0, s86, 18496
    ds_read_b64_tr_b16 a[26:27], v6 offset:53312
    v_mfma_f32_16x16x32_bf16 v[116:119], a[28:31], a[84:87], v[116:119]
    buffer_load_dwordx4 v27, s[52:55], s87 offen  lds
    v_mfma_f32_16x16x32_bf16 v[112:115], a[28:31], a[80:83], v[112:115]
    s_waitcnt lgkmcnt(6)
    v_mfma_f32_16x16x32_bf16 v[128:131], a[0:3], a[80:83], v[128:131]
    ds_read_b64_tr_b16 a[28:29], v6 offset:60928
    v_mfma_f32_16x16x32_bf16 v[132:135], a[0:3], a[84:87], v[132:135]
    ds_read_b64_tr_b16 a[30:31], v6 offset:62016
    v_mfma_f32_16x16x32_bf16 v[136:139], a[0:3], a[88:91], v[136:139]
    buffer_load_dwordx4 a[72:75], v10, s[44:47], s69 offen sc1
    v_mfma_f32_16x16x32_bf16 v[140:143], a[0:3], a[92:95], v[140:143]
    v_mfma_f32_16x16x32_bf16 v[156:159], a[4:7], a[92:95], v[156:159]
    v_add_u32 v5, 0x11000, v5
    ds_read_b64_tr_b16 a[0:1], v5 offset:0
    v_mfma_f32_16x16x32_bf16 v[152:155], a[4:7], a[88:91], v[152:155]
    ds_read_b64_tr_b16 a[2:3], v5 offset:1088
    v_mfma_f32_16x16x32_bf16 v[148:151], a[4:7], a[84:87], v[148:151]
    v_mfma_f32_16x16x32_bf16 v[144:147], a[4:7], a[80:83], v[144:147]
    v_mfma_f32_16x16x32_bf16 v[160:163], a[8:11], a[80:83], v[160:163]
    ds_read_b64_tr_b16 a[4:5], v5 offset:8704
    v_mfma_f32_16x16x32_bf16 v[164:167], a[8:11], a[84:87], v[164:167]
    s_add_u32 m0, s86, 26112
    ds_read_b64_tr_b16 a[6:7], v5 offset:9792
    v_mfma_f32_16x16x32_bf16 v[168:171], a[8:11], a[88:91], v[168:171]
    buffer_load_dwordx4 v26, s[56:59], s87 offen  lds
    v_mfma_f32_16x16x32_bf16 v[172:175], a[8:11], a[92:95], v[172:175]
    v_mfma_f32_16x16x32_bf16 v[188:191], a[12:15], a[92:95], v[188:191]
    ds_read_b64_tr_b16 a[8:9], v5 offset:32
    v_mfma_f32_16x16x32_bf16 v[184:187], a[12:15], a[88:91], v[184:187]
    ds_read_b64_tr_b16 a[10:11], v5 offset:1120
    v_mfma_f32_16x16x32_bf16 v[180:183], a[12:15], a[84:87], v[180:183]
    buffer_load_dwordx4 a[76:79], v11, s[44:47], s69 offen sc1
    v_mfma_f32_16x16x32_bf16 v[176:179], a[12:15], a[80:83], v[176:179]
    s_waitcnt lgkmcnt(6)
    v_mfma_f32_16x16x32_bf16 v[192:195], a[16:19], a[80:83], v[192:195]
    ds_read_b64_tr_b16 a[12:13], v5 offset:8736
    v_mfma_f32_16x16x32_bf16 v[196:199], a[16:19], a[84:87], v[196:199]
    ds_read_b64_tr_b16 a[14:15], v5 offset:9824
    v_mfma_f32_16x16x32_bf16 v[200:203], a[16:19], a[88:91], v[200:203]
    v_mfma_f32_16x16x32_bf16 v[204:207], a[16:19], a[92:95], v[204:207]
    v_mfma_f32_16x16x32_bf16 v[220:223], a[20:23], a[92:95], v[220:223]
    ds_read_b64_tr_b16 a[16:17], v5 offset:64
    v_mfma_f32_16x16x32_bf16 v[216:219], a[20:23], a[88:91], v[216:219]
    s_add_u32 m0, s86, 27200
    ds_read_b64_tr_b16 a[18:19], v5 offset:1152
    v_mfma_f32_16x16x32_bf16 v[212:215], a[20:23], a[84:87], v[212:215]
    buffer_load_dwordx4 v27, s[56:59], s87 offen  lds
    v_mfma_f32_16x16x32_bf16 v[208:211], a[20:23], a[80:83], v[208:211]
    v_mfma_f32_16x16x32_bf16 v[224:227], a[24:27], a[80:83], v[224:227]
    ds_read_b64_tr_b16 a[20:21], v5 offset:8768
    v_mfma_f32_16x16x32_bf16 v[228:231], a[24:27], a[84:87], v[228:231]
    s_cmp_eq_u32 s82, 3
    s_cselect_b32 s81, s80, 0x40000000
    ds_read_b64_tr_b16 a[22:23], v5 offset:9856
    v_mfma_f32_16x16x32_bf16 v[232:235], a[24:27], a[88:91], v[232:235]
    buffer_load_dword v7, v3, s[48:51], s81 offen
    v_mfma_f32_16x16x32_bf16 v[236:239], a[24:27], a[92:95], v[236:239]
    v_mfma_f32_16x16x32_bf16 v[252:255], a[28:31], a[92:95], v[252:255]
    ds_read_b64_tr_b16 a[24:25], v5 offset:96
    v_mfma_f32_16x16x32_bf16 v[248:251], a[28:31], a[88:91], v[248:251]
    ds_read_b64_tr_b16 a[26:27], v5 offset:1184
    v_mfma_f32_16x16x32_bf16 v[244:247], a[28:31], a[84:87], v[244:247]
    v_mfma_f32_16x16x32_bf16 v[240:243], a[28:31], a[80:83], v[240:243]
    s_add_u32 s65, s86, 0
    s_add_u32 s67, s86, 69632
    s_mov_b32 s70, 0x11000
    s_mov_b32 s66, 4
L_g1_loop:
    s_waitcnt vmcnt(20) lgkmcnt(10)
    s_barrier
    v_mfma_f32_16x16x32_bf16 v[32:35], a[0:3], a[32:35], v[32:35]
    ds_read_b64_tr_b16 a[28:29], v5 offset:8800
    v_mfma_f32_16x16x32_bf16 v[36:39], a[0:3], a[36:39], v[36:39]
    ds_read_b64_tr_b16 a[30:31], v5 offset:9888
    v_mfma_f32_16x16x32_bf16 v[40:43], a[0:3], a[40:43], v[40:43]
    v_mfma_f32_16x16x32_bf16 v[44:47], a[0:3], a[44:47], v[44:47]
    v_mfma_f32_16x16x32_bf16 v[60:63], a[4:7], a[44:47], v[60:63]
    ds_read_b64_tr_b16 a[0:1], v5 offset:128
    v_mfma_f32_16x16x32_bf16 v[56:59], a[4:7], a[40:43], v[56:59]
    s_add_u32 s69, s69, 5120
    ds_read_b64_tr_b16 a[2:3], v5 offset:1216
    v_mfma_f32_16x16x32_bf16 v[52:55], a[4:7], a[36:39], v[52:55]
    buffer_load_dwordx4 a[80:83], v8, s[44:47], s69 offen sc1
    v_mfma_f32_16x16x32_bf16 v[48:51], a[4:7], a[32:35], v[48:51]
    s_waitcnt lgkmcnt(6)
    v_mfma_f32_16x16x32_bf16 v[64:67], a[8:11], a[32:35], v[64:67]
    s_add_u32 s87, s87, 229376
    ds_read_b64_tr_b16 a[4:5], v5 offset:8832
    v_mfma_f32_16x16x32_bf16 v[68:71], a[8:11], a[36:39], v[68:71]
    s_add_u32 m0, s65, 34816
    ds_read_b64_tr_b16 a[6:7], v5 offset:9920
    v_mfma_f32_16x16x32_bf16 v[72:75], a[8:11], a[40:43], v[72:75]
    buffer_load_dwordx4 v26, s[52:55], s87 offen  lds
    v_mfma_f32_16x16x32_bf16 v[76:79], a[8:11], a[44:47], v[76:79]
    v_mfma_f32_16x16x32_bf16 v[92:95], a[12:15], a[44:47], v[92:95]
    ds_read_b64_tr_b16 a[8:9], v5 offset:160
    v_mfma_f32_16x16x32_bf16 v[88:91], a[12:15], a[40:43], v[88:91]
    ds_read_b64_tr_b16 a[10:11], v5 offset:1248
    v_mfma_f32_16x16x32_bf16 v[84:87], a[12:15], a[36:39], v[84:87]
    buffer_load_dwordx4 a[84:87], v9, s[44:47], s69 offen sc1
    v_mfma_f32_16x16x32_bf16 v[80:83], a[12:15], a[32:35], v[80:83]
    v_mfma_f32_16x16x32_bf16 v[96:99], a[16:19], a[32:35], v[96:99]
    ds_read_b64_tr_b16 a[12:13], v5 offset:8864
    v_mfma_f32_16x16x32_bf16 v[100:103], a[16:19], a[36:39], v[100:103]
    ds_read_b64_tr_b16 a[14:15], v5 offset:9952
    v_mfma_f32_16x16x32_bf16 v[104:107], a[16:19], a[40:43], v[104:107]
    v_mfma_f32_16x16x32_bf16 v[108:111], a[16:19], a[44:47], v[108:111]
    v_mfma_f32_16x16x32_bf16 v[124:127], a[20:23], a[44:47], v[124:127]
    v_add_u32 v6, s70, v6
    s_sub_u32 s70, 0, s70
    ds_read_b64_tr_b16 a[16:17], v6 offset:0
    v_mfma_f32_16x16x32_bf16 v[120:123], a[20:23], a[40:43], v[120:123]
    s_add_u32 m0, s65, 35904
    ds_read_b64_tr_b16 a[18:19], v6 offset:1088
    v_mfma_f32_16x16x32_bf16 v[116:119], a[20:23], a[36:39], v[116:119]
    buffer_load_dwordx4 v27, s[52:55], s87 offen  lds
    v_mfma_f32_16x16x32_bf16 v[112:115], a[20:23], a[32:35], v[112:115]
    s_waitcnt lgkmcnt(6)
    v_mfma_f32_16x16x32_bf16 v[128:131], a[24:27], a[32:35], v[128:131]
    ds_read_b64_tr_b16 a[20:21], v6 offset:8704
    v_mfma_f32_16x16x32_bf16 v[132:135], a[24:27], a[36:39], v[132:135]
    ds_read_b64_tr_b16 a[22:23], v6 offset:9792
    v_mfma_f32_16x16x32_bf16 v[136:139], a[24:27], a[40:43], v[136:139]
    buffer_load_dwordx4 a[88:91], v10, s[44:47], s69 offen sc1
    v_mfma_f32_16x16x32_bf16 v[140:143], a[24:27], a[44:47], v[140:143]
    v_mfma_f32_16x16x32_bf16 v[156:159], a[28:31], a[44:47], v[156:159]
    ds_read_b64_tr_b16 a[24:25], v5 offset:17408
    v_mfma_f32_16x16x32_bf16 v[152:155], a[28:31], a[40:43], v[152:155]
    ds_read_b64_tr_b16 a[26:27], v5 offset:18496
    v_mfma_f32_16x16x32_bf16 v[148:151], a[28:31], a[36:39], v[148:151]
    v_mfma_f32_16x16x32_bf16 v[144:147], a[28:31], a[32:35], v[144:147]
    v_mfma_f32_16x16x32_bf16 v[160:163], a[0:3], a[32:35], v[160:163]
    ds_read_b64_tr_b16 a[28:29], v5 offset:26112
    v_mfma_f32_16x16x32_bf16 v[164:167], a[0:3], a[36:39], v[164:167]
    s_add_u32 m0, s65, 43520
    ds_read_b64_tr_b16 a[30:31], v5 offset:27200
    v_mfma_f32_16x16x32_bf16 v[168:171], a[0:3], a[40:43], v[168:171]
    buffer_load_dwordx4 v26, s[56:59], s87 offen  lds
    v_mfma_f32_16x16x32_bf16 v[172:175], a[0:3], a[44:47], v[172:175]
    v_mfma_f32_16x16x32_bf16 v[188:191], a[4:7], a[44:47], v[188:191]
    ds_read_b64_tr_b16 a[0:1], v5 offset:17440
    v_mfma_f32_16x16x32_bf16 v[184:187], a[4:7], a[40:43], v[184:187]
    ds_read_b64_tr_b16 a[2:3], v5 offset:18528
    v_mfma_f32_16x16x32_bf16 v[180:183], a[4:7], a[36:39], v[180:183]
    buffer_load_dwordx4 a[92:95], v11, s[44:47], s69 offen sc1
    v_mfma_f32_16x16x32_bf16 v[176:179], a[4:7], a[32:35], v[176:179]
    s_waitcnt lgkmcnt(6)
    v_mfma_f32_16x16x32_bf16 v[192:195], a[8:11], a[32:35], v[192:195]
    ds_read_b64_tr_b16 a[4:5], v5 offset:26144
    v_mfma_f32_16x16x32_bf16 v[196:199], a[8:11], a[36:39], v[196:199]
    ds_read_b64_tr_b16 a[6:7], v5 offset:27232
    v_mfma_f32_16x16x32_bf16 v[200:203], a[8:11], a[40:43], v[200:203]
    v_mfma_f32_16x16x32_bf16 v[204:207], a[8:11], a[44:47], v[204:207]
    v_mfma_f32_16x16x32_bf16 v[220:223], a[12:15], a[44:47], v[220:223]
    ds_read_b64_tr_b16 a[8:9], v5 offset:17472
    v_mfma_f32_16x16x32_bf16 v[216:219], a[12:15], a[40:43], v[216:219]
    s_add_u32 m0, s65, 44608
    ds_read_b64_tr_b16 a[10:11], v5 offset:18560
    v_mfma_f32_16x16x32_bf16 v[212:215], a[12:15], a[36:39], v[212:215]
    buffer_load_dwordx4 v27, s[56:59], s87 offen  lds
    v_mfma_f32_16x16x32_bf16 v[208:211], a[12:15], a[32:35], v[208:211]
    v_mfma_f32_16x16x32_bf16 v[224:227], a[16:19], a[32:35], v[224:227]
    s_add_u32 s81, s66, 0
    ds_read_b64_tr_b16 a[12:13], v5 offset:26176
    v_mfma_f32_16x16x32_bf16 v[228:231], a[16:19], a[36:39], v[228:231]
    s_cmp_eq_u32 s81, s79
    s_cselect_b32 s81, s78, 0x40000000
    ds_read_b64_tr_b16 a[14:15], v5 offset:27264
    v_mfma_f32_16x16x32_bf16 v[232:235], a[16:19], a[40:43], v[232:235]
    buffer_load_dword v7, v3, s[40:43], s81 offen
    v_mfma_f32_16x16x32_bf16 v[236:239], a[16:19], a[44:47], v[236:239]
    v_mfma_f32_16x16x32_bf16 v[252:255], a[20:23], a[44:47], v[252:255]
    ds_read_b64_tr_b16 a[16:17], v5 offset:17504
    v_mfma_f32_16x16x32_bf16 v[248:251], a[20:23], a[40:43], v[248:251]
    ds_read_b64_tr_b16 a[18:19], v5 offset:18592
    v_mfma_f32_16x16x32_bf16 v[244:247], a[20:23], a[36:39], v[244:247]
    v_mfma_f32_16x16x32_bf16 v[240:243], a[20:23], a[32:35], v[240:243]
    s_waitcnt vmcnt(20) lgkmcnt(10)
    v_mfma_f32_16x16x32_bf16 v[32:35], a[24:27], a[48:51], v[32:35]
    ds_read_b64_tr_b16 a[20:21], v5 offset:26208
    v_mfma_f32_16x16x32_bf16 v[36:39], a[24:27], a[52:55], v[36:39]
    ds_read_b64_tr_b16 a[22:23], v5 offset:27296
    v_mfma_f32_16x16x32_bf16 v[40:43], a[24:27], a[56:59], v[40:43]
    v_mfma_f32_16x16x32_bf16 v[44:47], a[24:27], a[60:63], v[44:47]
    v_mfma_f32_16x16x32_bf16 v[60:63], a[28:31], a[60:63], v[60:63]
    ds_read_b64_tr_b16 a[24:25], v5 offset:17536
    v_mfma_f32_16x16x32_bf16 v[56:59], a[28:31], a[56:59], v[56:59]
    s_add_u32 s69, s69, 5120
    ds_read_b64_tr_b16 a[26:27], v5 offset:18624
    v_mfma_f32_16x16x32_bf16 v[52:55], a[28:31], a[52:55], v[52:55]
    buffer_load_dwordx4 a[32:35], v8, s[44:47], s69 offen sc1
    v_mfma_f32_16x16x32_bf16 v[48:51], a[28:31], a[48:51], v[48:51]
    s_waitcnt lgkmcnt(6)
    v_mfma_f32_16x16x32_bf16 v[64:67], a[0:3], a[48:51], v[64:67]
    s_add_u32 s87, s87, 229376
    ds_read_b64_tr_b16 a[28:29], v5 offset:26240
    v_mfma_f32_16x16x32_bf16 v[68:71], a[0:3], a[52:55], v[68:71]
    s_add_u32 m0, s65, 52224
    ds_read_b64_tr_b16 a[30:31], v5 offset:27328
    v_mfma_f32_16x16x32_bf16 v[72:75], a[0:3], a[56:59], v[72:75]
    buffer_load_dwordx4 v26, s[52:55], s87 offen  lds
    v_mfma_f32_16x16x32_bf16 v[76:79], a[0:3], a[60:63], v[76:79]
    v_mfma_f32_16x16x32_bf16 v[92:95], a[4:7], a[60:63], v[92:95]
    ds_read_b64_tr_b16 a[0:1], v5 offset:17568
    v_mfma_f32_16x16x32_bf16 v[88:91], a[4:7], a[56:59], v[88:91]
    ds_read_b64_tr_b16 a[2:3], v5 offset:18656
    v_mfma_f32_16x16x32_bf16 v[84:87], a[4:7], a[52:55], v[84:87]
    buffer_load_dwordx4 a[36:39], v9, s[44:47], s69 offen sc1
    v_mfma_f32_16x16x32_bf16 v[80:83], a[4:7], a[48:51], v[80:83]
    v_mfma_f32_16x16x32_bf16 v[96:99], a[8:11], a[48:51], v[96:99]
    ds_read_b64_tr_b16 a[4:5], v5 offset:26272
    v_mfma_f32_16x16x32_bf16 v[100:103], a[8:11], a[52:55], v[100:103]
    ds_read_b64_tr_b16 a[6:7], v5 offset:27360
    v_mfma_f32_16x16x32_bf16 v[104:107], a[8:11], a[56:59], v[104:107]
    v_mfma_f32_16x16x32_bf16 v[108:111], a[8:11], a[60:63], v[108:111]
    v_mfma_f32_16x16x32_bf16 v[124:127], a[12:15], a[60:63], v[124:127]
    ds_read_b64_tr_b16 a[8:9], v6 offset:17408
    v_mfma_f32_16x16x32_bf16 v[120:123], a[12:15], a[56:59], v[120:123]
    s_add_u32 m0, s65, 53312
    ds_read_b64_tr_b16 a[10:11], v6 offset:18496
    v_mfma_f32_16x16x32_bf16 v[116:119], a[12:15], a[52:55], v[116:119]
    buffer_load_dwordx4 v27, s[52:55], s87 offen  lds
    v_mfma_f32_16x16x32_bf16 v[112:115], a[12:15], a[48:51], v[112:115]
    s_waitcnt lgkmcnt(6)
    v_mfma_f32_16x16x32_bf16 v[128:131], a[16:19], a[48:51], v[128:131]
    ds_read_b64_tr_b16 a[12:13], v6 offset:26112
    v_mfma_f32_16x16x32_bf16 v[132:135], a[16:19], a[52:55], v[132:135]
    ds_read_b64_tr_b16 a[14:15], v6 offset:27200
    v_mfma_f32_16x16x32_bf16 v[136:139], a[16:19], a[56:59], v[136:139]
    buffer_load_dwordx4 a[40:43], v10, s[44:47], s69 offen sc1
    v_mfma_f32_16x16x32_bf16 v[140:143], a[16:19], a[60:63], v[140:143]
    v_mfma_f32_16x16x32_bf16 v[156:159], a[20:23], a[60:63], v[156:159]
    ds_read_b64_tr_b16 a[16:17], v5 offset:34816
    v_mfma_f32_16x16x32_bf16 v[152:155], a[20:23], a[56:59], v[152:155]
    ds_read_b64_tr_b16 a[18:19], v5 offset:35904
    v_mfma_f32_16x16x32_bf16 v[148:151], a[20:23], a[52:55], v[148:151]
    v_mfma_f32_16x16x32_bf16 v[144:147], a[20:23], a[48:51], v[144:147]
    v_mfma_f32_16x16x32_bf16 v[160:163], a[24:27], a[48:51], v[160:163]
    ds_read_b64_tr_b16 a[20:21], v5 offset:43520
    v_mfma_f32_16x16x32_bf16 v[164:167], a[24:27], a[52:55], v[164:167]
    s_add_u32 m0, s65, 60928
    ds_read_b64_tr_b16 a[22:23], v5 offset:44608
    v_mfma_f32_16x16x32_bf16 v[168:171], a[24:27], a[56:59], v[168:171]
    buffer_load_dwordx4 v26, s[56:59], s87 offen  lds
    v_mfma_f32_16x16x32_bf16 v[172:175], a[24:27], a[60:63], v[172:175]
    v_mfma_f32_16x16x32_bf16 v[188:191], a[28:31], a[60:63], v[188:191]
    ds_read_b64_tr_b16 a[24:25], v5 offset:34848
    v_mfma_f32_16x16x32_bf16 v[184:187], a[28:31], a[56:59], v[184:187]
    ds_read_b64_tr_b16 a[26:27], v5 offset:35936
    v_mfma_f32_16x16x32_bf16 v[180:183], a[28:31], a[52:55], v[180:183]
    buffer_load_dwordx4 a[44:47], v11, s[44:47], s69 offen sc1
    v_mfma_f32_16x16x32_bf16 v[176:179], a[28:31], a[48:51], v[176:179]
    s_waitcnt lgkmcnt(6)
    v_mfma_f32_16x16x32_bf16 v[192:195], a[0:3], a[48:51], v[192:195]
    ds_read_b64_tr_b16 a[28:29], v5 offset:43552
    v_mfma_f32_16x16x32_bf16 v[196:199], a[0:3], a[52:55], v[196:199]
    ds_read_b64_tr_b16 a[30:31], v5 offset:44640
    v_mfma_f32_16x16x32_bf16 v[200:203], a[0:3], a[56:59], v[200:203]
    v_mfma_f32_16x16x32_bf16 v[204:207], a[0:3], a[60:63], v[204:207]
    v_mfma_f32_16x16x32_bf16 v[220:223], a[4:7], a[60:63], v[220:223]
    ds_read_b64_tr_b16 a[0:1], v5 offset:34880
    v_mfma_f32_16x16x32_bf16 v[216:219], a[4:7], a[56:59], v[216:219]
    s_add_u32 m0, s65, 62016
    ds_read_b64_tr_b16 a[2:3], v5 offset:35968
    v_mfma_f32_16x16x32_bf16 v[212:215], a[4:7], a[52:55], v[212:215]
    buffer_load_dwordx4 v27, s[56:59], s87 offen  lds
    v_mfma_f32_16x16x32_bf16 v[208:211], a[4:7], a[48:51], v[208:211]
    v_mfma_f32_16x16x32_bf16 v[224:227], a[8:11], a[48:51], v[224:227]
    s_add_u32 s81, s66, 1
    ds_read_b64_tr_b16 a[4:5], v5 offset:43584
    v_mfma_f32_16x16x32_bf16 v[228:231], a[8:11], a[52:55], v[228:231]
    s_cmp_eq_u32 s81, s82
    s_cselect_b32 s81, s80, 0x40000000
    ds_read_b64_tr_b16 a[6:7], v5 offset:44672
    v_mfma_f32_16x16x32_bf16 v[232:235], a[8:11], a[56:59], v[232:235]
    buffer_load_dword v7, v3, s[48:51], s81 offen
    v_mfma_f32_16x16x32_bf16 v[236:239], a[8:11], a[60:63], v[236:239]
    v_mfma_f32_16x16x32_bf16 v[252:255], a[12:15], a[60:63], v[252:255]
    ds_read_b64_tr_b16 a[8:9], v5 offset:34912
    v_mfma_f32_16x16x32_bf16 v[248:251], a[12:15], a[56:59], v[248:251]
    ds_read_b64_tr_b16 a[10:11], v5 offset:36000
    v_mfma_f32_16x16x32_bf16 v[244:247], a[12:15], a[52:55], v[244:247]
    v_mfma_f32_16x16x32_bf16 v[240:243], a[12:15], a[48:51], v[240:243]
    s_waitcnt vmcnt(20) lgkmcnt(10)
    s_barrier
    v_mfma_f32_16x16x32_bf16 v[32:35], a[16:19], a[64:67], v[32:35]
    ds_read_b64_tr_b16 a[12:13], v5 offset:43616
    v_mfma_f32_16x16x32_bf16 v[36:39], a[16:19], a[68:71], v[36:39]
    ds_read_b64_tr_b16 a[14:15], v5 offset:44704
    v_mfma_f32_16x16x32_bf16 v[40:43], a[16:19], a[72:75], v[40:43]
    v_mfma_f32_16x16x32_bf16 v[44:47], a[16:19], a[76:79], v[44:47]
    v_mfma_f32_16x16x32_bf16 v[60:63], a[20:23], a[76:79], v[60:63]
    ds_read_b64_tr_b16 a[16:17], v5 offset:34944
    v_mfma_f32_16x16x32_bf16 v[56:59], a[20:23], a[72:75], v[56:59]
    s_add_u32 s69, s69, 5120
    ds_read_b64_tr_b16 a[18:19], v5 offset:36032
    v_mfma_f32_16x16x32_bf16 v[52:55], a[20:23], a[68:71], v[52:55]
    buffer_load_dwordx4 a[48:51], v8, s[44:47], s69 offen sc1
    v_mfma_f32_16x16x32_bf16 v[48:51], a[20:23], a[64:67], v[48:51]
    s_waitcnt lgkmcnt(6)
    v_mfma_f32_16x16x32_bf16 v[64:67], a[24:27], a[64:67], v[64:67]
    s_add_u32 s87, s87, 229376
    ds_read_b64_tr_b16 a[20:21], v5 offset:43648
    v_mfma_f32_16x16x32_bf16 v[68:71], a[24:27], a[68:71], v[68:71]
    s_add_u32 m0, s67, 0
    ds_read_b64_tr_b16 a[22:23], v5 offset:44736
    v_mfma_f32_16x16x32_bf16 v[72:75], a[24:27], a[72:75], v[72:75]
    buffer_load_dwordx4 v26, s[52:55], s87 offen  lds
    v_mfma_f32_16x16x32_bf16 v[76:79], a[24:27], a[76:79], v[76:79]
    v_mfma_f32_16x16x32_bf16 v[92:95], a[28:31], a[76:79], v[92:95]
    ds_read_b64_tr_b16 a[24:25], v5 offset:34976
    v_mfma_f32_16x16x32_bf16 v[88:91], a[28:31], a[72:75], v[88:91]
    ds_read_b64_tr_b16 a[26:27], v5 offset:36064
    v_mfma_f32_16x16x32_bf16 v[84:87], a[28:31], a[68:71], v[84:87]
    buffer_load_dwordx4 a[52:55], v9, s[44:47], s69 offen sc1
    v_mfma_f32_16x16x32_bf16 v[80:83], a[28:31], a[64:67], v[80:83]
    v_mfma_f32_16x16x32_bf16 v[96:99], a[0:3], a[64:67], v[96:99]
    ds_read_b64_tr_b16 a[28:29], v5 offset:43680
    v_mfma_f32_16x16x32_bf16 v[100:103], a[0:3], a[68:71], v[100:103]
    ds_read_b64_tr_b16 a[30:31], v5 offset:44768
    v_mfma_f32_16x16x32_bf16 v[104:107], a[0:3], a[72:75], v[104:107]
    v_mfma_f32_16x16x32_bf16 v[108:111], a[0:3], a[76:79], v[108:111]
    v_mfma_f32_16x16x32_bf16 v[124:127], a[4:7], a[76:79], v[124:127]
    ds_read_b64_tr_b16 a[0:1], v6 offset:34816
    v_mfma_f32_16x16x32_bf16 v[120:123], a[4:7], a[72:75], v[120:123]
    s_add_u32 m0, s67, 1088
    ds_read_b64_tr_b16 a[2:3], v6 offset:35904
    v_mfma_f32_16x16x32_bf16 v[116:119], a[4:7], a[68:71], v[116:119]
    buffer_load_dwordx4 v27, s[52:55], s87 offen  lds
    v_mfma_f32_16x16x32_bf16 v[112:115], a[4:7], a[64:67], v[112:115]
    s_waitcnt lgkmcnt(6)
    v_mfma_f32_16x16x32_bf16 v[128:131], a[8:11], a[64:67], v[128:131]
    ds_read_b64_tr_b16 a[4:5], v6 offset:43520
    v_mfma_f32_16x16x32_bf16 v[132:135], a[8:11], a[68:71], v[132:135]
    ds_read_b64_tr_b16 a[6:7], v6 offset:44608
    v_mfma_f32_16x16x32_bf16 v[136:139], a[8:11], a[72:75], v[136:139]
    buffer_load_dwordx4 a[56:59], v10, s[44:47], s69 offen sc1
    v_mfma_f32_16x16x32_bf16 v[140:143], a[8:11], a[76:79], v[140:143]
    v_mfma_f32_16x16x32_bf16 v[156:159], a[12:15], a[76:79], v[156:159]
    ds_read_b64_tr_b16 a[8:9], v5 offset:52224
    v_mfma_f32_16x16x32_bf16 v[152:155], a[12:15], a[72:75], v[152:155]
    ds_read_b64_tr_b16 a[10:11], v5 offset:53312
    v_mfma_f32_16x16x32_bf16 v[148:151], a[12:15], a[68:71], v[148:151]
    v_mfma_f32_16x16x32_bf16 v[144:147], a[12:15], a[64:67], v[144:147]
    v_mfma_f32_16x16x32_bf16 v[160:163], a[16:19], a[64:67], v[160:163]
    ds_read_b64_tr_b16 a[12:13], v5 offset:60928
    v_mfma_f32_16x16x32_bf16 v[164:167], a[16:19], a[68:71], v[164:167]
    s_add_u32 m0, s67, 8704
    ds_read_b64_tr_b16 a[14:15], v5 offset:62016
    v_mfma_f32_16x16x32_bf16 v[168:171], a[16:19], a[72:75], v[168:171]
    buffer_load_dwordx4 v26, s[56:59], s87 offen  lds
    v_mfma_f32_16x16x32_bf16 v[172:175], a[16:19], a[76:79], v[172:175]
    v_mfma_f32_16x16x32_bf16 v[188:191], a[20:23], a[76:79], v[188:191]
    ds_read_b64_tr_b16 a[16:17], v5 offset:52256
    v_mfma_f32_16x16x32_bf16 v[184:187], a[20:23], a[72:75], v[184:187]
    ds_read_b64_tr_b16 a[18:19], v5 offset:53344
    v_mfma_f32_16x16x32_bf16 v[180:183], a[20:23], a[68:71], v[180:183]
    buffer_load_dwordx4 a[60:63], v11, s[44:47], s69 offen sc1
    v_mfma_f32_16x16x32_bf16 v[176:179], a[20:23], a[64:67], v[176:179]
    s_waitcnt lgkmcnt(6)
    v_mfma_f32_16x16x32_bf16 v[192:195], a[24:27], a[64:67], v[192:195]
    ds_read_b64_tr_b16 a[20:21], v5 offset:60960
    v_mfma_f32_16x16x32_bf16 v[196:199], a[24:27], a[68:71], v[196:199]
    ds_read_b64_tr_b16 a[22:23], v5 offset:62048
    v_mfma_f32_16x16x32_bf16 v[200:203], a[24:27], a[72:75], v[200:203]
    v_mfma_f32_16x16x32_bf16 v[204:207], a[24:27], a[76:79], v[204:207]
    v_mfma_f32_16x16x32_bf16 v[220:223], a[28:31], a[76:79], v[220:223]
    ds_read_b64_tr_b16 a[24:25], v5 offset:52288
    v_mfma_f32_16x16x32_bf16 v[216:219], a[28:31], a[72:75], v[216:219]
    s_add_u32 m0, s67, 9792
    ds_read_b64_tr_b16 a[26:27], v5 offset:53376
    v_mfma_f32_16x16x32_bf16 v[212:215], a[28:31], a[68:71], v[212:215]
    buffer_load_dwordx4 v27, s[56:59], s87 offen  lds
    v_mfma_f32_16x16x32_bf16 v[208:211], a[28:31], a[64:67], v[208:211]
    v_mfma_f32_16x16x32_bf16 v[224:227], a[0:3], a[64:67], v[224:227]
    s_add_u32 s81, s66, 2
    ds_read_b64_tr_b16 a[28:29], v5 offset:60992
    v_mfma_f32_16x16x32_bf16 v[228:231], a[0:3], a[68:71], v[228:231]
    s_cmp_eq_u32 s81, s79
    s_cselect_b32 s81, s78, 0x40000000
    ds_read_b64_tr_b16 a[30:31], v5 offset:62080
    v_mfma_f32_16x16x32_bf16 v[232:235], a[0:3], a[72:75], v[232:235]
    buffer_load_dword v7, v3, s[40:43], s81 offen
    v_mfma_f32_16x16x32_bf16 v[236:239], a[0:3], a[76:79], v[236:239]
    v_mfma_f32_16x16x32_bf16 v[252:255], a[4:7], a[76:79], v[252:255]
    ds_read_b64_tr_b16 a[0:1], v5 offset:52320
    v_mfma_f32_16x16x32_bf16 v[248:251], a[4:7], a[72:75], v[248:251]
    ds_read_b64_tr_b16 a[2:3], v5 offset:53408
    v_mfma_f32_16x16x32_bf16 v[244:247], a[4:7], a[68:71], v[244:247]
    v_mfma_f32_16x16x32_bf16 v[240:243], a[4:7], a[64:67], v[240:243]
    s_waitcnt vmcnt(20) lgkmcnt(10)
    v_mfma_f32_16x16x32_bf16 v[32:35], a[8:11], a[80:83], v[32:35]
    ds_read_b64_tr_b16 a[4:5], v5 offset:61024
    v_mfma_f32_16x16x32_bf16 v[36:39], a[8:11], a[84:87], v[36:39]
    ds_read_b64_tr_b16 a[6:7], v5 offset:62112
    v_mfma_f32_16x16x32_bf16 v[40:43], a[8:11], a[88:91], v[40:43]
    v_mfma_f32_16x16x32_bf16 v[44:47], a[8:11], a[92:95], v[44:47]
    v_mfma_f32_16x16x32_bf16 v[60:63], a[12:15], a[92:95], v[60:63]
    ds_read_b64_tr_b16 a[8:9], v5 offset:52352
    v_mfma_f32_16x16x32_bf16 v[56:59], a[12:15], a[88:91], v[56:59]
    s_add_u32 s69, s69, 5120
    ds_read_b64_tr_b16 a[10:11], v5 offset:53440
    v_mfma_f32_16x16x32_bf16 v[52:55], a[12:15], a[84:87], v[52:55]
    buffer_load_dwordx4 a[64:67], v8, s[44:47], s69 offen sc1
    v_mfma_f32_16x16x32_bf16 v[48:51], a[12:15], a[80:83], v[48:51]
    s_waitcnt lgkmcnt(6)
    v_mfma_f32_16x16x32_bf16 v[64:67], a[16:19], a[80:83], v[64:67]
    s_add_u32 s87, s87, 229376
    ds_read_b64_tr_b16 a[12:13], v5 offset:61056
    v_mfma_f32_16x16x32_bf16 v[68:71], a[16:19], a[84:87], v[68:71]
    s_add_u32 m0, s67, 17408
    ds_read_b64_tr_b16 a[14:15], v5 offset:62144
    v_mfma_f32_16x16x32_bf16 v[72:75], a[16:19], a[88:91], v[72:75]
    buffer_load_dwordx4 v26, s[52:55], s87 offen  lds
    v_mfma_f32_16x16x32_bf16 v[76:79], a[16:19], a[92:95], v[76:79]
    v_mfma_f32_16x16x32_bf16 v[92:95], a[20:23], a[92:95], v[92:95]
    ds_read_b64_tr_b16 a[16:17], v5 offset:52384
    v_mfma_f32_16x16x32_bf16 v[88:91], a[20:23], a[88:91], v[88:91]
    ds_read_b64_tr_b16 a[18:19], v5 offset:53472
    v_mfma_f32_16x16x32_bf16 v[84:87], a[20:23], a[84:87], v[84:87]
    buffer_load_dwordx4 a[68:71], v9, s[44:47], s69 offen sc1
    v_mfma_f32_16x16x32_bf16 v[80:83], a[20:23], a[80:83], v[80:83]
    v_mfma_f32_16x16x32_bf16 v[96:99], a[24:27], a[80:83], v[96:99]
    ds_read_b64_tr_b16 a[20:21], v5 offset:61088
    v_mfma_f32_16x16x32_bf16 v[100:103], a[24:27], a[84:87], v[100:103]
    ds_read_b64_tr_b16 a[22:23], v5 offset:62176
    v_mfma_f32_16x16x32_bf16 v[104:107], a[24:27], a[88:91], v[104:107]
    v_mfma_f32_16x16x32_bf16 v[108:111], a[24:27], a[92:95], v[108:111]
    v_mfma_f32_16x16x32_bf16 v[124:127], a[28:31], a[92:95], v[124:127]
    ds_read_b64_tr_b16 a[24:25], v6 offset:52224
    v_mfma_f32_16x16x32_bf16 v[120:123], a[28:31], a[88:91], v[120:123]
    s_add_u32 m0, s67, 18496
    ds_read_b64_tr_b16 a[26:27], v6 offset:53312
    v_mfma_f32_16x16x32_bf16 v[116:119], a[28:31], a[84:87], v[116:119]
    buffer_load_dwordx4 v27, s[52:55], s87 offen  lds
    v_mfma_f32_16x16x32_bf16 v[112:115], a[28:31], a[80:83], v[112:115]
    s_waitcnt lgkmcnt(6)
    v_mfma_f32_16x16x32_bf16 v[128:131], a[0:3], a[80:83], v[128:131]
    ds_read_b64_tr_b16 a[28:29], v6 offset:60928
    v_mfma_f32_16x16x32_bf16 v[132:135], a[0:3], a[84:87], v[132:135]
    ds_read_b64_tr_b16 a[30:31], v6 offset:62016
    v_mfma_f32_16x16x32_bf16 v[136:139], a[0:3], a[88:91], v[136:139]
    buffer_load_dwordx4 a[72:75], v10, s[44:47], s69 offen sc1
    v_mfma_f32_16x16x32_bf16 v[140:143], a[0:3], a[92:95], v[140:143]
    v_mfma_f32_16x16x32_bf16 v[156:159], a[4:7], a[92:95], v[156:159]
    v_add_u32 v5, s70, v5
    ds_read_b64_tr_b16 a[0:1], v5 offset:0
    v_mfma_f32_16x16x32_bf16 v[152:155], a[4:7], a[88:91], v[152:155]
    ds_read_b64_tr_b16 a[2:3], v5 offset:1088
    v_mfma_f32_16x16x32_bf16 v[148:151], a[4:7], a[84:87], v[148:151]
    v_mfma_f32_16x16x32_bf16 v[144:147], a[4:7], a[80:83], v[144:147]
    v_mfma_f32_16x16x32_bf16 v[160:163], a[8:11], a[80:83], v[160:163]
    ds_read_b64_tr_b16 a[4:5], v5 offset:8704
    v_mfma_f32_16x16x32_bf16 v[164:167], a[8:11], a[84:87], v[164:167]
    s_add_u32 m0, s67, 26112
    ds_read_b64_tr_b16 a[6:7], v5 offset:9792
    v_mfma_f32_16x16x32_bf16 v[168:171], a[8:11], a[88:91], v[168:171]
    buffer_load_dwordx4 v26, s[56:59], s87 offen  lds
    v_mfma_f32_16x16x32_bf16 v[172:175], a[8:11], a[92:95], v[172:175]
    v_mfma_f32_16x16x32_bf16 v[188:191], a[12:15], a[92:95], v[188:191]
    ds_read_b64_tr_b16 a[8:9], v5 offset:32
    v_mfma_f32_16x16x32_bf16 v[184:187], a[12:15], a[88:91], v[184:187]
    ds_read_b64_tr_b16 a[10:11], v5 offset:1120
    v_mfma_f32_16x16x32_bf16 v[180:183], a[12:15], a[84:87], v[180:183]
    buffer_load_dwordx4 a[76:79], v11, s[44:47], s69 offen sc1
    v_mfma_f32_16x16x32_bf16 v[176:179], a[12:15], a[80:83], v[176:179]
    s_waitcnt lgkmcnt(6)
    v_mfma_f32_16x16x32_bf16 v[192:195], a[16:19], a[80:83], v[192:195]
    ds_read_b64_tr_b16 a[12:13], v5 offset:8736
    v_mfma_f32_16x16x32_bf16 v[196:199], a[16:19], a[84:87], v[196:199]
    ds_read_b64_tr_b16 a[14:15], v5 offset:9824
    v_mfma_f32_16x16x32_bf16 v[200:203], a[16:19], a[88:91], v[200:203]
    v_mfma_f32_16x16x32_bf16 v[204:207], a[16:19], a[92:95], v[204:207]
    v_mfma_f32_16x16x32_bf16 v[220:223], a[20:23], a[92:95], v[220:223]
    ds_read_b64_tr_b16 a[16:17], v5 offset:64
    v_mfma_f32_16x16x32_bf16 v[216:219], a[20:23], a[88:91], v[216:219]
    s_add_u32 m0, s67, 27200
    ds_read_b64_tr_b16 a[18:19], v5 offset:1152
    v_mfma_f32_16x16x32_bf16 v[212:215], a[20:23], a[84:87], v[212:215]
    buffer_load_dwordx4 v27, s[56:59], s87 offen  lds
    v_mfma_f32_16x16x32_bf16 v[208:211], a[20:23], a[80:83], v[208:211]
    v_mfma_f32_16x16x32_bf16 v[224:227], a[24:27], a[80:83], v[224:227]
    s_add_u32 s81, s66, 3
    ds_read_b64_tr_b16 a[20:21], v5 offset:8768
    v_mfma_f32_16x16x32_bf16 v[228:231], a[24:27], a[84:87], v[228:231]
    s_cmp_eq_u32 s81, s82
    s_cselect_b32 s81, s80, 0x40000000
    ds_read_b64_tr_b16 a[22:23], v5 offset:9856
    v_mfma_f32_16x16x32_bf16 v[232:235], a[24:27], a[88:91], v[232:235]
    buffer_load_dword v7, v3, s[48:51], s81 offen
    v_mfma_f32_16x16x32_bf16 v[236:239], a[24:27], a[92:95], v[236:239]
    v_mfma_f32_16x16x32_bf16 v[252:255], a[28:31], a[92:95], v[252:255]
    ds_read_b64_tr_b16 a[24:25], v5 offset:96
    v_mfma_f32_16x16x32_bf16 v[248:251], a[28:31], a[88:91], v[248:251]
    ds_read_b64_tr_b16 a[26:27], v5 offset:1184
    v_mfma_f32_16x16x32_bf16 v[244:247], a[28:31], a[84:87], v[244:247]
    v_mfma_f32_16x16x32_bf16 v[240:243], a[28:31], a[80:83], v[240:243]
    s_mov_b32 s81, s65
    s_mov_b32 s65, s67
    s_mov_b32 s67, s81
    s_add_u32 s66, s66, 4
    s_cmp_lt_u32 s66, 20
    s_cbranch_scc1 L_g1_loop
L_g1_post:
    s_waitcnt vmcnt(20) lgkmcnt(10)
    s_barrier
    v_mfma_f32_16x16x32_bf16 v[32:35], a[0:3], a[32:35], v[32:35]
    ds_read_b64_tr_b16 a[28:29], v5 offset:8800
    v_mfma_f32_16x16x32_bf16 v[36:39], a[0:3], a[36:39], v[36:39]
    ds_read_b64_tr_b16 a[30:31], v5 offset:9888
    v_mfma_f32_16x16x32_bf16 v[40:43], a[0:3], a[40:43], v[40:43]
    v_mfma_f32_16x16x32_bf16 v[44:47], a[0:3], a[44:47], v[44:47]
    v_mfma_f32_16x16x32_bf16 v[60:63], a[4:7], a[44:47], v[60:63]
    ds_read_b64_tr_b16 a[0:1], v5 offset:128
    v_mfma_f32_16x16x32_bf16 v[56:59], a[4:7], a[40:43], v[56:59]
    s_add_u32 s69, s69, 5120
    ds_read_b64_tr_b16 a[2:3], v5 offset:1216
    v_mfma_f32_16x16x32_bf16 v[52:55], a[4:7], a[36:39], v[52:55]
    buffer_load_dwordx4 a[80:83], v8, s[44:47], s69 offen sc1
    v_mfma_f32_16x16x32_bf16 v[48:51], a[4:7], a[32:35], v[48:51]
    s_waitcnt lgkmcnt(6)
    v_mfma_f32_16x16x32_bf16 v[64:67], a[8:11], a[32:35], v[64:67]
    s_add_u32 s87, s87, 229376
    ds_read_b64_tr_b16 a[4:5], v5 offset:8832
    v_mfma_f32_16x16x32_bf16 v[68:71], a[8:11], a[36:39], v[68:71]
    s_add_u32 m0, s86, 34816
    ds_read_b64_tr_b16 a[6:7], v5 offset:9920
    v_mfma_f32_16x16x32_bf16 v[72:75], a[8:11], a[40:43], v[72:75]
    buffer_load_dwordx4 v26, s[52:55], s87 offen  lds
    v_mfma_f32_16x16x32_bf16 v[76:79], a[8:11], a[44:47], v[76:79]
    v_mfma_f32_16x16x32_bf16 v[92:95], a[12:15], a[44:47], v[92:95]
    ds_read_b64_tr_b16 a[8:9], v5 offset:160
    v_mfma_f32_16x16x32_bf16 v[88:91], a[12:15], a[40:43], v[88:91]
    ds_read_b64_tr_b16 a[10:11], v5 offset:1248
    v_mfma_f32_16x16x32_bf16 v[84:87], a[12:15], a[36:39], v[84:87]
    buffer_load_dwordx4 a[84:87], v9, s[44:47], s69 offen sc1
    v_mfma_f32_16x16x32_bf16 v[80:83], a[12:15], a[32:35], v[80:83]
    v_mfma_f32_16x16x32_bf16 v[96:99], a[16:19], a[32:35], v[96:99]
    ds_read_b64_tr_b16 a[12:13], v5 offset:8864
    v_mfma_f32_16x16x32_bf16 v[100:103], a[16:19], a[36:39], v[100:103]
    ds_read_b64_tr_b16 a[14:15], v5 offset:9952
    v_mfma_f32_16x16x32_bf16 v[104:107], a[16:19], a[40:43], v[104:107]
    v_mfma_f32_16x16x32_bf16 v[108:111], a[16:19], a[44:47], v[108:111]
    v_mfma_f32_16x16x32_bf16 v[124:127], a[20:23], a[44:47], v[124:127]
    v_add_u32 v6, 0x11000, v6
    ds_read_b64_tr_b16 a[16:17], v6 offset:0
    v_mfma_f32_16x16x32_bf16 v[120:123], a[20:23], a[40:43], v[120:123]
    s_add_u32 m0, s86, 35904
    ds_read_b64_tr_b16 a[18:19], v6 offset:1088
    v_mfma_f32_16x16x32_bf16 v[116:119], a[20:23], a[36:39], v[116:119]
    buffer_load_dwordx4 v27, s[52:55], s87 offen  lds
    v_mfma_f32_16x16x32_bf16 v[112:115], a[20:23], a[32:35], v[112:115]
    s_waitcnt lgkmcnt(6)
    v_mfma_f32_16x16x32_bf16 v[128:131], a[24:27], a[32:35], v[128:131]
    ds_read_b64_tr_b16 a[20:21], v6 offset:8704
    v_mfma_f32_16x16x32_bf16 v[132:135], a[24:27], a[36:39], v[132:135]
    ds_read_b64_tr_b16 a[22:23], v6 offset:9792
    v_mfma_f32_16x16x32_bf16 v[136:139], a[24:27], a[40:43], v[136:139]
    buffer_load_dwordx4 a[88:91], v10, s[44:47], s69 offen sc1
    v_mfma_f32_16x16x32_bf16 v[140:143], a[24:27], a[44:47], v[140:143]
    v_mfma_f32_16x16x32_bf16 v[156:159], a[28:31], a[44:47], v[156:159]
    ds_read_b64_tr_b16 a[24:25], v5 offset:17408
    v_mfma_f32_16x16x32_bf16 v[152:155], a[28:31], a[40:43], v[152:155]
    ds_read_b64_tr_b16 a[26:27], v5 offset:18496
    v_mfma_f32_16x16x32_bf16 v[148:151], a[28:31], a[36:39], v[148:151]
    v_mfma_f32_16x16x32_bf16 v[144:147], a[28:31], a[32:35], v[144:147]
    v_mfma_f32_16x16x32_bf16 v[160:163], a[0:3], a[32:35], v[160:163]
    ds_read_b64_tr_b16 a[28:29], v5 offset:26112
    v_mfma_f32_16x16x32_bf16 v[164:167], a[0:3], a[36:39], v[164:167]
    s_add_u32 m0, s86, 43520
    ds_read_b64_tr_b16 a[30:31], v5 offset:27200
    v_mfma_f32_16x16x32_bf16 v[168:171], a[0:3], a[40:43], v[168:171]
    buffer_load_dwordx4 v26, s[56:59], s87 offen  lds
    v_mfma_f32_16x16x32_bf16 v[172:175], a[0:3], a[44:47], v[172:175]
    v_mfma_f32_16x16x32_bf16 v[188:191], a[4:7], a[44:47], v[188:191]
    ds_read_b64_tr_b16 a[0:1], v5 offset:17440
    v_mfma_f32_16x16x32_bf16 v[184:187], a[4:7], a[40:43], v[184:187]
    ds_read_b64_tr_b16 a[2:3], v5 offset:18528
    v_mfma_f32_16x16x32_bf16 v[180:183], a[4:7], a[36:39], v[180:183]
    buffer_load_dwordx4 a[92:95], v11, s[44:47], s69 offen sc1
    v_mfma_f32_16x16x32_bf16 v[176:179], a[4:7], a[32:35], v[176:179]
    s_waitcnt lgkmcnt(6)
    v_mfma_f32_16x16x32_bf16 v[192:195], a[8:11], a[32:35], v[192:195]
    ds_read_b64_tr_b16 a[4:5], v5 offset:26144
    v_mfma_f32_16x16x32_bf16 v[196:199], a[8:11], a[36:39], v[196:199]
    ds_read_b64_tr_b16 a[6:7], v5 offset:27232
    v_mfma_f32_16x16x32_bf16 v[200:203], a[8:11], a[40:43], v[200:203]
    v_mfma_f32_16x16x32_bf16 v[204:207], a[8:11], a[44:47], v[204:207]
    v_mfma_f32_16x16x32_bf16 v[220:223], a[12:15], a[44:47], v[220:223]
    ds_read_b64_tr_b16 a[8:9], v5 offset:17472
    v_mfma_f32_16x16x32_bf16 v[216:219], a[12:15], a[40:43], v[216:219]
    s_add_u32 m0, s86, 44608
    ds_read_b64_tr_b16 a[10:11], v5 offset:18560
    v_mfma_f32_16x16x32_bf16 v[212:215], a[12:15], a[36:39], v[212:215]
    buffer_load_dwordx4 v27, s[56:59], s87 offen  lds
    v_mfma_f32_16x16x32_bf16 v[208:211], a[12:15], a[32:35], v[208:211]
    v_mfma_f32_16x16x32_bf16 v[224:227], a[16:19], a[32:35], v[224:227]
    ds_read_b64_tr_b16 a[12:13], v5 offset:26176
    v_mfma_f32_16x16x32_bf16 v[228:231], a[16:19], a[36:39], v[228:231]
    s_mov_b32 s73, 0x500000
    ds_read_b64_tr_b16 a[14:15], v5 offset:27264
    v_mfma_f32_16x16x32_bf16 v[232:235], a[16:19], a[40:43], v[232:235]
    buffer_store_dwordx4 a[240:243], v4, s[44:47], s73 offen sc1
    v_mfma_f32_16x16x32_bf16 v[236:239], a[16:19], a[44:47], v[236:239]
    v_mfma_f32_16x16x32_bf16 v[252:255], a[20:23], a[44:47], v[252:255]
    ds_read_b64_tr_b16 a[16:17], v5 offset:17504
    v_mfma_f32_16x16x32_bf16 v[248:251], a[20:23], a[40:43], v[248:251]
    ds_read_b64_tr_b16 a[18:19], v5 offset:18592
    v_mfma_f32_16x16x32_bf16 v[244:247], a[20:23], a[36:39], v[244:247]
    v_mfma_f32_16x16x32_bf16 v[240:243], a[20:23], a[32:35], v[240:243]
    s_waitcnt vmcnt(20) lgkmcnt(10)
    v_mfma_f32_16x16x32_bf16 v[32:35], a[24:27], a[48:51], v[32:35]
    ds_read_b64_tr_b16 a[20:21], v5 offset:26208
    v_mfma_f32_16x16x32_bf16 v[36:39], a[24:27], a[52:55], v[36:39]
    ds_read_b64_tr_b16 a[22:23], v5 offset:27296
    v_mfma_f32_16x16x32_bf16 v[40:43], a[24:27], a[56:59], v[40:43]
    v_mfma_f32_16x16x32_bf16 v[44:47], a[24:27], a[60:63], v[44:47]
    v_mfma_f32_16x16x32_bf16 v[60:63], a[28:31], a[60:63], v[60:63]
    ds_read_b64_tr_b16 a[24:25], v5 offset:17536
    v_mfma_f32_16x16x32_bf16 v[56:59], a[28:31], a[56:59], v[56:59]
    s_add_u32 s69, s69, 5120
    ds_read_b64_tr_b16 a[26:27], v5 offset:18624
    v_mfma_f32_16x16x32_bf16 v[52:55], a[28:31], a[52:55], v[52:55]
    buffer_load_dwordx4 a[32:35], v8, s[44:47], s69 offen sc1
    v_mfma_f32_16x16x32_bf16 v[48:51], a[28:31], a[48:51], v[48:51]
    s_waitcnt lgkmcnt(6)
    v_mfma_f32_16x16x32_bf16 v[64:67], a[0:3], a[48:51], v[64:67]
    s_add_u32 s87, s87, 229376
    ds_read_b64_tr_b16 a[28:29], v5 offset:26240
    v_mfma_f32_16x16x32_bf16 v[68:71], a[0:3], a[52:55], v[68:71]
    s_add_u32 m0, s86, 52224
    ds_read_b64_tr_b16 a[30:31], v5 offset:27328
    v_mfma_f32_16x16x32_bf16 v[72:75], a[0:3], a[56:59], v[72:75]
    buffer_load_dwordx4 v26, s[52:55], s87 offen  lds
    v_mfma_f32_16x16x32_bf16 v[76:79], a[0:3], a[60:63], v[76:79]
    v_mfma_f32_16x16x32_bf16 v[92:95], a[4:7], a[60:63], v[92:95]
    ds_read_b64_tr_b16 a[0:1], v5 offset:17568
    v_mfma_f32_16x16x32_bf16 v[88:91], a[4:7], a[56:59], v[88:91]
    ds_read_b64_tr_b16 a[2:3], v5 offset:18656
    v_mfma_f32_16x16x32_bf16 v[84:87], a[4:7], a[52:55], v[84:87]
    buffer_load_dwordx4 a[36:39], v9, s[44:47], s69 offen sc1
    v_mfma_f32_16x16x32_bf16 v[80:83], a[4:7], a[48:51], v[80:83]
    v_mfma_f32_16x16x32_bf16 v[96:99], a[8:11], a[48:51], v[96:99]
    ds_read_b64_tr_b16 a[4:5], v5 offset:26272
    v_mfma_f32_16x16x32_bf16 v[100:103], a[8:11], a[52:55], v[100:103]
    s_add_u32 m0, s86, 53312
    ds_read_b64_tr_b16 a[6:7], v5 offset:27360
    v_mfma_f32_16x16x32_bf16 v[104:107], a[8:11], a[56:59], v[104:107]
    buffer_load_dwordx4 v27, s[52:55], s87 offen  lds
    v_mfma_f32_16x16x32_bf16 v[108:111], a[8:11], a[60:63], v[108:111]
    v_mfma_f32_16x16x32_bf16 v[124:127], a[12:15], a[60:63], v[124:127]
    ds_read_b64_tr_b16 a[8:9], v6 offset:17408
    v_mfma_f32_16x16x32_bf16 v[120:123], a[12:15], a[56:59], v[120:123]
    ds_read_b64_tr_b16 a[10:11], v6 offset:18496
    v_mfma_f32_16x16x32_bf16 v[116:119], a[12:15], a[52:55], v[116:119]
    buffer_load_dwordx4 a[40:43], v10, s[44:47], s69 offen sc1
    v_mfma_f32_16x16x32_bf16 v[112:115], a[12:15], a[48:51], v[112:115]
    s_waitcnt lgkmcnt(6)
    v_mfma_f32_16x16x32_bf16 v[128:131], a[16:19], a[48:51], v[128:131]
    ds_read_b64_tr_b16 a[12:13], v6 offset:26112
    v_mfma_f32_16x16x32_bf16 v[132:135], a[16:19], a[52:55], v[132:135]
    s_add_u32 m0, s86, 60928
    ds_read_b64_tr_b16 a[14:15], v6 offset:27200
    v_mfma_f32_16x16x32_bf16 v[136:139], a[16:19], a[56:59], v[136:139]
    buffer_load_dwordx4 v26, s[56:59], s87 offen  lds
    v_mfma_f32_16x16x32_bf16 v[140:143], a[16:19], a[60:63], v[140:143]
    v_mfma_f32_16x16x32_bf16 v[156:159], a[20:23], a[60:63], v[156:159]
    ds_read_b64_tr_b16 a[16:17], v5 offset:34816
    v_mfma_f32_16x16x32_bf16 v[152:155], a[20:23], a[56:59], v[152:155]
    ds_read_b64_tr_b16 a[18:19], v5 offset:35904
    v_mfma_f32_16x16x32_bf16 v[148:151], a[20:23], a[52:55], v[148:151]
    v_mfma_f32_16x16x32_bf16 v[144:147], a[20:23], a[48:51], v[144:147]
    v_mfma_f32_16x16x32_bf16 v[160:163], a[24:27], a[48:51], v[160:163]
    ds_read_b64_tr_b16 a[20:21], v5 offset:43520
    v_mfma_f32_16x16x32_bf16 v[164:167], a[24:27], a[52:55], v[164:167]
    ds_read_b64_tr_b16 a[22:23], v5 offset:44608
    v_mfma_f32_16x16x32_bf16 v[168:171], a[24:27], a[56:59], v[168:171]
    buffer_load_dwordx4 a[44:47], v11, s[44:47], s69 offen sc1
    v_mfma_f32_16x16x32_bf16 v[172:175], a[24:27], a[60:63], v[172:175]
    v_mfma_f32_16x16x32_bf16 v[188:191], a[28:31], a[60:63], v[188:191]
    ds_read_b64_tr_b16 a[24:25], v5 offset:34848
    v_mfma_f32_16x16x32_bf16 v[184:187], a[28:31], a[56:59], v[184:187]
    s_add_u32 m0, s86, 62016
    ds_read_b64_tr_b16 a[26:27], v5 offset:35936
    v_mfma_f32_16x16x32_bf16 v[180:183], a[28:31], a[52:55], v[180:183]
    buffer_load_dwordx4 v27, s[56:59], s87 offen  lds
    v_mfma_f32_16x16x32_bf16 v[176:179], a[28:31], a[48:51], v[176:179]
    s_waitcnt lgkmcnt(6)
    v_mfma_f32_16x16x32_bf16 v[192:195], a[0:3], a[48:51], v[192:195]
    ds_read_b64_tr_b16 a[28:29], v5 offset:43552
    v_mfma_f32_16x16x32_bf16 v[196:199], a[0:3], a[52:55], v[196:199]
    s_mov_b32 s73, 0x50a000
    ds_read_b64_tr_b16 a[30:31], v5 offset:44640
    v_mfma_f32_16x16x32_bf16 v[200:203], a[0:3], a[56:59], v[200:203]
    buffer_store_dwordx4 a[244:247], v4, s[44:47], s73 offen sc1
    v_mfma_f32_16x16x32_bf16 v[204:207], a[0:3], a[60:63], v[204:207]
    v_mfma_f32_16x16x32_bf16 v[220:223], a[4:7], a[60:63], v[220:223]
    v_readlane_b32 s95, v2, 18
    ds_read_b64_tr_b16 a[0:1], v5 offset:34880
    v_mfma_f32_16x16x32_bf16 v[216:219], a[4:7], a[56:59], v[216:219]
    s_mov_b32 s90, s95
    ds_read_b64_tr_b16 a[2:3], v5 offset:35968
    v_mfma_f32_16x16x32_bf16 v[212:215], a[4:7], a[52:55], v[212:215]
    buffer_load_dwordx4 a[128:131], v22, s[36:39], s90 offen sc1
    v_mfma_f32_16x16x32_bf16 v[208:211], a[4:7], a[48:51], v[208:211]
    v_mfma_f32_16x16x32_bf16 v[224:227], a[8:11], a[48:51], v[224:227]
    ds_read_b64_tr_b16 a[4:5], v5 offset:43584
    v_mfma_f32_16x16x32_bf16 v[228:231], a[8:11], a[52:55], v[228:231]
    ds_read_b64_tr_b16 a[6:7], v5 offset:44672
    v_mfma_f32_16x16x32_bf16 v[232:235], a[8:11], a[56:59], v[232:235]
    buffer_load_dwordx4 a[132:135], v23, s[36:39], s90 offen sc1
    v_mfma_f32_16x16x32_bf16 v[236:239], a[8:11], a[60:63], v[236:239]
    v_mfma_f32_16x16x32_bf16 v[252:255], a[12:15], a[60:63], v[252:255]
    ds_read_b64_tr_b16 a[8:9], v5 offset:34912
    v_mfma_f32_16x16x32_bf16 v[248:251], a[12:15], a[56:59], v[248:251]
    ds_read_b64_tr_b16 a[10:11], v5 offset:36000
    v_mfma_f32_16x16x32_bf16 v[244:247], a[12:15], a[52:55], v[244:247]
    v_mfma_f32_16x16x32_bf16 v[240:243], a[12:15], a[48:51], v[240:243]
    s_waitcnt vmcnt(22) lgkmcnt(10)
    s_barrier
    v_mfma_f32_16x16x32_bf16 v[32:35], a[16:19], a[64:67], v[32:35]
    ds_read_b64_tr_b16 a[12:13], v5 offset:43616
    v_mfma_f32_16x16x32_bf16 v[36:39], a[16:19], a[68:71], v[36:39]
    ds_read_b64_tr_b16 a[14:15], v5 offset:44704
    v_mfma_f32_16x16x32_bf16 v[40:43], a[16:19], a[72:75], v[40:43]
    v_mfma_f32_16x16x32_bf16 v[44:47], a[16:19], a[76:79], v[44:47]
    v_mfma_f32_16x16x32_bf16 v[60:63], a[20:23], a[76:79], v[60:63]
    ds_read_b64_tr_b16 a[16:17], v5 offset:34944
    v_mfma_f32_16x16x32_bf16 v[56:59], a[20:23], a[72:75], v[56:59]
    s_add_u32 s69, s69, 5120
    ds_read_b64_tr_b16 a[18:19], v5 offset:36032
    v_mfma_f32_16x16x32_bf16 v[52:55], a[20:23], a[68:71], v[52:55]
    buffer_load_dwordx4 a[48:51], v8, s[44:47], s69 offen sc1
    v_mfma_f32_16x16x32_bf16 v[48:51], a[20:23], a[64:67], v[48:51]
    s_waitcnt lgkmcnt(6)
    v_mfma_f32_16x16x32_bf16 v[64:67], a[24:27], a[64:67], v[64:67]
    s_add_u32 s87, s87, 229376
    ds_read_b64_tr_b16 a[20:21], v5 offset:43648
    v_mfma_f32_16x16x32_bf16 v[68:71], a[24:27], a[68:71], v[68:71]
    s_add_u32 m0, s86, 69632
    ds_read_b64_tr_b16 a[22:23], v5 offset:44736
    v_mfma_f32_16x16x32_bf16 v[72:75], a[24:27], a[72:75], v[72:75]
    buffer_load_dwordx4 v26, s[52:55], s87 offen  lds
    v_mfma_f32_16x16x32_bf16 v[76:79], a[24:27], a[76:79], v[76:79]
    v_mfma_f32_16x16x32_bf16 v[92:95], a[28:31], a[76:79], v[92:95]
    ds_read_b64_tr_b16 a[24:25], v5 offset:34976
    v_mfma_f32_16x16x32_bf16 v[88:91], a[28:31], a[72:75], v[88:91]
    ds_read_b64_tr_b16 a[26:27], v5 offset:36064
    v_mfma_f32_16x16x32_bf16 v[84:87], a[28:31], a[68:71], v[84:87]
    buffer_load_dwordx4 a[52:55], v9, s[44:47], s69 offen sc1
    v_mfma_f32_16x16x32_bf16 v[80:83], a[28:31], a[64:67], v[80:83]
    v_mfma_f32_16x16x32_bf16 v[96:99], a[0:3], a[64:67], v[96:99]
    ds_read_b64_tr_b16 a[28:29], v5 offset:43680
    v_mfma_f32_16x16x32_bf16 v[100:103], a[0:3], a[68:71], v[100:103]
    s_add_u32 m0, s86, 70720
    ds_read_b64_tr_b16 a[30:31], v5 offset:44768
    v_mfma_f32_16x16x32_bf16 v[104:107], a[0:3], a[72:75], v[104:107]
    buffer_load_dwordx4 v27, s[52:55], s87 offen  lds
    v_mfma_f32_16x16x32_bf16 v[108:111], a[0:3], a[76:79], v[108:111]
    v_mfma_f32_16x16x32_bf16 v[124:127], a[4:7], a[76:79], v[124:127]
    ds_read_b64_tr_b16 a[0:1], v6 offset:34816
    v_mfma_f32_16x16x32_bf16 v[120:123], a[4:7], a[72:75], v[120:123]
    ds_read_b64_tr_b16 a[2:3], v6 offset:35904
    v_mfma_f32_16x16x32_bf16 v[116:119], a[4:7], a[68:71], v[116:119]
    buffer_load_dwordx4 a[56:59], v10, s[44:47], s69 offen sc1
    v_mfma_f32_16x16x32_bf16 v[112:115], a[4:7], a[64:67], v[112:115]
    s_waitcnt lgkmcnt(6)
    v_mfma_f32_16x16x32_bf16 v[128:131], a[8:11], a[64:67], v[128:131]
    ds_read_b64_tr_b16 a[4:5], v6 offset:43520
    v_mfma_f32_16x16x32_bf16 v[132:135], a[8:11], a[68:71], v[132:135]
    s_add_u32 m0, s86, 78336
    ds_read_b64_tr_b16 a[6:7], v6 offset:44608
    v_mfma_f32_16x16x32_bf16 v[136:139], a[8:11], a[72:75], v[136:139]
    buffer_load_dwordx4 v26, s[56:59], s87 offen  lds
    v_mfma_f32_16x16x32_bf16 v[140:143], a[8:11], a[76:79], v[140:143]
    v_mfma_f32_16x16x32_bf16 v[156:159], a[12:15], a[76:79], v[156:159]
    ds_read_b64_tr_b16 a[8:9], v5 offset:52224
    v_mfma_f32_16x16x32_bf16 v[152:155], a[12:15], a[72:75], v[152:155]
    ds_read_b64_tr_b16 a[10:11], v5 offset:53312
    v_mfma_f32_16x16x32_bf16 v[148:151], a[12:15], a[68:71], v[148:151]
    v_mfma_f32_16x16x32_bf16 v[144:147], a[12:15], a[64:67], v[144:147]
    v_mfma_f32_16x16x32_bf16 v[160:163], a[16:19], a[64:67], v[160:163]
    ds_read_b64_tr_b16 a[12:13], v5 offset:60928
    v_mfma_f32_16x16x32_bf16 v[164:167], a[16:19], a[68:71], v[164:167]
    ds_read_b64_tr_b16 a[14:15], v5 offset:62016
    v_mfma_f32_16x16x32_bf16 v[168:171], a[16:19], a[72:75], v[168:171]
    buffer_load_dwordx4 a[60:63], v11, s[44:47], s69 offen sc1
    v_mfma_f32_16x16x32_bf16 v[172:175], a[16:19], a[76:79], v[172:175]
    v_mfma_f32_16x16x32_bf16 v[188:191], a[20:23], a[76:79], v[188:191]
    ds_read_b64_tr_b16 a[16:17], v5 offset:52256
    v_mfma_f32_16x16x32_bf16 v[184:187], a[20:23], a[72:75], v[184:187]
    s_add_u32 m0, s86, 79424
    ds_read_b64_tr_b16 a[18:19], v5 offset:53344
    v_mfma_f32_16x16x32_bf16 v[180:183], a[20:23], a[68:71], v[180:183]
    buffer_load_dwordx4 v27, s[56:59], s87 offen  lds
    v_mfma_f32_16x16x32_bf16 v[176:179], a[20:23], a[64:67], v[176:179]
    s_waitcnt lgkmcnt(6)
    v_mfma_f32_16x16x32_bf16 v[192:195], a[24:27], a[64:67], v[192:195]
    ds_read_b64_tr_b16 a[20:21], v5 offset:60960
    v_mfma_f32_16x16x32_bf16 v[196:199], a[24:27], a[68:71], v[196:199]
    s_mov_b32 s73, 0x514000
    ds_read_b64_tr_b16 a[22:23], v5 offset:62048
    v_mfma_f32_16x16x32_bf16 v[200:203], a[24:27], a[72:75], v[200:203]
    buffer_store_dwordx4 a[248:251], v4, s[44:47], s73 offen sc1
    v_mfma_f32_16x16x32_bf16 v[204:207], a[24:27], a[76:79], v[204:207]
    v_mfma_f32_16x16x32_bf16 v[220:223], a[28:31], a[76:79], v[220:223]
    ds_read_b64_tr_b16 a[24:25], v5 offset:52288
    v_mfma_f32_16x16x32_bf16 v[216:219], a[28:31], a[72:75], v[216:219]
    ds_read_b64_tr_b16 a[26:27], v5 offset:53376
    v_mfma_f32_16x16x32_bf16 v[212:215], a[28:31], a[68:71], v[212:215]
    buffer_load_dwordx4 a[136:139], v24, s[36:39], s90 offen sc1
    v_mfma_f32_16x16x32_bf16 v[208:211], a[28:31], a[64:67], v[208:211]
    v_mfma_f32_16x16x32_bf16 v[224:227], a[0:3], a[64:67], v[224:227]
    ds_read_b64_tr_b16 a[28:29], v5 offset:60992
    v_mfma_f32_16x16x32_bf16 v[228:231], a[0:3], a[68:71], v[228:231]
    ds_read_b64_tr_b16 a[30:31], v5 offset:62080
    v_mfma_f32_16x16x32_bf16 v[232:235], a[0:3], a[72:75], v[232:235]
    buffer_load_dwordx4 a[140:143], v25, s[36:39], s90 offen sc1
    v_mfma_f32_16x16x32_bf16 v[236:239], a[0:3], a[76:79], v[236:239]
    v_mfma_f32_16x16x32_bf16 v[252:255], a[4:7], a[76:79], v[252:255]
    ds_read_b64_tr_b16 a[0:1], v5 offset:52320
    v_mfma_f32_16x16x32_bf16 v[248:251], a[4:7], a[72:75], v[248:251]
    ds_read_b64_tr_b16 a[2:3], v5 offset:53408
    v_mfma_f32_16x16x32_bf16 v[244:247], a[4:7], a[68:71], v[244:247]
    v_mfma_f32_16x16x32_bf16 v[240:243], a[4:7], a[64:67], v[240:243]
    s_waitcnt vmcnt(24) lgkmcnt(10)
    v_mfma_f32_16x16x32_bf16 v[32:35], a[8:11], a[80:83], v[32:35]
    ds_read_b64_tr_b16 a[4:5], v5 offset:61024
    v_mfma_f32_16x16x32_bf16 v[36:39], a[8:11], a[84:87], v[36:39]
    ds_read_b64_tr_b16 a[6:7], v5 offset:62112
    v_mfma_f32_16x16x32_bf16 v[40:43], a[8:11], a[88:91], v[40:43]
    v_mfma_f32_16x16x32_bf16 v[44:47], a[8:11], a[92:95], v[44:47]
    v_mfma_f32_16x16x32_bf16 v[60:63], a[12:15], a[92:95], v[60:63]
    ds_read_b64_tr_b16 a[8:9], v5 offset:52352
    v_mfma_f32_16x16x32_bf16 v[56:59], a[12:15], a[88:91], v[56:59]
    s_add_u32 s69, s69, 5120
    ds_read_b64_tr_b16 a[10:11], v5 offset:53440
    v_mfma_f32_16x16x32_bf16 v[52:55], a[12:15], a[84:87], v[52:55]
    buffer_load_dwordx4 a[64:67], v8, s[44:47], s69 offen sc1
    v_mfma_f32_16x16x32_bf16 v[48:51], a[12:15], a[80:83], v[48:51]
    s_waitcnt lgkmcnt(6)
    v_mfma_f32_16x16x32_bf16 v[64:67], a[16:19], a[80:83], v[64:67]
    s_add_u32 s87, s87, 229376
    ds_read_b64_tr_b16 a[12:13], v5 offset:61056
    v_mfma_f32_16x16x32_bf16 v[68:71], a[16:19], a[84:87], v[68:71]
    s_add_u32 m0, s86, 87040
    ds_read_b64_tr_b16 a[14:15], v5 offset:62144
    v_mfma_f32_16x16x32_bf16 v[72:75], a[16:19], a[88:91], v[72:75]
    buffer_load_dwordx4 v26, s[52:55], s87 offen  lds
    v_mfma_f32_16x16x32_bf16 v[76:79], a[16:19], a[92:95], v[76:79]
    v_mfma_f32_16x16x32_bf16 v[92:95], a[20:23], a[92:95], v[92:95]
    ds_read_b64_tr_b16 a[16:17], v5 offset:52384
    v_mfma_f32_16x16x32_bf16 v[88:91], a[20:23], a[88:91], v[88:91]
    ds_read_b64_tr_b16 a[18:19], v5 offset:53472
    v_mfma_f32_16x16x32_bf16 v[84:87], a[20:23], a[84:87], v[84:87]
    buffer_load_dwordx4 a[68:71], v9, s[44:47], s69 offen sc1
    v_mfma_f32_16x16x32_bf16 v[80:83], a[20:23], a[80:83], v[80:83]
    v_mfma_f32_16x16x32_bf16 v[96:99], a[24:27], a[80:83], v[96:99]
    ds_read_b64_tr_b16 a[20:21], v5 offset:61088
    v_mfma_f32_16x16x32_bf16 v[100:103], a[24:27], a[84:87], v[100:103]
    s_add_u32 m0, s86, 88128
    ds_read_b64_tr_b16 a[22:23], v5 offset:62176
    v_mfma_f32_16x16x32_bf16 v[104:107], a[24:27], a[88:91], v[104:107]
    buffer_load_dwordx4 v27, s[52:55], s87 offen  lds
    v_mfma_f32_16x16x32_bf16 v[108:111], a[24:27], a[92:95], v[108:111]
    v_mfma_f32_16x16x32_bf16 v[124:127], a[28:31], a[92:95], v[124:127]
    ds_read_b64_tr_b16 a[24:25], v6 offset:52224
    v_mfma_f32_16x16x32_bf16 v[120:123], a[28:31], a[88:91], v[120:123]
    ds_read_b64_tr_b16 a[26:27], v6 offset:53312
    v_mfma_f32_16x16x32_bf16 v[116:119], a[28:31], a[84:87], v[116:119]
    buffer_load_dwordx4 a[72:75], v10, s[44:47], s69 offen sc1
    v_mfma_f32_16x16x32_bf16 v[112:115], a[28:31], a[80:83], v[112:115]
    s_waitcnt lgkmcnt(6)
    v_mfma_f32_16x16x32_bf16 v[128:131], a[0:3], a[80:83], v[128:131]
    ds_read_b64_tr_b16 a[28:29], v6 offset:60928
    v_mfma_f32_16x16x32_bf16 v[132:135], a[0:3], a[84:87], v[132:135]
    s_add_u32 m0, s86, 95744
    ds_read_b64_tr_b16 a[30:31], v6 offset:62016
    v_mfma_f32_16x16x32_bf16 v[136:139], a[0:3], a[88:91], v[136:139]
    buffer_load_dwordx4 v26, s[56:59], s87 offen  lds
    v_mfma_f32_16x16x32_bf16 v[140:143], a[0:3], a[92:95], v[140:143]
    v_mfma_f32_16x16x32_bf16 v[156:159], a[4:7], a[92:95], v[156:159]
    v_add_u32 v5, 0xfffef000, v5
    ds_read_b64_tr_b16 a[0:1], v5 offset:0
    v_mfma_f32_16x16x32_bf16 v[152:155], a[4:7], a[88:91], v[152:155]
    ds_read_b64_tr_b16 a[2:3], v5 offset:1088
    v_mfma_f32_16x16x32_bf16 v[148:151], a[4:7], a[84:87], v[148:151]
    v_mfma_f32_16x16x32_bf16 v[144:147], a[4:7], a[80:83], v[144:147]
    v_mfma_f32_16x16x32_bf16 v[160:163], a[8:11], a[80:83], v[160:163]
    ds_read_b64_tr_b16 a[4:5], v5 offset:8704
    v_mfma_f32_16x16x32_bf16 v[164:167], a[8:11], a[84:87], v[164:167]
    ds_read_b64_tr_b16 a[6:7], v5 offset:9792
    v_mfma_f32_16x16x32_bf16 v[168:171], a[8:11], a[88:91], v[168:171]
    buffer_load_dwordx4 a[76:79], v11, s[44:47], s69 offen sc1
    v_mfma_f32_16x16x32_bf16 v[172:175], a[8:11], a[92:95], v[172:175]
    v_mfma_f32_16x16x32_bf16 v[188:191], a[12:15], a[92:95], v[188:191]
    ds_read_b64_tr_b16 a[8:9], v5 offset:32
    v_mfma_f32_16x16x32_bf16 v[184:187], a[12:15], a[88:91], v[184:187]
    s_add_u32 m0, s86, 96832
    ds_read_b64_tr_b16 a[10:11], v5 offset:1120
    v_mfma_f32_16x16x32_bf16 v[180:183], a[12:15], a[84:87], v[180:183]
    buffer_load_dwordx4 v27, s[56:59], s87 offen  lds
    v_mfma_f32_16x16x32_bf16 v[176:179], a[12:15], a[80:83], v[176:179]
    s_waitcnt lgkmcnt(6)
    v_mfma_f32_16x16x32_bf16 v[192:195], a[16:19], a[80:83], v[192:195]
    ds_read_b64_tr_b16 a[12:13], v5 offset:8736
    v_mfma_f32_16x16x32_bf16 v[196:199], a[16:19], a[84:87], v[196:199]
    s_mov_b32 s73, 0x51e000
    ds_read_b64_tr_b16 a[14:15], v5 offset:9824
    v_mfma_f32_16x16x32_bf16 v[200:203], a[16:19], a[88:91], v[200:203]
    buffer_store_dwordx4 a[252:255], v4, s[44:47], s73 offen sc1
    v_mfma_f32_16x16x32_bf16 v[204:207], a[16:19], a[92:95], v[204:207]
    v_mfma_f32_16x16x32_bf16 v[220:223], a[20:23], a[92:95], v[220:223]
    v_readlane_b32 s95, v2, 19
    ds_read_b64_tr_b16 a[16:17], v5 offset:64
    v_mfma_f32_16x16x32_bf16 v[216:219], a[20:23], a[88:91], v[216:219]
    s_mov_b32 s90, s95
    ds_read_b64_tr_b16 a[18:19], v5 offset:1152
    v_mfma_f32_16x16x32_bf16 v[212:215], a[20:23], a[84:87], v[212:215]
    buffer_load_dwordx4 a[144:147], v22, s[36:39], s90 offen sc1
    v_mfma_f32_16x16x32_bf16 v[208:211], a[20:23], a[80:83], v[208:211]
    v_mfma_f32_16x16x32_bf16 v[224:227], a[24:27], a[80:83], v[224:227]
    ds_read_b64_tr_b16 a[20:21], v5 offset:8768
    v_mfma_f32_16x16x32_bf16 v[228:231], a[24:27], a[84:87], v[228:231]
    ds_read_b64_tr_b16 a[22:23], v5 offset:9856
    v_mfma_f32_16x16x32_bf16 v[232:235], a[24:27], a[88:91], v[232:235]
    buffer_load_dwordx4 a[148:151], v23, s[36:39], s90 offen sc1
    v_mfma_f32_16x16x32_bf16 v[236:239], a[24:27], a[92:95], v[236:239]
    v_mfma_f32_16x16x32_bf16 v[252:255], a[28:31], a[92:95], v[252:255]
    ds_read_b64_tr_b16 a[24:25], v5 offset:96
    v_mfma_f32_16x16x32_bf16 v[248:251], a[28:31], a[88:91], v[248:251]
    ds_read_b64_tr_b16 a[26:27], v5 offset:1184
    v_mfma_f32_16x16x32_bf16 v[244:247], a[28:31], a[84:87], v[244:247]
    v_mfma_f32_16x16x32_bf16 v[240:243], a[28:31], a[80:83], v[240:243]
    s_cmp_lg_u32 s5, 3
    s_cbranch_scc1 L_ctb
    s_add_u32 s60, s6, L_g1_tail-L_pc
    s_addc_u32 s61, s7, 0
    s_mov_b32 s62, L_code_end-L_g1_tail
    s_mov_b32 s63, 0x20000
    s_lshl_b32 s100, s4, 7
    v_lshlrev_b32 v30, 12, v1
    buffer_load_dword v30, v30, s[60:63], s100 offen
L_ctb:
    s_waitcnt vmcnt(26) lgkmcnt(10)
    s_barrier
    v_mfma_f32_16x16x32_bf16 v[32:35], a[0:3], a[32:35], v[32:35]
    ds_read_b64_tr_b16 a[28:29], v5 offset:8800
    v_mfma_f32_16x16x32_bf16 v[36:39], a[0:3], a[36:39], v[36:39]
    ds_read_b64_tr_b16 a[30:31], v5 offset:9888
    v_mfma_f32_16x16x32_bf16 v[40:43], a[0:3], a[40:43], v[40:43]
    v_mfma_f32_16x16x32_bf16 v[44:47], a[0:3], a[44:47], v[44:47]
    v_mfma_f32_16x16x32_bf16 v[60:63], a[4:7], a[44:47], v[60:63]
    ds_read_b64_tr_b16 a[0:1], v5 offset:128
    v_mfma_f32_16x16x32_bf16 v[56:59], a[4:7], a[40:43], v[56:59]
    s_add_u32 s69, s69, 5120
    ds_read_b64_tr_b16 a[2:3], v5 offset:1216
    v_mfma_f32_16x16x32_bf16 v[52:55], a[4:7], a[36:39], v[52:55]
    buffer_load_dwordx4 a[80:83], v8, s[44:47], s69 offen sc1
    v_mfma_f32_16x16x32_bf16 v[48:51], a[4:7], a[32:35], v[48:51]
    s_waitcnt lgkmcnt(6)
    v_mfma_f32_16x16x32_bf16 v[64:67], a[8:11], a[32:35], v[64:67]
    ds_read_b64_tr_b16 a[4:5], v5 offset:8832
    v_mfma_f32_16x16x32_bf16 v[68:71], a[8:11], a[36:39], v[68:71]
    ds_read_b64_tr_b16 a[6:7], v5 offset:9920
    v_mfma_f32_16x16x32_bf16 v[72:75], a[8:11], a[40:43], v[72:75]
    buffer_load_dwordx4 a[84:87], v9, s[44:47], s69 offen sc1
    v_mfma_f32_16x16x32_bf16 v[76:79], a[8:11], a[44:47], v[76:79]
    v_mfma_f32_16x16x32_bf16 v[92:95], a[12:15], a[44:47], v[92:95]
    ds_read_b64_tr_b16 a[8:9], v5 offset:160
    v_mfma_f32_16x16x32_bf16 v[88:91], a[12:15], a[40:43], v[88:91]
    ds_read_b64_tr_b16 a[10:11], v5 offset:1248
    v_mfma_f32_16x16x32_bf16 v[84:87], a[12:15], a[36:39], v[84:87]
    buffer_load_dwordx4 a[88:91], v10, s[44:47], s69 offen sc1
    v_mfma_f32_16x16x32_bf16 v[80:83], a[12:15], a[32:35], v[80:83]
    v_mfma_f32_16x16x32_bf16 v[96:99], a[16:19], a[32:35], v[96:99]
    ds_read_b64_tr_b16 a[12:13], v5 offset:8864
    v_mfma_f32_16x16x32_bf16 v[100:103], a[16:19], a[36:39], v[100:103]
    ds_read_b64_tr_b16 a[14:15], v5 offset:9952
    v_mfma_f32_16x16x32_bf16 v[104:107], a[16:19], a[40:43], v[104:107]
    buffer_load_dwordx4 a[92:95], v11, s[44:47], s69 offen sc1
    v_mfma_f32_16x16x32_bf16 v[108:111], a[16:19], a[44:47], v[108:111]
    v_mfma_f32_16x16x32_bf16 v[124:127], a[20:23], a[44:47], v[124:127]
    s_add_u32 s87, s87, 229376
    v_add_u32 v6, 0xfffef000, v6
    ds_read_b64_tr_b16 a[16:17], v6 offset:0
    v_mfma_f32_16x16x32_bf16 v[120:123], a[20:23], a[40:43], v[120:123]
    s_add_u32 m0, s86, 104448
    ds_read_b64_tr_b16 a[18:19], v6 offset:1088
    v_mfma_f32_16x16x32_bf16 v[116:119], a[20:23], a[36:39], v[116:119]
    buffer_load_dwordx4 v26, s[52:55], s87 offen  lds
    v_mfma_f32_16x16x32_bf16 v[112:115], a[20:23], a[32:35], v[112:115]
    s_waitcnt lgkmcnt(6)
    v_mfma_f32_16x16x32_bf16 v[128:131], a[24:27], a[32:35], v[128:131]
    ds_read_b64_tr_b16 a[20:21], v6 offset:8704
    v_mfma_f32_16x16x32_bf16 v[132:135], a[24:27], a[36:39], v[132:135]
    s_add_u32 m0, s86, 105536
    ds_read_b64_tr_b16 a[22:23], v6 offset:9792
    v_mfma_f32_16x16x32_bf16 v[136:139], a[24:27], a[40:43], v[136:139]
    buffer_load_dwordx4 v27, s[52:55], s87 offen  lds
    v_mfma_f32_16x16x32_bf16 v[140:143], a[24:27], a[44:47], v[140:143]
    v_mfma_f32_16x16x32_bf16 v[156:159], a[28:31], a[44:47], v[156:159]
    ds_read_b64_tr_b16 a[24:25], v5 offset:17408
    v_mfma_f32_16x16x32_bf16 v[152:155], a[28:31], a[40:43], v[152:155]
    s_add_u32 m0, s86, 113152
    ds_read_b64_tr_b16 a[26:27], v5 offset:18496
    v_mfma_f32_16x16x32_bf16 v[148:151], a[28:31], a[36:39], v[148:151]
    buffer_load_dwordx4 v26, s[56:59], s87 offen  lds
    v_mfma_f32_16x16x32_bf16 v[144:147], a[28:31], a[32:35], v[144:147]
    v_mfma_f32_16x16x32_bf16 v[160:163], a[0:3], a[32:35], v[160:163]
    ds_read_b64_tr_b16 a[28:29], v5 offset:26112
    v_mfma_f32_16x16x32_bf16 v[164:167], a[0:3], a[36:39], v[164:167]
    s_add_u32 m0, s86, 114240
    ds_read_b64_tr_b16 a[30:31], v5 offset:27200
    v_mfma_f32_16x16x32_bf16 v[168:171], a[0:3], a[40:43], v[168:171]
    buffer_load_dwordx4 v27, s[56:59], s87 offen  lds
    v_mfma_f32_16x16x32_bf16 v[172:175], a[0:3], a[44:47], v[172:175]
    v_mfma_f32_16x16x32_bf16 v[188:191], a[4:7], a[44:47], v[188:191]
    s_add_u32 s87, s87, 229376
    ds_read_b64_tr_b16 a[0:1], v5 offset:17440
    v_mfma_f32_16x16x32_bf16 v[184:187], a[4:7], a[40:43], v[184:187]
    s_add_u32 m0, s86, 121856
    ds_read_b64_tr_b16 a[2:3], v5 offset:18528
    v_mfma_f32_16x16x32_bf16 v[180:183], a[4:7], a[36:39], v[180:183]
    buffer_load_dwordx4 v26, s[52:55], s87 offen  lds
    v_mfma_f32_16x16x32_bf16 v[176:179], a[4:7], a[32:35], v[176:179]
    s_waitcnt lgkmcnt(6)
    v_mfma_f32_16x16x32_bf16 v[192:195], a[8:11], a[32:35], v[192:195]
    ds_read_b64_tr_b16 a[4:5], v5 offset:26144
    v_mfma_f32_16x16x32_bf16 v[196:199], a[8:11], a[36:39], v[196:199]
    s_add_u32 m0, s86, 122944
    ds_read_b64_tr_b16 a[6:7], v5 offset:27232
    v_mfma_f32_16x16x32_bf16 v[200:203], a[8:11], a[40:43], v[200:203]
    buffer_load_dwordx4 v27, s[52:55], s87 offen  lds
    v_mfma_f32_16x16x32_bf16 v[204:207], a[8:11], a[44:47], v[204:207]
    v_mfma_f32_16x16x32_bf16 v[220:223], a[12:15], a[44:47], v[220:223]
    ds_read_b64_tr_b16 a[8:9], v5 offset:17472
    v_mfma_f32_16x16x32_bf16 v[216:219], a[12:15], a[40:43], v[216:219]
    s_add_u32 m0, s86, 130560
    ds_read_b64_tr_b16 a[10:11], v5 offset:18560
    v_mfma_f32_16x16x32_bf16 v[212:215], a[12:15], a[36:39], v[212:215]
    buffer_load_dwordx4 v26, s[56:59], s87 offen  lds
    v_mfma_f32_16x16x32_bf16 v[208:211], a[12:15], a[32:35], v[208:211]
    v_mfma_f32_16x16x32_bf16 v[224:227], a[16:19], a[32:35], v[224:227]
    ds_read_b64_tr_b16 a[12:13], v5 offset:26176
    v_mfma_f32_16x16x32_bf16 v[228:231], a[16:19], a[36:39], v[228:231]
    s_add_u32 m0, s86, 131648
    ds_read_b64_tr_b16 a[14:15], v5 offset:27264
    v_mfma_f32_16x16x32_bf16 v[232:235], a[16:19], a[40:43], v[232:235]
    buffer_load_dwordx4 v27, s[56:59], s87 offen  lds
    v_mfma_f32_16x16x32_bf16 v[236:239], a[16:19], a[44:47], v[236:239]
    v_mfma_f32_16x16x32_bf16 v[252:255], a[20:23], a[44:47], v[252:255]
    ds_read_b64_tr_b16 a[16:17], v5 offset:17504
    v_mfma_f32_16x16x32_bf16 v[248:251], a[20:23], a[40:43], v[248:251]
    ds_read_b64_tr_b16 a[18:19], v5 offset:18592
    v_mfma_f32_16x16x32_bf16 v[244:247], a[20:23], a[36:39], v[244:247]
    v_mfma_f32_16x16x32_bf16 v[240:243], a[20:23], a[32:35], v[240:243]
    s_waitcnt vmcnt(27) lgkmcnt(10)
    v_mfma_f32_16x16x32_bf16 v[32:35], a[24:27], a[48:51], v[32:35]
    ds_read_b64_tr_b16 a[20:21], v5 offset:26208
    v_mfma_f32_16x16x32_bf16 v[36:39], a[24:27], a[52:55], v[36:39]
    ds_read_b64_tr_b16 a[22:23], v5 offset:27296
    v_mfma_f32_16x16x32_bf16 v[40:43], a[24:27], a[56:59], v[40:43]
    s_mov_b32 s82, 0xbdd2d3e8
    v_mfma_f32_16x16x32_bf16 v[44:47], a[24:27], a[60:63], v[44:47]
    s_mov_b32 s83, 0xbdd2d3e8
    v_mfma_f32_16x16x32_bf16 v[60:63], a[28:31], a[60:63], v[60:63]
    ds_read_b64_tr_b16 a[24:25], v5 offset:17536
    v_mfma_f32_16x16x32_bf16 v[56:59], a[28:31], a[56:59], v[56:59]
    s_add_u32 s69, s69, 5120
    ds_read_b64_tr_b16 a[26:27], v5 offset:18624
    v_mfma_f32_16x16x32_bf16 v[52:55], a[28:31], a[52:55], v[52:55]
    buffer_load_dwordx4 a[32:35], v8, s[44:47], s69 offen sc1
    v_mfma_f32_16x16x32_bf16 v[48:51], a[28:31], a[48:51], v[48:51]
    s_mov_b32 s84, 1.0
    s_waitcnt lgkmcnt(6)
    v_mfma_f32_16x16x32_bf16 v[64:67], a[0:3], a[48:51], v[64:67]
    ds_read_b64_tr_b16 a[28:29], v5 offset:26240
    v_mfma_f32_16x16x32_bf16 v[68:71], a[0:3], a[52:55], v[68:71]
    ds_read_b64_tr_b16 a[30:31], v5 offset:27328
    v_mfma_f32_16x16x32_bf16 v[72:75], a[0:3], a[56:59], v[72:75]
    buffer_load_dwordx4 a[36:39], v9, s[44:47], s69 offen sc1
    v_mfma_f32_16x16x32_bf16 v[76:79], a[0:3], a[60:63], v[76:79]
    s_mov_b32 s85, 1.0
    v_mfma_f32_16x16x32_bf16 v[92:95], a[4:7], a[60:63], v[92:95]
    ds_read_b64_tr_b16 a[0:1], v5 offset:17568
    v_mfma_f32_16x16x32_bf16 v[88:91], a[4:7], a[56:59], v[88:91]
    ds_read_b64_tr_b16 a[2:3], v5 offset:18656
    v_mfma_f32_16x16x32_bf16 v[84:87], a[4:7], a[52:55], v[84:87]
    buffer_load_dwordx4 a[40:43], v10, s[44:47], s69 offen sc1
    v_mfma_f32_16x16x32_bf16 v[80:83], a[4:7], a[48:51], v[80:83]
    v_mov_b32 v12, 0xc0135761
    v_mfma_f32_16x16x32_bf16 v[96:99], a[8:11], a[48:51], v[96:99]
    ds_read_b64_tr_b16 a[4:5], v5 offset:26272
    v_mfma_f32_16x16x32_bf16 v[100:103], a[8:11], a[52:55], v[100:103]
    ds_read_b64_tr_b16 a[6:7], v5 offset:27360
    v_mfma_f32_16x16x32_bf16 v[104:107], a[8:11], a[56:59], v[104:107]
    buffer_load_dwordx4 a[44:47], v11, s[44:47], s69 offen sc1
    v_mfma_f32_16x16x32_bf16 v[108:111], a[8:11], a[60:63], v[108:111]
    v_mov_b32 v13, 0xc0135761
    v_mfma_f32_16x16x32_bf16 v[124:127], a[12:15], a[60:63], v[124:127]
    ds_read_b64_tr_b16 a[8:9], v6 offset:17408
    v_mfma_f32_16x16x32_bf16 v[120:123], a[12:15], a[56:59], v[120:123]
    ds_read_b64_tr_b16 a[10:11], v6 offset:18496
    v_mfma_f32_16x16x32_bf16 v[116:119], a[12:15], a[52:55], v[116:119]
    buffer_load_dwordx4 a[152:155], v24, s[36:39], s90 offen sc1
    v_mfma_f32_16x16x32_bf16 v[112:115], a[12:15], a[48:51], v[112:115]
    s_lshr_b32 s68, s92, 1
    s_waitcnt lgkmcnt(6)
    v_mfma_f32_16x16x32_bf16 v[128:131], a[16:19], a[48:51], v[128:131]
    ds_read_b64_tr_b16 a[12:13], v6 offset:26112
    v_mfma_f32_16x16x32_bf16 v[132:135], a[16:19], a[52:55], v[132:135]
    ds_read_b64_tr_b16 a[14:15], v6 offset:27200
    v_mfma_f32_16x16x32_bf16 v[136:139], a[16:19], a[56:59], v[136:139]
    buffer_load_dwordx4 a[156:159], v25, s[36:39], s90 offen sc1
    v_mfma_f32_16x16x32_bf16 v[140:143], a[16:19], a[60:63], v[140:143]
    s_mov_b32 s64, s31
    v_mfma_f32_16x16x32_bf16 v[156:159], a[20:23], a[60:63], v[156:159]
    ds_read_b64_tr_b16 a[16:17], v5 offset:34816
    v_mfma_f32_16x16x32_bf16 v[152:155], a[20:23], a[56:59], v[152:155]
    ds_read_b64_tr_b16 a[18:19], v5 offset:35904
    v_mfma_f32_16x16x32_bf16 v[148:151], a[20:23], a[52:55], v[148:151]
    v_and_b32 v29, 31, v1
    v_mfma_f32_16x16x32_bf16 v[144:147], a[20:23], a[48:51], v[144:147]
    v_lshlrev_b32 v29, 2, v29
    v_mfma_f32_16x16x32_bf16 v[160:163], a[24:27], a[48:51], v[160:163]
    v_readlane_b32 s95, v2, 20
    ds_read_b64_tr_b16 a[20:21], v5 offset:43520
    v_mfma_f32_16x16x32_bf16 v[164:167], a[24:27], a[52:55], v[164:167]
    s_mov_b32 s90, s95
    ds_read_b64_tr_b16 a[22:23], v5 offset:44608
    v_mfma_f32_16x16x32_bf16 v[168:171], a[24:27], a[56:59], v[168:171]
    buffer_load_dwordx4 a[160:163], v22, s[36:39], s90 offen sc1
    v_mfma_f32_16x16x32_bf16 v[172:175], a[24:27], a[60:63], v[172:175]
    s_lshl_b32 s66, s68, 5
    v_mfma_f32_16x16x32_bf16 v[188:191], a[28:31], a[60:63], v[188:191]
    ds_read_b64_tr_b16 a[24:25], v5 offset:34848
    v_mfma_f32_16x16x32_bf16 v[184:187], a[28:31], a[56:59], v[184:187]
    ds_read_b64_tr_b16 a[26:27], v5 offset:35936
    v_mfma_f32_16x16x32_bf16 v[180:183], a[28:31], a[52:55], v[180:183]
    buffer_load_dwordx4 a[164:167], v23, s[36:39], s90 offen sc1
    v_mfma_f32_16x16x32_bf16 v[176:179], a[28:31], a[48:51], v[176:179]
    s_add_u32 s66, s66, s64
    s_waitcnt lgkmcnt(6)
    v_mfma_f32_16x16x32_bf16 v[192:195], a[0:3], a[48:51], v[192:195]
    ds_read_b64_tr_b16 a[28:29], v5 offset:43552
    v_mfma_f32_16x16x32_bf16 v[196:199], a[0:3], a[52:55], v[196:199]
    ds_read_b64_tr_b16 a[30:31], v5 offset:44640
    v_mfma_f32_16x16x32_bf16 v[200:203], a[0:3], a[56:59], v[200:203]
    buffer_load_dwordx4 a[168:171], v24, s[36:39], s90 offen sc1
    v_mfma_f32_16x16x32_bf16 v[204:207], a[0:3], a[60:63], v[204:207]
    s_lshl_b32 s66, s66, 8
    v_mfma_f32_16x16x32_bf16 v[220:223], a[4:7], a[60:63], v[220:223]
    ds_read_b64_tr_b16 a[0:1], v5 offset:34880
    v_mfma_f32_16x16x32_bf16 v[216:219], a[4:7], a[56:59], v[216:219]
    ds_read_b64_tr_b16 a[2:3], v5 offset:35968
    v_mfma_f32_16x16x32_bf16 v[212:215], a[4:7], a[52:55], v[212:215]
    buffer_load_dwordx4 a[172:175], v25, s[36:39], s90 offen sc1
    v_mfma_f32_16x16x32_bf16 v[208:211], a[4:7], a[48:51], v[208:211]
    s_add_u32 s66, s66, 0x1740000
    v_mfma_f32_16x16x32_bf16 v[224:227], a[8:11], a[48:51], v[224:227]
    v_readlane_b32 s95, v2, 21
    ds_read_b64_tr_b16 a[4:5], v5 offset:43584
    v_mfma_f32_16x16x32_bf16 v[228:231], a[8:11], a[52:55], v[228:231]
    s_mov_b32 s90, s95
    ds_read_b64_tr_b16 a[6:7], v5 offset:44672
    v_mfma_f32_16x16x32_bf16 v[232:235], a[8:11], a[56:59], v[232:235]
    buffer_load_dwordx4 a[176:179], v22, s[36:39], s90 offen sc1
    v_mfma_f32_16x16x32_bf16 v[236:239], a[8:11], a[60:63], v[236:239]
    s_lshl_b32 s65, s68, 8
    v_mfma_f32_16x16x32_bf16 v[252:255], a[12:15], a[60:63], v[252:255]
    ds_read_b64_tr_b16 a[8:9], v5 offset:34912
    v_mfma_f32_16x16x32_bf16 v[248:251], a[12:15], a[56:59], v[248:251]
    ds_read_b64_tr_b16 a[10:11], v5 offset:36000
    v_mfma_f32_16x16x32_bf16 v[244:247], a[12:15], a[52:55], v[244:247]
    s_add_u32 s65, s65, 0x1750000
    v_mfma_f32_16x16x32_bf16 v[240:243], a[12:15], a[48:51], v[240:243]
    s_and_b32 s67, s71, 1
    s_waitcnt vmcnt(11) lgkmcnt(10)
    s_barrier
    v_mfma_f32_16x16x32_bf16 v[32:35], a[16:19], a[64:67], v[32:35]
    ds_read_b64_tr_b16 a[12:13], v5 offset:43616
    v_mfma_f32_16x16x32_bf16 v[36:39], a[16:19], a[68:71], v[36:39]
    ds_read_b64_tr_b16 a[14:15], v5 offset:44704
    v_mfma_f32_16x16x32_bf16 v[40:43], a[16:19], a[72:75], v[40:43]
    v_mov_b32 v7, s67
    v_mfma_f32_16x16x32_bf16 v[44:47], a[16:19], a[76:79], v[44:47]
    v_cmp_eq_u32 vcc, 1, v7
    v_mfma_f32_16x16x32_bf16 v[60:63], a[20:23], a[76:79], v[60:63]
    ds_read_b64_tr_b16 a[16:17], v5 offset:34944
    v_mfma_f32_16x16x32_bf16 v[56:59], a[20:23], a[72:75], v[56:59]
    s_add_u32 s69, s69, 5120
    ds_read_b64_tr_b16 a[18:19], v5 offset:36032
    v_mfma_f32_16x16x32_bf16 v[52:55], a[20:23], a[68:71], v[52:55]
    buffer_load_dwordx4 a[48:51], v8, s[44:47], s69 offen sc1
    v_mfma_f32_16x16x32_bf16 v[48:51], a[20:23], a[64:67], v[48:51]
    v_cndmask_b32 v26, v8, v10, vcc
    s_waitcnt lgkmcnt(6)
    v_mfma_f32_16x16x32_bf16 v[64:67], a[24:27], a[64:67], v[64:67]
    ds_read_b64_tr_b16 a[20:21], v5 offset:43648
    v_mfma_f32_16x16x32_bf16 v[68:71], a[24:27], a[68:71], v[68:71]
    ds_read_b64_tr_b16 a[22:23], v5 offset:44736
    v_mfma_f32_16x16x32_bf16 v[72:75], a[24:27], a[72:75], v[72:75]
    buffer_load_dwordx4 a[52:55], v9, s[44:47], s69 offen sc1
    v_mfma_f32_16x16x32_bf16 v[76:79], a[24:27], a[76:79], v[76:79]
    v_cndmask_b32 v27, v9, v11, vcc
    v_mfma_f32_16x16x32_bf16 v[92:95], a[28:31], a[76:79], v[92:95]
    ds_read_b64_tr_b16 a[24:25], v5 offset:34976
    v_mfma_f32_16x16x32_bf16 v[88:91], a[28:31], a[72:75], v[88:91]
    ds_read_b64_tr_b16 a[26:27], v5 offset:36064
    v_mfma_f32_16x16x32_bf16 v[84:87], a[28:31], a[68:71], v[84:87]
    buffer_load_dwordx4 a[56:59], v10, s[44:47], s69 offen sc1
    v_mfma_f32_16x16x32_bf16 v[80:83], a[28:31], a[64:67], v[80:83]
    v_mfma_f32_16x16x32_bf16 v[96:99], a[0:3], a[64:67], v[96:99]
    ds_read_b64_tr_b16 a[28:29], v5 offset:43680
    v_mfma_f32_16x16x32_bf16 v[100:103], a[0:3], a[68:71], v[100:103]
    ds_read_b64_tr_b16 a[30:31], v5 offset:44768
    v_mfma_f32_16x16x32_bf16 v[104:107], a[0:3], a[72:75], v[104:107]
    buffer_load_dwordx4 a[60:63], v11, s[44:47], s69 offen sc1
    v_mfma_f32_16x16x32_bf16 v[108:111], a[0:3], a[76:79], v[108:111]
    v_mfma_f32_16x16x32_bf16 v[124:127], a[4:7], a[76:79], v[124:127]
    ds_read_b64_tr_b16 a[0:1], v6 offset:34816
    v_mfma_f32_16x16x32_bf16 v[120:123], a[4:7], a[72:75], v[120:123]
    s_add_u32 s69, s69, 5120
    ds_read_b64_tr_b16 a[2:3], v6 offset:35904
    v_mfma_f32_16x16x32_bf16 v[116:119], a[4:7], a[68:71], v[116:119]
    buffer_load_dwordx4 a[96:99], v8, s[44:47], s69 offen sc1
    v_mfma_f32_16x16x32_bf16 v[112:115], a[4:7], a[64:67], v[112:115]
    s_waitcnt lgkmcnt(6)
    v_mfma_f32_16x16x32_bf16 v[128:131], a[8:11], a[64:67], v[128:131]
    ds_read_b64_tr_b16 a[4:5], v6 offset:43520
    v_mfma_f32_16x16x32_bf16 v[132:135], a[8:11], a[68:71], v[132:135]
    ds_read_b64_tr_b16 a[6:7], v6 offset:44608
    v_mfma_f32_16x16x32_bf16 v[136:139], a[8:11], a[72:75], v[136:139]
    buffer_load_dwordx4 a[100:103], v9, s[44:47], s69 offen sc1
    v_mfma_f32_16x16x32_bf16 v[140:143], a[8:11], a[76:79], v[140:143]
    v_mfma_f32_16x16x32_bf16 v[156:159], a[12:15], a[76:79], v[156:159]
    ds_read_b64_tr_b16 a[8:9], v5 offset:52224
    v_mfma_f32_16x16x32_bf16 v[152:155], a[12:15], a[72:75], v[152:155]
    ds_read_b64_tr_b16 a[10:11], v5 offset:53312
    v_mfma_f32_16x16x32_bf16 v[148:151], a[12:15], a[68:71], v[148:151]
    buffer_load_dwordx4 a[104:107], v10, s[44:47], s69 offen sc1
    v_mfma_f32_16x16x32_bf16 v[144:147], a[12:15], a[64:67], v[144:147]
    v_mfma_f32_16x16x32_bf16 v[160:163], a[16:19], a[64:67], v[160:163]
    ds_read_b64_tr_b16 a[12:13], v5 offset:60928
    v_mfma_f32_16x16x32_bf16 v[164:167], a[16:19], a[68:71], v[164:167]
    ds_read_b64_tr_b16 a[14:15], v5 offset:62016
    v_mfma_f32_16x16x32_bf16 v[168:171], a[16:19], a[72:75], v[168:171]
    buffer_load_dwordx4 a[108:111], v11, s[44:47], s69 offen sc1
    v_mfma_f32_16x16x32_bf16 v[172:175], a[16:19], a[76:79], v[172:175]
    v_mfma_f32_16x16x32_bf16 v[188:191], a[20:23], a[76:79], v[188:191]
    ds_read_b64_tr_b16 a[16:17], v5 offset:52256
    v_mfma_f32_16x16x32_bf16 v[184:187], a[20:23], a[72:75], v[184:187]
    s_add_u32 s69, s69, 5120
    ds_read_b64_tr_b16 a[18:19], v5 offset:53344
    v_mfma_f32_16x16x32_bf16 v[180:183], a[20:23], a[68:71], v[180:183]
    buffer_load_dwordx4 a[112:115], v8, s[44:47], s69 offen sc1
    v_mfma_f32_16x16x32_bf16 v[176:179], a[20:23], a[64:67], v[176:179]
    s_waitcnt lgkmcnt(6)
    v_mfma_f32_16x16x32_bf16 v[192:195], a[24:27], a[64:67], v[192:195]
    ds_read_b64_tr_b16 a[20:21], v5 offset:60960
    v_mfma_f32_16x16x32_bf16 v[196:199], a[24:27], a[68:71], v[196:199]
    ds_read_b64_tr_b16 a[22:23], v5 offset:62048
    v_mfma_f32_16x16x32_bf16 v[200:203], a[24:27], a[72:75], v[200:203]
    buffer_load_dwordx4 a[116:119], v9, s[44:47], s69 offen sc1
    v_mfma_f32_16x16x32_bf16 v[204:207], a[24:27], a[76:79], v[204:207]
    v_mfma_f32_16x16x32_bf16 v[220:223], a[28:31], a[76:79], v[220:223]
    ds_read_b64_tr_b16 a[24:25], v5 offset:52288
    v_mfma_f32_16x16x32_bf16 v[216:219], a[28:31], a[72:75], v[216:219]
    ds_read_b64_tr_b16 a[26:27], v5 offset:53376
    v_mfma_f32_16x16x32_bf16 v[212:215], a[28:31], a[68:71], v[212:215]
    buffer_load_dwordx4 a[120:123], v10, s[44:47], s69 offen sc1
    v_mfma_f32_16x16x32_bf16 v[208:211], a[28:31], a[64:67], v[208:211]
    v_mfma_f32_16x16x32_bf16 v[224:227], a[0:3], a[64:67], v[224:227]
    ds_read_b64_tr_b16 a[28:29], v5 offset:60992
    v_mfma_f32_16x16x32_bf16 v[228:231], a[0:3], a[68:71], v[228:231]
    ds_read_b64_tr_b16 a[30:31], v5 offset:62080
    v_mfma_f32_16x16x32_bf16 v[232:235], a[0:3], a[72:75], v[232:235]
    buffer_load_dwordx4 a[124:127], v11, s[44:47], s69 offen sc1
    v_mfma_f32_16x16x32_bf16 v[236:239], a[0:3], a[76:79], v[236:239]
    v_mfma_f32_16x16x32_bf16 v[252:255], a[4:7], a[76:79], v[252:255]
    ds_read_b64_tr_b16 a[0:1], v5 offset:52320
    v_mfma_f32_16x16x32_bf16 v[248:251], a[4:7], a[72:75], v[248:251]
    ds_read_b64_tr_b16 a[2:3], v5 offset:53408
    v_mfma_f32_16x16x32_bf16 v[244:247], a[4:7], a[68:71], v[244:247]
    v_mfma_f32_16x16x32_bf16 v[240:243], a[4:7], a[64:67], v[240:243]
    s_waitcnt vmcnt(31) lgkmcnt(10)
    v_mfma_f32_16x16x32_bf16 v[32:35], a[8:11], a[80:83], v[32:35]
    ds_read_b64_tr_b16 a[4:5], v5 offset:61024
    v_mfma_f32_16x16x32_bf16 v[36:39], a[8:11], a[84:87], v[36:39]
    ds_read_b64_tr_b16 a[6:7], v5 offset:62112
    v_mfma_f32_16x16x32_bf16 v[40:43], a[8:11], a[88:91], v[40:43]
    v_mfma_f32_16x16x32_bf16 v[44:47], a[8:11], a[92:95], v[44:47]
    v_mfma_f32_16x16x32_bf16 v[60:63], a[12:15], a[92:95], v[60:63]
    ds_read_b64_tr_b16 a[8:9], v5 offset:52352
    v_mfma_f32_16x16x32_bf16 v[56:59], a[12:15], a[88:91], v[56:59]
    ds_read_b64_tr_b16 a[10:11], v5 offset:53440
    v_mfma_f32_16x16x32_bf16 v[52:55], a[12:15], a[84:87], v[52:55]
    buffer_load_dwordx4 a[180:183], v23, s[36:39], s90 offen sc1
    v_mfma_f32_16x16x32_bf16 v[48:51], a[12:15], a[80:83], v[48:51]
    s_waitcnt lgkmcnt(6)
    v_mfma_f32_16x16x32_bf16 v[64:67], a[16:19], a[80:83], v[64:67]
    ds_read_b64_tr_b16 a[12:13], v5 offset:61056
    v_mfma_f32_16x16x32_bf16 v[68:71], a[16:19], a[84:87], v[68:71]
    ds_read_b64_tr_b16 a[14:15], v5 offset:62144
    v_mfma_f32_16x16x32_bf16 v[72:75], a[16:19], a[88:91], v[72:75]
    buffer_load_dwordx4 a[184:187], v24, s[36:39], s90 offen sc1
    v_mfma_f32_16x16x32_bf16 v[76:79], a[16:19], a[92:95], v[76:79]
    v_mfma_f32_16x16x32_bf16 v[92:95], a[20:23], a[92:95], v[92:95]
    ds_read_b64_tr_b16 a[16:17], v5 offset:52384
    v_mfma_f32_16x16x32_bf16 v[88:91], a[20:23], a[88:91], v[88:91]
    ds_read_b64_tr_b16 a[18:19], v5 offset:53472
    v_mfma_f32_16x16x32_bf16 v[84:87], a[20:23], a[84:87], v[84:87]
    buffer_load_dwordx4 a[188:191], v25, s[36:39], s90 offen sc1
    v_mfma_f32_16x16x32_bf16 v[80:83], a[20:23], a[80:83], v[80:83]
    v_mfma_f32_16x16x32_bf16 v[96:99], a[24:27], a[80:83], v[96:99]
    v_readlane_b32 s95, v2, 22
    ds_read_b64_tr_b16 a[20:21], v5 offset:61088
    v_mfma_f32_16x16x32_bf16 v[100:103], a[24:27], a[84:87], v[100:103]
    s_mov_b32 s90, s95
    ds_read_b64_tr_b16 a[22:23], v5 offset:62176
    v_mfma_f32_16x16x32_bf16 v[104:107], a[24:27], a[88:91], v[104:107]
    buffer_load_dwordx4 a[192:195], v22, s[36:39], s90 offen sc1
    v_mfma_f32_16x16x32_bf16 v[108:111], a[24:27], a[92:95], v[108:111]
    v_mfma_f32_16x16x32_bf16 v[124:127], a[28:31], a[92:95], v[124:127]
    ds_read_b64_tr_b16 a[24:25], v6 offset:52224
    v_mfma_f32_16x16x32_bf16 v[120:123], a[28:31], a[88:91], v[120:123]
    ds_read_b64_tr_b16 a[26:27], v6 offset:53312
    v_mfma_f32_16x16x32_bf16 v[116:119], a[28:31], a[84:87], v[116:119]
    buffer_load_dwordx4 a[196:199], v23, s[36:39], s90 offen sc1
    v_mfma_f32_16x16x32_bf16 v[112:115], a[28:31], a[80:83], v[112:115]
    s_waitcnt lgkmcnt(6)
    v_mfma_f32_16x16x32_bf16 v[128:131], a[0:3], a[80:83], v[128:131]
    ds_read_b64_tr_b16 a[28:29], v6 offset:60928
    v_mfma_f32_16x16x32_bf16 v[132:135], a[0:3], a[84:87], v[132:135]
    ds_read_b64_tr_b16 a[30:31], v6 offset:62016
    v_mfma_f32_16x16x32_bf16 v[136:139], a[0:3], a[88:91], v[136:139]
    buffer_load_dwordx4 a[200:203], v24, s[36:39], s90 offen sc1
    v_mfma_f32_16x16x32_bf16 v[140:143], a[0:3], a[92:95], v[140:143]
    v_mfma_f32_16x16x32_bf16 v[156:159], a[4:7], a[92:95], v[156:159]
    v_add_u32 v6, 0x11000, v6
    ds_read_b64_tr_b16 a[0:1], v6 offset:0
    v_mfma_f32_16x16x32_bf16 v[152:155], a[4:7], a[88:91], v[152:155]
    ds_read_b64_tr_b16 a[2:3], v6 offset:1088
    v_mfma_f32_16x16x32_bf16 v[148:151], a[4:7], a[84:87], v[148:151]
    v_mfma_f32_16x16x32_bf16 v[144:147], a[4:7], a[80:83], v[144:147]
    v_mfma_f32_16x16x32_bf16 v[160:163], a[8:11], a[80:83], v[160:163]
    ds_read_b64_tr_b16 a[4:5], v6 offset:8704
    v_mfma_f32_16x16x32_bf16 v[164:167], a[8:11], a[84:87], v[164:167]
    ds_read_b64_tr_b16 a[6:7], v6 offset:9792
    v_mfma_f32_16x16x32_bf16 v[168:171], a[8:11], a[88:91], v[168:171]
    buffer_load_dwordx4 a[204:207], v25, s[36:39], s90 offen sc1
    v_mfma_f32_16x16x32_bf16 v[172:175], a[8:11], a[92:95], v[172:175]
    v_mfma_f32_16x16x32_bf16 v[188:191], a[12:15], a[92:95], v[188:191]
    v_readlane_b32 s95, v2, 23
    ds_read_b64_tr_b16 a[8:9], v6 offset:17408
    v_mfma_f32_16x16x32_bf16 v[184:187], a[12:15], a[88:91], v[184:187]
    s_mov_b32 s90, s95
    ds_read_b64_tr_b16 a[10:11], v6 offset:18496
    v_mfma_f32_16x16x32_bf16 v[180:183], a[12:15], a[84:87], v[180:183]
    buffer_load_dwordx4 a[208:211], v22, s[36:39], s90 offen sc1
    v_mfma_f32_16x16x32_bf16 v[176:179], a[12:15], a[80:83], v[176:179]
    s_waitcnt lgkmcnt(6)
    v_mfma_f32_16x16x32_bf16 v[192:195], a[16:19], a[80:83], v[192:195]
    ds_read_b64_tr_b16 a[12:13], v6 offset:26112
    v_mfma_f32_16x16x32_bf16 v[196:199], a[16:19], a[84:87], v[196:199]
    ds_read_b64_tr_b16 a[14:15], v6 offset:27200
    v_mfma_f32_16x16x32_bf16 v[200:203], a[16:19], a[88:91], v[200:203]
    buffer_load_dwordx4 a[212:215], v23, s[36:39], s90 offen sc1
    v_mfma_f32_16x16x32_bf16 v[204:207], a[16:19], a[92:95], v[204:207]
    v_mfma_f32_16x16x32_bf16 v[220:223], a[20:23], a[92:95], v[220:223]
    ds_read_b64_tr_b16 a[16:17], v6 offset:34816
    v_mfma_f32_16x16x32_bf16 v[216:219], a[20:23], a[88:91], v[216:219]
    ds_read_b64_tr_b16 a[18:19], v6 offset:35904
    v_mfma_f32_16x16x32_bf16 v[212:215], a[20:23], a[84:87], v[212:215]
    buffer_load_dwordx4 a[216:219], v24, s[36:39], s90 offen sc1
    v_mfma_f32_16x16x32_bf16 v[208:211], a[20:23], a[80:83], v[208:211]
    v_mfma_f32_16x16x32_bf16 v[224:227], a[24:27], a[80:83], v[224:227]
    ds_read_b64_tr_b16 a[20:21], v6 offset:43520
    v_mfma_f32_16x16x32_bf16 v[228:231], a[24:27], a[84:87], v[228:231]
    ds_read_b64_tr_b16 a[22:23], v6 offset:44608
    v_mfma_f32_16x16x32_bf16 v[232:235], a[24:27], a[88:91], v[232:235]
    buffer_load_dwordx4 a[220:223], v25, s[36:39], s90 offen sc1
    v_mfma_f32_16x16x32_bf16 v[236:239], a[24:27], a[92:95], v[236:239]
    v_mfma_f32_16x16x32_bf16 v[252:255], a[28:31], a[92:95], v[252:255]
    ds_read_b64_tr_b16 a[24:25], v6 offset:52224
    v_mfma_f32_16x16x32_bf16 v[248:251], a[28:31], a[88:91], v[248:251]
    ds_read_b64_tr_b16 a[26:27], v6 offset:53312
    v_mfma_f32_16x16x32_bf16 v[244:247], a[28:31], a[84:87], v[244:247]
    v_mfma_f32_16x16x32_bf16 v[240:243], a[28:31], a[80:83], v[240:243]
L_g1_tail:
    s_waitcnt vmcnt(11) lgkmcnt(10)
    s_barrier
    v_mfma_f32_16x16x32_bf16 v[224:227], a[0:3], a[32:35], v[224:227]
    v_readlane_b32 s95, v2, 24
    ds_read_b64_tr_b16 a[28:29], v6 offset:60928
    v_mfma_f32_16x16x32_bf16 v[228:231], a[0:3], a[36:39], v[228:231]
    s_mov_b32 s90, s95
    ds_read_b64_tr_b16 a[30:31], v6 offset:62016
    v_mfma_f32_16x16x32_bf16 v[232:235], a[0:3], a[40:43], v[232:235]
    buffer_load_dwordx4 a[224:227], v22, s[36:39], s90 offen sc1
    v_mfma_f32_16x16x32_bf16 v[236:239], a[0:3], a[44:47], v[236:239]
    buffer_load_dwordx4 a[228:231], v23, s[36:39], s90 offen sc1
    v_mfma_f32_16x16x32_bf16 v[252:255], a[4:7], a[44:47], v[252:255]
    v_add_u32 v5, 0x11000, v5
    ds_read_b64_tr_b16 a[0:1], v5 offset:128
    v_mfma_f32_16x16x32_bf16 v[248:251], a[4:7], a[40:43], v[248:251]
    ds_read_b64_tr_b16 a[2:3], v5 offset:1216
    v_mfma_f32_16x16x32_bf16 v[244:247], a[4:7], a[36:39], v[244:247]
    buffer_load_dwordx4 a[232:235], v24, s[36:39], s90 offen sc1
    v_mfma_f32_16x16x32_bf16 v[240:243], a[4:7], a[32:35], v[240:243]
    s_waitcnt lgkmcnt(6)
    v_mfma_f32_16x16x32_bf16 v[224:227], a[8:11], a[48:51], v[224:227]
    ds_read_b64_tr_b16 a[4:5], v5 offset:8832
    v_mfma_f32_16x16x32_bf16 v[228:231], a[8:11], a[52:55], v[228:231]
    ds_read_b64_tr_b16 a[6:7], v5 offset:9920
    v_mfma_f32_16x16x32_bf16 v[232:235], a[8:11], a[56:59], v[232:235]
    buffer_load_dwordx4 a[236:239], v25, s[36:39], s90 offen sc1
    v_mfma_f32_16x16x32_bf16 v[236:239], a[8:11], a[60:63], v[236:239]
    v_readlane_b32 s95, v2, 9
    v_mfma_f32_16x16x32_bf16 v[252:255], a[12:15], a[60:63], v[252:255]
    s_mov_b32 s90, s95
    ds_read_b64_tr_b16 a[8:9], v5 offset:160
    v_mfma_f32_16x16x32_bf16 v[248:251], a[12:15], a[56:59], v[248:251]
    s_add_u32 m0, s89, 147456
    ds_read_b64_tr_b16 a[10:11], v5 offset:1248
    v_mfma_f32_16x16x32_bf16 v[244:247], a[12:15], a[52:55], v[244:247]
    buffer_load_dwordx4 v22, s[36:39], s90 offen sc1 lds
    v_mfma_f32_16x16x32_bf16 v[240:243], a[12:15], a[48:51], v[240:243]
    v_mfma_f32_16x16x32_bf16 v[224:227], a[16:19], a[96:99], v[224:227]
    ds_read_b64_tr_b16 a[12:13], v5 offset:8864
    v_mfma_f32_16x16x32_bf16 v[228:231], a[16:19], a[100:103], v[228:231]
    s_add_u32 m0, s89, 148480
    ds_read_b64_tr_b16 a[14:15], v5 offset:9952
    v_mfma_f32_16x16x32_bf16 v[232:235], a[16:19], a[104:107], v[232:235]
    buffer_load_dwordx4 v23, s[36:39], s90 offen sc1 lds
    v_mfma_f32_16x16x32_bf16 v[236:239], a[16:19], a[108:111], v[236:239]
    s_add_u32 m0, s89, 149504
    s_nop 0
    buffer_load_dwordx4 v24, s[36:39], s90 offen sc1 lds
    v_mfma_f32_16x16x32_bf16 v[252:255], a[20:23], a[108:111], v[252:255]
    ds_read_b64_tr_b16 a[16:17], v5 offset:17536
    v_mfma_f32_16x16x32_bf16 v[248:251], a[20:23], a[104:107], v[248:251]
    s_add_u32 m0, s89, 150528
    ds_read_b64_tr_b16 a[18:19], v5 offset:18624
    v_mfma_f32_16x16x32_bf16 v[244:247], a[20:23], a[100:103], v[244:247]
    buffer_load_dwordx4 v25, s[36:39], s90 offen sc1 lds
    v_mfma_f32_16x16x32_bf16 v[240:243], a[20:23], a[96:99], v[240:243]
    s_waitcnt lgkmcnt(6)
    v_mfma_f32_16x16x32_bf16 v[224:227], a[24:27], a[112:115], v[224:227]
    ds_read_b64_tr_b16 a[20:21], v5 offset:26240
    v_mfma_f32_16x16x32_bf16 v[228:231], a[24:27], a[116:119], v[228:231]
    v_readlane_b32 s95, v2, 25
    ds_read_b64_tr_b16 a[22:23], v5 offset:27328
    v_mfma_f32_16x16x32_bf16 v[232:235], a[24:27], a[120:123], v[232:235]
    s_mov_b32 s90, s95
    v_mfma_f32_16x16x32_bf16 v[236:239], a[24:27], a[124:127], v[236:239]
    buffer_load_dwordx4 a[240:243], v22, s[36:39], s90 offen sc1
    v_mfma_f32_16x16x32_bf16 v[252:255], a[28:31], a[124:127], v[252:255]
    ds_read_b64_tr_b16 a[24:25], v5 offset:17568
    v_mfma_f32_16x16x32_bf16 v[248:251], a[28:31], a[120:123], v[248:251]
    ds_read_b64_tr_b16 a[26:27], v5 offset:18656
    v_mfma_f32_16x16x32_bf16 v[244:247], a[28:31], a[116:119], v[244:247]
    buffer_load_dwordx4 a[244:247], v23, s[36:39], s90 offen sc1
    v_mfma_f32_16x16x32_bf16 v[240:243], a[28:31], a[112:115], v[240:243]
    v_mfma_f32_16x16x32_bf16 v[160:163], a[0:3], a[32:35], v[160:163]
    ds_read_b64_tr_b16 a[28:29], v5 offset:26272
    v_mfma_f32_16x16x32_bf16 v[164:167], a[0:3], a[36:39], v[164:167]
    ds_read_b64_tr_b16 a[30:31], v5 offset:27360
    v_mfma_f32_16x16x32_bf16 v[168:171], a[0:3], a[40:43], v[168:171]
    buffer_load_dwordx4 a[248:251], v24, s[36:39], s90 offen sc1
    v_mfma_f32_16x16x32_bf16 v[172:175], a[0:3], a[44:47], v[172:175]
    buffer_load_dwordx4 a[252:255], v25, s[36:39], s90 offen sc1
    v_mfma_f32_16x16x32_bf16 v[188:191], a[4:7], a[44:47], v[188:191]
    ds_read_b64_tr_b16 a[0:1], v5 offset:34944
    v_mul_f32 v14, v224, v224
    v_mul_f32 v15, v225, v225
    v_mul_f32 v16, v226, v226
    v_mfma_f32_16x16x32_bf16 v[184:187], a[4:7], a[40:43], v[184:187]
    ds_read_b64_tr_b16 a[2:3], v5 offset:36032
    v_mul_f32 v17, v227, v227
    v_mul_f32 v18, v228, v228
    v_mul_f32 v19, v229, v229
    v_mfma_f32_16x16x32_bf16 v[180:183], a[4:7], a[36:39], v[180:183]
    v_mul_f32 v20, v230, v230
    v_mul_f32 v21, v231, v231
    v_fma_f32 v14, v14, s82, v12
    v_fma_f32 v15, v15, s83, v13
    v_mfma_f32_16x16x32_bf16 v[176:179], a[4:7], a[32:35], v[176:179]
    v_readlane_b32 s95, v2, 0
    v_fma_f32 v16, v16, s82, v12
    v_fma_f32 v17, v17, s83, v13
    v_fma_f32 v18, v18, s82, v12
    s_waitcnt lgkmcnt(6)
    v_mfma_f32_16x16x32_bf16 v[192:195], a[8:11], a[32:35], v[192:195]
    s_mov_b32 s90, s95
    ds_read_b64_tr_b16 a[4:5], v5 offset:43648
    v_fma_f32 v19, v19, s83, v13
    v_fma_f32 v20, v20, s82, v12
    v_mfma_f32_16x16x32_bf16 v[196:199], a[8:11], a[36:39], v[196:199]
    s_add_u32 m0, s89, 0
    ds_read_b64_tr_b16 a[6:7], v5 offset:44736
    v_fma_f32 v21, v21, s83, v13
    v_mul_f32 v14, v14, v224
    v_mfma_f32_16x16x32_bf16 v[200:203], a[8:11], a[40:43], v[200:203]
    buffer_load_dwordx4 v22, s[36:39], s90 offen sc1 lds
    v_mul_f32 v15, v15, v225
    v_mul_f32 v16, v16, v226
    v_mfma_f32_16x16x32_bf16 v[204:207], a[8:11], a[44:47], v[204:207]
    s_add_u32 m0, s89, 1024
    s_nop 0
    buffer_load_dwordx4 v23, s[36:39], s90 offen sc1 lds
    v_mul_f32 v17, v17, v227
    v_mfma_f32_16x16x32_bf16 v[220:223], a[12:15], a[44:47], v[220:223]
    ds_read_b64_tr_b16 a[8:9], v5 offset:34976
    v_mul_f32 v18, v18, v228
    v_mul_f32 v19, v19, v229
    v_mul_f32 v20, v20, v230
    v_mfma_f32_16x16x32_bf16 v[216:219], a[12:15], a[40:43], v[216:219]
    s_add_u32 m0, s89, 2048
    ds_read_b64_tr_b16 a[10:11], v5 offset:36064
    v_mul_f32 v21, v21, v231
    v_exp_f32 v14, v14
    v_mfma_f32_16x16x32_bf16 v[212:215], a[12:15], a[36:39], v[212:215]
    buffer_load_dwordx4 v24, s[36:39], s90 offen sc1 lds
    v_exp_f32 v15, v15
    v_mfma_f32_16x16x32_bf16 v[208:211], a[12:15], a[32:35], v[208:211]
    v_exp_f32 v16, v16
    v_exp_f32 v17, v17
    v_mfma_f32_16x16x32_bf16 v[160:163], a[16:19], a[48:51], v[160:163]
    ds_read_b64_tr_b16 a[12:13], v5 offset:43680
    v_exp_f32 v18, v18
    v_exp_f32 v19, v19
    v_mfma_f32_16x16x32_bf16 v[164:167], a[16:19], a[52:55], v[164:167]
    s_add_u32 m0, s89, 3072
    ds_read_b64_tr_b16 a[14:15], v5 offset:44768
    v_exp_f32 v20, v20
    v_mfma_f32_16x16x32_bf16 v[168:171], a[16:19], a[56:59], v[168:171]
    buffer_load_dwordx4 v25, s[36:39], s90 offen sc1 lds
    v_exp_f32 v21, v21
    v_mfma_f32_16x16x32_bf16 v[172:175], a[16:19], a[60:63], v[172:175]
    v_readlane_b32 s95, v2, 1
    v_mul_f32 v224, v224, v240
    v_mul_f32 v225, v225, v241
    v_mul_f32 v226, v226, v242
    v_mfma_f32_16x16x32_bf16 v[188:191], a[20:23], a[60:63], v[188:191]
    s_mov_b32 s90, s95
    ds_read_b64_tr_b16 a[16:17], v5 offset:52352
    v_mul_f32 v227, v227, v243
    v_mul_f32 v228, v228, v244
    v_mfma_f32_16x16x32_bf16 v[184:187], a[20:23], a[56:59], v[184:187]
    s_add_u32 m0, s89, 16384
    ds_read_b64_tr_b16 a[18:19], v5 offset:53440
    v_mul_f32 v229, v229, v245
    v_mul_f32 v230, v230, v246
    v_mfma_f32_16x16x32_bf16 v[180:183], a[20:23], a[52:55], v[180:183]
    buffer_load_dwordx4 v22, s[36:39], s90 offen sc1 lds
    v_mul_f32 v231, v231, v247
    v_add_f32 v14, s84, v14
    v_mfma_f32_16x16x32_bf16 v[176:179], a[20:23], a[48:51], v[176:179]
    v_add_f32 v15, s85, v15
    v_add_f32 v16, s84, v16
    v_add_f32 v17, s85, v17
    v_add_f32 v18, s84, v18
    s_waitcnt lgkmcnt(6)
    v_mfma_f32_16x16x32_bf16 v[192:195], a[24:27], a[48:51], v[192:195]
    ds_read_b64_tr_b16 a[20:21], v5 offset:61056
    v_add_f32 v19, s85, v19
    v_add_f32 v20, s84, v20
    v_add_f32 v21, s85, v21
    v_mfma_f32_16x16x32_bf16 v[196:199], a[24:27], a[52:55], v[196:199]
    s_add_u32 m0, s89, 17408
    ds_read_b64_tr_b16 a[22:23], v5 offset:62144
    v_rcp_f32 v14, v14
    v_mfma_f32_16x16x32_bf16 v[200:203], a[24:27], a[56:59], v[200:203]
    buffer_load_dwordx4 v23, s[36:39], s90 offen sc1 lds
    v_rcp_f32 v15, v15
    v_mfma_f32_16x16x32_bf16 v[204:207], a[24:27], a[60:63], v[204:207]
    s_add_u32 m0, s89, 18432
    s_nop 0
    buffer_load_dwordx4 v24, s[36:39], s90 offen sc1 lds
    v_rcp_f32 v16, v16
    v_mfma_f32_16x16x32_bf16 v[220:223], a[28:31], a[60:63], v[220:223]
    ds_read_b64_tr_b16 a[24:25], v5 offset:52384
    v_rcp_f32 v17, v17
    v_rcp_f32 v18, v18
    v_mfma_f32_16x16x32_bf16 v[216:219], a[28:31], a[56:59], v[216:219]
    s_add_u32 m0, s89, 19456
    ds_read_b64_tr_b16 a[26:27], v5 offset:53472
    v_rcp_f32 v19, v19
    v_mfma_f32_16x16x32_bf16 v[212:215], a[28:31], a[52:55], v[212:215]
    buffer_load_dwordx4 v25, s[36:39], s90 offen sc1 lds
    v_rcp_f32 v20, v20
    v_mfma_f32_16x16x32_bf16 v[208:211], a[28:31], a[48:51], v[208:211]
    v_rcp_f32 v21, v21
    v_mul_f32 v224, v224, v14
    v_mul_f32 v225, v225, v15
    v_mfma_f32_16x16x32_bf16 v[160:163], a[0:3], a[96:99], v[160:163]
    v_readlane_b32 s95, v2, 2
    ds_read_b64_tr_b16 a[28:29], v5 offset:61088
    v_mul_f32 v226, v226, v16
    v_mul_f32 v227, v227, v17
    v_mfma_f32_16x16x32_bf16 v[164:167], a[0:3], a[100:103], v[164:167]
    s_mov_b32 s90, s95
    ds_read_b64_tr_b16 a[30:31], v5 offset:62176
    v_mul_f32 v228, v228, v18
    v_mul_f32 v229, v229, v19
    v_mfma_f32_16x16x32_bf16 v[168:171], a[0:3], a[104:107], v[168:171]
    s_add_u32 m0, s89, 32768
    v_mul_f32 v230, v230, v20
    v_mul_f32 v231, v231, v21
    v_cvt_pk_bf16_f32 v224, v224, v225
    v_mfma_f32_16x16x32_bf16 v[172:175], a[0:3], a[108:111], v[172:175]
    buffer_load_dwordx4 v22, s[36:39], s90 offen sc1 lds
    v_cvt_pk_bf16_f32 v225, v226, v227
    v_cvt_pk_bf16_f32 v226, v228, v229
    v_mfma_f32_16x16x32_bf16 v[188:191], a[4:7], a[108:111], v[188:191]
    ds_read_b64_tr_b16 a[0:1], v5 offset:64
    v_cvt_pk_bf16_f32 v227, v230, v231
    buffer_store_dwordx4 v[224:227], v26, s[44:47], s77 offen sc1
    v_mfma_f32_16x16x32_bf16 v[184:187], a[4:7], a[104:107], v[184:187]
    s_add_u32 m0, s89, 33792
    ds_read_b64_tr_b16 a[2:3], v5 offset:1152
    v_mul_f32 v14, v232, v232
    v_mul_f32 v15, v233, v233
    v_mfma_f32_16x16x32_bf16 v[180:183], a[4:7], a[100:103], v[180:183]
    buffer_load_dwordx4 v23, s[36:39], s90 offen sc1 lds
    v_mul_f32 v16, v234, v234
    v_mul_f32 v17, v235, v235
    v_mfma_f32_16x16x32_bf16 v[176:179], a[4:7], a[96:99], v[176:179]
    v_mul_f32 v18, v236, v236
    v_mul_f32 v19, v237, v237
    v_mul_f32 v20, v238, v238
    v_mul_f32 v21, v239, v239
    s_waitcnt lgkmcnt(6)
    v_mfma_f32_16x16x32_bf16 v[192:195], a[8:11], a[96:99], v[192:195]
    ds_read_b64_tr_b16 a[4:5], v5 offset:8768
    v_fma_f32 v14, v14, s82, v12
    v_fma_f32 v15, v15, s83, v13
    v_fma_f32 v16, v16, s82, v12
    v_mfma_f32_16x16x32_bf16 v[196:199], a[8:11], a[100:103], v[196:199]
    s_add_u32 m0, s89, 34816
    ds_read_b64_tr_b16 a[6:7], v5 offset:9856
    v_fma_f32 v17, v17, s83, v13
    v_fma_f32 v18, v18, s82, v12
    v_mfma_f32_16x16x32_bf16 v[200:203], a[8:11], a[104:107], v[200:203]
    buffer_load_dwordx4 v24, s[36:39], s90 offen sc1 lds
    v_fma_f32 v19, v19, s83, v13
    v_fma_f32 v20, v20, s82, v12
    v_mfma_f32_16x16x32_bf16 v[204:207], a[8:11], a[108:111], v[204:207]
    s_add_u32 m0, s89, 35840
    s_nop 0
    buffer_load_dwordx4 v25, s[36:39], s90 offen sc1 lds
    v_fma_f32 v21, v21, s83, v13
    v_mfma_f32_16x16x32_bf16 v[220:223], a[12:15], a[108:111], v[220:223]
    ds_read_b64_tr_b16 a[8:9], v5 offset:96
    v_mul_f32 v14, v14, v232
    v_mul_f32 v15, v15, v233
    v_mul_f32 v16, v16, v234
    v_mfma_f32_16x16x32_bf16 v[216:219], a[12:15], a[104:107], v[216:219]
    ds_read_b64_tr_b16 a[10:11], v5 offset:1184
    v_mul_f32 v17, v17, v235
    v_mul_f32 v18, v18, v236
    v_mul_f32 v19, v19, v237
    v_mfma_f32_16x16x32_bf16 v[212:215], a[12:15], a[100:103], v[212:215]
    v_mul_f32 v20, v20, v238
    v_mul_f32 v21, v21, v239
    v_exp_f32 v14, v14
    v_mfma_f32_16x16x32_bf16 v[208:211], a[12:15], a[96:99], v[208:211]
    v_readlane_b32 s95, v2, 3
    v_exp_f32 v15, v15
    v_exp_f32 v16, v16
    v_mfma_f32_16x16x32_bf16 v[160:163], a[16:19], a[112:115], v[160:163]
    s_mov_b32 s90, s95
    ds_read_b64_tr_b16 a[12:13], v5 offset:8800
    v_exp_f32 v17, v17
    v_mfma_f32_16x16x32_bf16 v[164:167], a[16:19], a[116:119], v[164:167]
    s_add_u32 m0, s89, 49152
    ds_read_b64_tr_b16 a[14:15], v5 offset:9888
    v_exp_f32 v18, v18
    v_mfma_f32_16x16x32_bf16 v[168:171], a[16:19], a[120:123], v[168:171]
    buffer_load_dwordx4 v22, s[36:39], s90 offen sc1 lds
    v_exp_f32 v19, v19
    v_mfma_f32_16x16x32_bf16 v[172:175], a[16:19], a[124:127], v[172:175]
    s_add_u32 m0, s89, 50176
    s_nop 0
    buffer_load_dwordx4 v23, s[36:39], s90 offen sc1 lds
    v_exp_f32 v20, v20
    v_mfma_f32_16x16x32_bf16 v[188:191], a[20:23], a[124:127], v[188:191]
    ds_read_b64_tr_b16 a[16:17], v5 offset:17472
    v_exp_f32 v21, v21
    v_mul_f32 v232, v232, v248
    v_mfma_f32_16x16x32_bf16 v[184:187], a[20:23], a[120:123], v[184:187]
    s_add_u32 m0, s89, 51200
    ds_read_b64_tr_b16 a[18:19], v5 offset:18560
    v_mul_f32 v233, v233, v249
    v_mul_f32 v234, v234, v250
    v_mfma_f32_16x16x32_bf16 v[180:183], a[20:23], a[116:119], v[180:183]
    buffer_load_dwordx4 v24, s[36:39], s90 offen sc1 lds
    v_mul_f32 v235, v235, v251
    v_mul_f32 v236, v236, v252
    v_mfma_f32_16x16x32_bf16 v[176:179], a[20:23], a[112:115], v[176:179]
    v_mul_f32 v237, v237, v253
    v_mul_f32 v238, v238, v254
    v_mul_f32 v239, v239, v255
    v_add_f32 v14, s84, v14
    s_waitcnt lgkmcnt(6)
    v_mfma_f32_16x16x32_bf16 v[192:195], a[24:27], a[112:115], v[192:195]
    ds_read_b64_tr_b16 a[20:21], v5 offset:26176
    v_add_f32 v15, s85, v15
    v_add_f32 v16, s84, v16
    v_add_f32 v17, s85, v17
    v_mfma_f32_16x16x32_bf16 v[196:199], a[24:27], a[116:119], v[196:199]
    s_add_u32 m0, s89, 52224
    ds_read_b64_tr_b16 a[22:23], v5 offset:27264
    v_add_f32 v18, s84, v18
    v_add_f32 v19, s85, v19
    v_mfma_f32_16x16x32_bf16 v[200:203], a[24:27], a[120:123], v[200:203]
    buffer_load_dwordx4 v25, s[36:39], s90 offen sc1 lds
    v_add_f32 v20, s84, v20
    v_add_f32 v21, s85, v21
    v_mfma_f32_16x16x32_bf16 v[204:207], a[24:27], a[124:127], v[204:207]
    v_rcp_f32 v14, v14
    v_rcp_f32 v15, v15
    v_mfma_f32_16x16x32_bf16 v[220:223], a[28:31], a[124:127], v[220:223]
    v_readlane_b32 s95, v2, 16
    ds_read_b64_tr_b16 a[24:25], v5 offset:17504
    v_rcp_f32 v16, v16
    v_mfma_f32_16x16x32_bf16 v[216:219], a[28:31], a[120:123], v[216:219]
    s_mov_b32 s90, s95
    ds_read_b64_tr_b16 a[26:27], v5 offset:18592
    v_rcp_f32 v17, v17
    v_mfma_f32_16x16x32_bf16 v[212:215], a[28:31], a[116:119], v[212:215]
    buffer_load_dwordx4 a[64:67], v22, s[36:39], s90 offen sc1
    v_rcp_f32 v18, v18
    v_mfma_f32_16x16x32_bf16 v[208:211], a[28:31], a[112:115], v[208:211]
    v_rcp_f32 v19, v19
    v_rcp_f32 v20, v20
    v_mfma_f32_16x16x32_bf16 v[96:99], a[0:3], a[32:35], v[96:99]
    ds_read_b64_tr_b16 a[28:29], v5 offset:26208
    v_rcp_f32 v21, v21
    v_mul_f32 v232, v232, v14
    v_mfma_f32_16x16x32_bf16 v[100:103], a[0:3], a[36:39], v[100:103]
    ds_read_b64_tr_b16 a[30:31], v5 offset:27296
    v_mul_f32 v233, v233, v15
    v_mul_f32 v234, v234, v16
    v_mul_f32 v235, v235, v17
    v_mfma_f32_16x16x32_bf16 v[104:107], a[0:3], a[40:43], v[104:107]
    buffer_load_dwordx4 a[68:71], v23, s[36:39], s90 offen sc1
    v_mul_f32 v236, v236, v18
    v_mul_f32 v237, v237, v19
    v_mfma_f32_16x16x32_bf16 v[108:111], a[0:3], a[44:47], v[108:111]
    buffer_load_dwordx4 a[72:75], v24, s[36:39], s90 offen sc1
    v_mul_f32 v238, v238, v20
    v_mul_f32 v239, v239, v21
    v_mfma_f32_16x16x32_bf16 v[124:127], a[4:7], a[44:47], v[124:127]
    ds_read_b64_tr_b16 a[0:1], v5 offset:34880
    v_cvt_pk_bf16_f32 v232, v232, v233
    v_cvt_pk_bf16_f32 v233, v234, v235
    v_cvt_pk_bf16_f32 v234, v236, v237
    v_mfma_f32_16x16x32_bf16 v[120:123], a[4:7], a[40:43], v[120:123]
    ds_read_b64_tr_b16 a[2:3], v5 offset:35968
    v_cvt_pk_bf16_f32 v235, v238, v239
    buffer_store_dwordx4 v[232:235], v27, s[44:47], s77 offen sc1
    v_mfma_f32_16x16x32_bf16 v[116:119], a[4:7], a[36:39], v[116:119]
    buffer_load_dwordx4 a[76:79], v25, s[36:39], s90 offen sc1
    v_mul_f32 v14, v160, v160
    v_mul_f32 v15, v161, v161
    v_mfma_f32_16x16x32_bf16 v[112:115], a[4:7], a[32:35], v[112:115]
    v_mul_f32 v16, v162, v162
    v_mul_f32 v17, v163, v163
    v_mul_f32 v18, v192, v192
    v_mul_f32 v19, v193, v193
    s_waitcnt lgkmcnt(6)
    v_mfma_f32_16x16x32_bf16 v[128:131], a[8:11], a[32:35], v[128:131]
    ds_read_b64_tr_b16 a[4:5], v5 offset:43584
    v_mul_f32 v20, v194, v194
    v_mul_f32 v21, v195, v195
    v_fma_f32 v14, v14, s82, v12
    v_mfma_f32_16x16x32_bf16 v[132:135], a[8:11], a[36:39], v[132:135]
    v_readlane_b32 s95, v2, 17
    ds_read_b64_tr_b16 a[6:7], v5 offset:44672
    v_fma_f32 v15, v15, s83, v13
    v_fma_f32 v16, v16, s82, v12
    v_mfma_f32_16x16x32_bf16 v[136:139], a[8:11], a[40:43], v[136:139]
    s_mov_b32 s90, s95
    v_fma_f32 v17, v17, s83, v13
    v_fma_f32 v18, v18, s82, v12
    v_fma_f32 v19, v19, s83, v13
    v_mfma_f32_16x16x32_bf16 v[140:143], a[8:11], a[44:47], v[140:143]
    buffer_load_dwordx4 a[80:83], v22, s[36:39], s90 offen sc1
    v_fma_f32 v20, v20, s82, v12
    v_fma_f32 v21, v21, s83, v13
    v_mfma_f32_16x16x32_bf16 v[156:159], a[12:15], a[44:47], v[156:159]
    ds_read_b64_tr_b16 a[8:9], v5 offset:34912
    v_mul_f32 v14, v14, v160
    v_mul_f32 v15, v15, v161
    v_mul_f32 v16, v16, v162
    v_mfma_f32_16x16x32_bf16 v[152:155], a[12:15], a[40:43], v[152:155]
    ds_read_b64_tr_b16 a[10:11], v5 offset:36000
    v_mul_f32 v17, v17, v163
    v_mul_f32 v18, v18, v192
    v_mul_f32 v19, v19, v193
    v_mfma_f32_16x16x32_bf16 v[148:151], a[12:15], a[36:39], v[148:151]
    buffer_load_dwordx4 a[84:87], v23, s[36:39], s90 offen sc1
    v_mul_f32 v20, v20, v194
    v_mul_f32 v21, v21, v195
    v_mfma_f32_16x16x32_bf16 v[144:147], a[12:15], a[32:35], v[144:147]
    v_exp_f32 v14, v14
    v_exp_f32 v15, v15
    v_mfma_f32_16x16x32_bf16 v[96:99], a[16:19], a[48:51], v[96:99]
    ds_read_b64_tr_b16 a[12:13], v5 offset:43616
    v_exp_f32 v16, v16
    v_exp_f32 v17, v17
    v_mfma_f32_16x16x32_bf16 v[100:103], a[16:19], a[52:55], v[100:103]
    ds_read_b64_tr_b16 a[14:15], v5 offset:44704
    v_exp_f32 v18, v18
    v_exp_f32 v19, v19
    v_mfma_f32_16x16x32_bf16 v[104:107], a[16:19], a[56:59], v[104:107]
    buffer_load_dwordx4 a[88:91], v24, s[36:39], s90 offen sc1
    v_exp_f32 v20, v20
    v_mfma_f32_16x16x32_bf16 v[108:111], a[16:19], a[60:63], v[108:111]
    buffer_load_dwordx4 a[92:95], v25, s[36:39], s90 offen sc1
    v_exp_f32 v21, v21
    v_mfma_f32_16x16x32_bf16 v[124:127], a[20:23], a[60:63], v[124:127]
    ds_read_b64_tr_b16 a[16:17], v5 offset:52288
    v_mul_f32 v160, v160, v176
    v_mul_f32 v161, v161, v177
    v_mul_f32 v162, v162, v178
    v_mfma_f32_16x16x32_bf16 v[120:123], a[20:23], a[56:59], v[120:123]
    ds_read_b64_tr_b16 a[18:19], v5 offset:53376
    v_mul_f32 v163, v163, v179
    v_mul_f32 v192, v192, v208
    v_mul_f32 v193, v193, v209
    v_mfma_f32_16x16x32_bf16 v[116:119], a[20:23], a[52:55], v[116:119]
    v_mul_f32 v194, v194, v210
    v_mul_f32 v195, v195, v211
    v_add_f32 v14, s84, v14
    v_add_f32 v15, s85, v15
    v_mfma_f32_16x16x32_bf16 v[112:115], a[20:23], a[48:51], v[112:115]
    v_add_f32 v16, s84, v16
    v_add_f32 v17, s85, v17
    v_add_f32 v18, s84, v18
    v_add_f32 v19, s85, v19
    s_waitcnt lgkmcnt(6)
    v_mfma_f32_16x16x32_bf16 v[128:131], a[24:27], a[48:51], v[128:131]
    ds_read_b64_tr_b16 a[20:21], v5 offset:60992
    v_add_f32 v20, s84, v20
    v_add_f32 v21, s85, v21
    v_rcp_f32 v14, v14
    v_mfma_f32_16x16x32_bf16 v[132:135], a[24:27], a[52:55], v[132:135]
    ds_read_b64_tr_b16 a[22:23], v5 offset:62080
    v_rcp_f32 v15, v15
    v_rcp_f32 v16, v16
    v_mfma_f32_16x16x32_bf16 v[136:139], a[24:27], a[56:59], v[136:139]
    v_rcp_f32 v17, v17
    v_rcp_f32 v18, v18
    v_mfma_f32_16x16x32_bf16 v[140:143], a[24:27], a[60:63], v[140:143]
    v_readlane_b32 s95, v2, 26
    s_nop 0
    s_mov_b32 s90, s95
    buffer_load_dwordx4 v[240:243], v22, s[36:39], s90 offen sc1
    v_rcp_f32 v19, v19
    v_mfma_f32_16x16x32_bf16 v[156:159], a[28:31], a[60:63], v[156:159]
    ds_read_b64_tr_b16 a[24:25], v5 offset:52320
    v_rcp_f32 v20, v20
    v_rcp_f32 v21, v21
    v_mfma_f32_16x16x32_bf16 v[152:155], a[28:31], a[56:59], v[152:155]
    ds_read_b64_tr_b16 a[26:27], v5 offset:53408
    v_mul_f32 v160, v160, v14
    v_mul_f32 v161, v161, v15
    v_mul_f32 v162, v162, v16
    v_mfma_f32_16x16x32_bf16 v[148:151], a[28:31], a[52:55], v[148:151]
    v_mul_f32 v163, v163, v17
    v_mul_f32 v192, v192, v18
    v_mul_f32 v193, v193, v19
    v_mul_f32 v194, v194, v20
    v_mfma_f32_16x16x32_bf16 v[144:147], a[28:31], a[48:51], v[144:147]
    v_mul_f32 v195, v195, v21
    v_cvt_pk_bf16_f32 v160, v160, v161
    v_cvt_pk_bf16_f32 v161, v162, v163
    v_cvt_pk_bf16_f32 v162, v192, v193
    v_mfma_f32_16x16x32_bf16 v[96:99], a[0:3], a[96:99], v[96:99]
    ds_read_b64_tr_b16 a[28:29], v5 offset:61024
    v_cvt_pk_bf16_f32 v163, v194, v195
    buffer_store_dwordx4 v[160:163], v8, s[44:47], s76 offen sc1
    v_mfma_f32_16x16x32_bf16 v[100:103], a[0:3], a[100:103], v[100:103]
    ds_read_b64_tr_b16 a[30:31], v5 offset:62112
    v_mul_f32 v14, v164, v164
    v_mul_f32 v15, v165, v165
    v_mul_f32 v16, v166, v166
    v_mfma_f32_16x16x32_bf16 v[104:107], a[0:3], a[104:107], v[104:107]
    v_mul_f32 v17, v167, v167
    v_mul_f32 v18, v196, v196
    v_mul_f32 v19, v197, v197
    v_mul_f32 v20, v198, v198
    v_mfma_f32_16x16x32_bf16 v[108:111], a[0:3], a[108:111], v[108:111]
    buffer_load_dwordx4 v[244:247], v23, s[36:39], s90 offen sc1
    v_mul_f32 v21, v199, v199
    v_fma_f32 v14, v14, s82, v12
    v_mfma_f32_16x16x32_bf16 v[124:127], a[4:7], a[108:111], v[124:127]
    ds_read_b64_tr_b16 a[0:1], v5 offset:0
    v_fma_f32 v15, v15, s83, v13
    v_fma_f32 v16, v16, s82, v12
    v_fma_f32 v17, v17, s83, v13
    v_mfma_f32_16x16x32_bf16 v[120:123], a[4:7], a[104:107], v[120:123]
    ds_read_b64_tr_b16 a[2:3], v5 offset:1088
    v_fma_f32 v18, v18, s82, v12
    v_fma_f32 v19, v19, s83, v13
    v_fma_f32 v20, v20, s82, v12
    v_mfma_f32_16x16x32_bf16 v[116:119], a[4:7], a[100:103], v[116:119]
    v_fma_f32 v21, v21, s83, v13
    v_mul_f32 v14, v14, v164
    v_mul_f32 v15, v15, v165
    v_mul_f32 v16, v16, v166
    v_mfma_f32_16x16x32_bf16 v[112:115], a[4:7], a[96:99], v[112:115]
    v_mul_f32 v17, v17, v167
    v_mul_f32 v18, v18, v196
    v_mul_f32 v19, v19, v197
    v_mul_f32 v20, v20, v198
    s_waitcnt lgkmcnt(6)
    v_mfma_f32_16x16x32_bf16 v[128:131], a[8:11], a[96:99], v[128:131]
    ds_read_b64_tr_b16 a[4:5], v5 offset:8704
    v_mul_f32 v21, v21, v199
    v_exp_f32 v14, v14
    v_mfma_f32_16x16x32_bf16 v[132:135], a[8:11], a[100:103], v[132:135]
    ds_read_b64_tr_b16 a[6:7], v5 offset:9792
    v_exp_f32 v15, v15
    v_exp_f32 v16, v16
    v_mfma_f32_16x16x32_bf16 v[136:139], a[8:11], a[104:107], v[136:139]
    v_exp_f32 v17, v17
    v_exp_f32 v18, v18
    v_mfma_f32_16x16x32_bf16 v[140:143], a[8:11], a[108:111], v[140:143]
    buffer_load_dwordx4 v[248:251], v24, s[36:39], s90 offen sc1
    v_exp_f32 v19, v19
    v_mfma_f32_16x16x32_bf16 v[156:159], a[12:15], a[108:111], v[156:159]
    ds_read_b64_tr_b16 a[8:9], v5 offset:32
    v_exp_f32 v20, v20
    v_exp_f32 v21, v21
    v_mfma_f32_16x16x32_bf16 v[152:155], a[12:15], a[104:107], v[152:155]
    ds_read_b64_tr_b16 a[10:11], v5 offset:1120
    v_mul_f32 v164, v164, v180
    v_mul_f32 v165, v165, v181
    v_mul_f32 v166, v166, v182
    v_mfma_f32_16x16x32_bf16 v[148:151], a[12:15], a[100:103], v[148:151]
    v_mul_f32 v167, v167, v183
    v_mul_f32 v196, v196, v212
    v_mul_f32 v197, v197, v213
    v_mul_f32 v198, v198, v214
    v_mfma_f32_16x16x32_bf16 v[144:147], a[12:15], a[96:99], v[144:147]
    v_mul_f32 v199, v199, v215
    v_add_f32 v14, s84, v14
    v_add_f32 v15, s85, v15
    v_add_f32 v16, s84, v16
    v_mfma_f32_16x16x32_bf16 v[96:99], a[16:19], a[112:115], v[96:99]
    ds_read_b64_tr_b16 a[12:13], v5 offset:8736
    v_add_f32 v17, s85, v17
    v_add_f32 v18, s84, v18
    v_add_f32 v19, s85, v19
    v_mfma_f32_16x16x32_bf16 v[100:103], a[16:19], a[116:119], v[100:103]
    ds_read_b64_tr_b16 a[14:15], v5 offset:9824
    v_add_f32 v20, s84, v20
    v_add_f32 v21, s85, v21
    v_rcp_f32 v14, v14
    v_mfma_f32_16x16x32_bf16 v[104:107], a[16:19], a[120:123], v[104:107]
    v_rcp_f32 v15, v15
    v_rcp_f32 v16, v16
    v_mfma_f32_16x16x32_bf16 v[108:111], a[16:19], a[124:127], v[108:111]
    buffer_load_dwordx4 v[252:255], v25, s[36:39], s90 offen sc1
    v_rcp_f32 v17, v17
    v_mfma_f32_16x16x32_bf16 v[124:127], a[20:23], a[124:127], v[124:127]
    ds_read_b64_tr_b16 a[16:17], v5 offset:17408
    v_rcp_f32 v18, v18
    v_rcp_f32 v19, v19
    v_mfma_f32_16x16x32_bf16 v[120:123], a[20:23], a[120:123], v[120:123]
    ds_read_b64_tr_b16 a[18:19], v5 offset:18496
    v_rcp_f32 v20, v20
    v_rcp_f32 v21, v21
    v_mfma_f32_16x16x32_bf16 v[116:119], a[20:23], a[116:119], v[116:119]
    v_mul_f32 v164, v164, v14
    v_mul_f32 v165, v165, v15
    v_mul_f32 v166, v166, v16
    v_mul_f32 v167, v167, v17
    v_mfma_f32_16x16x32_bf16 v[112:115], a[20:23], a[112:115], v[112:115]
    v_mul_f32 v196, v196, v18
    v_mul_f32 v197, v197, v19
    v_mul_f32 v198, v198, v20
    v_mul_f32 v199, v199, v21
    s_waitcnt lgkmcnt(6)
    v_mfma_f32_16x16x32_bf16 v[128:131], a[24:27], a[112:115], v[128:131]
    ds_read_b64_tr_b16 a[20:21], v5 offset:26112
    v_cvt_pk_bf16_f32 v164, v164, v165
    v_cvt_pk_bf16_f32 v165, v166, v167
    v_cvt_pk_bf16_f32 v166, v196, v197
    v_mfma_f32_16x16x32_bf16 v[132:135], a[24:27], a[116:119], v[132:135]
    ds_read_b64_tr_b16 a[22:23], v5 offset:27200
    v_cvt_pk_bf16_f32 v167, v198, v199
    buffer_store_dwordx4 v[164:167], v9, s[44:47], s76 offen sc1
    v_mfma_f32_16x16x32_bf16 v[136:139], a[24:27], a[120:123], v[136:139]
    v_mul_f32 v14, v168, v168
    v_mul_f32 v15, v169, v169
    v_mul_f32 v16, v170, v170
    v_mul_f32 v17, v171, v171
    v_mfma_f32_16x16x32_bf16 v[140:143], a[24:27], a[124:127], v[140:143]
    v_readlane_b32 s95, v2, 27
    s_nop 0
    s_mov_b32 s90, s95
    buffer_load_dwordx4 v[224:227], v22, s[36:39], s90 offen sc1
    v_mul_f32 v18, v200, v200
    v_mul_f32 v19, v201, v201
    v_mfma_f32_16x16x32_bf16 v[156:159], a[28:31], a[124:127], v[156:159]
    ds_read_b64_tr_b16 a[24:25], v5 offset:17440
    v_mul_f32 v20, v202, v202
    v_mul_f32 v21, v203, v203
    v_fma_f32 v14, v14, s82, v12
    v_mfma_f32_16x16x32_bf16 v[152:155], a[28:31], a[120:123], v[152:155]
    ds_read_b64_tr_b16 a[26:27], v5 offset:18528
    v_fma_f32 v15, v15, s83, v13
    v_fma_f32 v16, v16, s82, v12
    v_fma_f32 v17, v17, s83, v13
    v_mfma_f32_16x16x32_bf16 v[148:151], a[28:31], a[116:119], v[148:151]
    v_fma_f32 v18, v18, s82, v12
    v_fma_f32 v19, v19, s83, v13
    v_fma_f32 v20, v20, s82, v12
    v_fma_f32 v21, v21, s83, v13
    v_mfma_f32_16x16x32_bf16 v[144:147], a[28:31], a[112:115], v[144:147]
    v_mul_f32 v14, v14, v168
    v_mul_f32 v15, v15, v169
    v_mul_f32 v16, v16, v170
    v_mul_f32 v17, v17, v171
    v_mfma_f32_16x16x32_bf16 v[32:35], a[0:3], a[32:35], v[32:35]
    ds_read_b64_tr_b16 a[28:29], v5 offset:26144
    v_mul_f32 v18, v18, v200
    v_mul_f32 v19, v19, v201
    v_mul_f32 v20, v20, v202
    v_mfma_f32_16x16x32_bf16 v[36:39], a[0:3], a[36:39], v[36:39]
    ds_read_b64_tr_b16 a[30:31], v5 offset:27232
    v_mul_f32 v21, v21, v203
    v_exp_f32 v14, v14
    v_mfma_f32_16x16x32_bf16 v[40:43], a[0:3], a[40:43], v[40:43]
    v_exp_f32 v15, v15
    v_exp_f32 v16, v16
    v_mfma_f32_16x16x32_bf16 v[44:47], a[0:3], a[44:47], v[44:47]
    buffer_load_dwordx4 v[228:231], v23, s[36:39], s90 offen sc1
    v_exp_f32 v17, v17
    v_mfma_f32_16x16x32_bf16 v[60:63], a[4:7], a[44:47], v[60:63]
    ds_read_b64_tr_b16 a[0:1], v5 offset:34816
    v_exp_f32 v18, v18
    v_exp_f32 v19, v19
    v_mfma_f32_16x16x32_bf16 v[56:59], a[4:7], a[40:43], v[56:59]
    ds_read_b64_tr_b16 a[2:3], v5 offset:35904
    v_exp_f32 v20, v20
    v_exp_f32 v21, v21
    v_mfma_f32_16x16x32_bf16 v[52:55], a[4:7], a[36:39], v[52:55]
    v_mul_f32 v168, v168, v184
    v_mul_f32 v169, v169, v185
    v_mul_f32 v170, v170, v186
    v_mul_f32 v171, v171, v187
    v_mfma_f32_16x16x32_bf16 v[48:51], a[4:7], a[32:35], v[48:51]
    v_mul_f32 v200, v200, v216
    v_mul_f32 v201, v201, v217
    v_mul_f32 v202, v202, v218
    v_mul_f32 v203, v203, v219
    s_waitcnt lgkmcnt(6)
    v_mfma_f32_16x16x32_bf16 v[64:67], a[8:11], a[32:35], v[64:67]
    ds_read_b64_tr_b16 a[4:5], v5 offset:43520
    v_add_f32 v14, s84, v14
    v_add_f32 v15, s85, v15
    v_add_f32 v16, s84, v16
    v_mfma_f32_16x16x32_bf16 v[68:71], a[8:11], a[36:39], v[68:71]
    ds_read_b64_tr_b16 a[6:7], v5 offset:44608
    v_add_f32 v17, s85, v17
    v_add_f32 v18, s84, v18
    v_add_f32 v19, s85, v19
    v_mfma_f32_16x16x32_bf16 v[72:75], a[8:11], a[40:43], v[72:75]
    v_add_f32 v20, s84, v20
    v_add_f32 v21, s85, v21
    v_rcp_f32 v14, v14
    v_mfma_f32_16x16x32_bf16 v[76:79], a[8:11], a[44:47], v[76:79]
    buffer_load_dwordx4 v[232:235], v24, s[36:39], s90 offen sc1
    v_rcp_f32 v15, v15
    v_mfma_f32_16x16x32_bf16 v[92:95], a[12:15], a[44:47], v[92:95]
    ds_read_b64_tr_b16 a[8:9], v5 offset:34848
    v_rcp_f32 v16, v16
    v_rcp_f32 v17, v17
    v_mfma_f32_16x16x32_bf16 v[88:91], a[12:15], a[40:43], v[88:91]
    ds_read_b64_tr_b16 a[10:11], v5 offset:35936
    v_rcp_f32 v18, v18
    v_rcp_f32 v19, v19
    v_mfma_f32_16x16x32_bf16 v[84:87], a[12:15], a[36:39], v[84:87]
    v_rcp_f32 v20, v20
    v_rcp_f32 v21, v21
    v_mfma_f32_16x16x32_bf16 v[80:83], a[12:15], a[32:35], v[80:83]
    v_mul_f32 v168, v168, v14
    v_mul_f32 v169, v169, v15
    v_mul_f32 v170, v170, v16
    v_mul_f32 v171, v171, v17
    v_mfma_f32_16x16x32_bf16 v[32:35], a[16:19], a[48:51], v[32:35]
    ds_read_b64_tr_b16 a[12:13], v5 offset:43552
    v_mul_f32 v200, v200, v18
    v_mul_f32 v201, v201, v19
    v_mul_f32 v202, v202, v20
    v_mfma_f32_16x16x32_bf16 v[36:39], a[16:19], a[52:55], v[36:39]
    ds_read_b64_tr_b16 a[14:15], v5 offset:44640
    v_mul_f32 v203, v203, v21
    v_cvt_pk_bf16_f32 v168, v168, v169
    v_cvt_pk_bf16_f32 v169, v170, v171
    v_mfma_f32_16x16x32_bf16 v[40:43], a[16:19], a[56:59], v[40:43]
    v_cvt_pk_bf16_f32 v170, v200, v201
    v_cvt_pk_bf16_f32 v171, v202, v203
    buffer_store_dwordx4 v[168:171], v10, s[44:47], s76 offen sc1
    v_mfma_f32_16x16x32_bf16 v[44:47], a[16:19], a[60:63], v[44:47]
    buffer_load_dwordx4 v[236:239], v25, s[36:39], s90 offen sc1
    v_mul_f32 v14, v172, v172
    v_mul_f32 v15, v173, v173
    v_mfma_f32_16x16x32_bf16 v[60:63], a[20:23], a[60:63], v[60:63]
    ds_read_b64_tr_b16 a[16:17], v5 offset:52224
    v_mul_f32 v16, v174, v174
    v_mul_f32 v17, v175, v175
    v_mul_f32 v18, v204, v204
    v_mfma_f32_16x16x32_bf16 v[56:59], a[20:23], a[56:59], v[56:59]
    ds_read_b64_tr_b16 a[18:19], v5 offset:53312
    v_mul_f32 v19, v205, v205
    v_mul_f32 v20, v206, v206
    v_mul_f32 v21, v207, v207
    v_mfma_f32_16x16x32_bf16 v[52:55], a[20:23], a[52:55], v[52:55]
    v_fma_f32 v14, v14, s82, v12
    v_fma_f32 v15, v15, s83, v13
    v_fma_f32 v16, v16, s82, v12
    v_fma_f32 v17, v17, s83, v13
    v_mfma_f32_16x16x32_bf16 v[48:51], a[20:23], a[48:51], v[48:51]
    v_fma_f32 v18, v18, s82, v12
    v_fma_f32 v19, v19, s83, v13
    v_fma_f32 v20, v20, s82, v12
    v_fma_f32 v21, v21, s83, v13
    s_waitcnt lgkmcnt(6)
    v_mfma_f32_16x16x32_bf16 v[64:67], a[24:27], a[48:51], v[64:67]
    ds_read_b64_tr_b16 a[20:21], v5 offset:60928
    v_mul_f32 v14, v14, v172
    v_mul_f32 v15, v15, v173
    v_mul_f32 v16, v16, v174
    v_mfma_f32_16x16x32_bf16 v[68:71], a[24:27], a[52:55], v[68:71]
    ds_read_b64_tr_b16 a[22:23], v5 offset:62016
    v_mul_f32 v17, v17, v175
    v_mul_f32 v18, v18, v204
    v_mul_f32 v19, v19, v205
    v_mfma_f32_16x16x32_bf16 v[72:75], a[24:27], a[56:59], v[72:75]
    v_mul_f32 v20, v20, v206
    v_mul_f32 v21, v21, v207
    v_exp_f32 v14, v14
    v_mfma_f32_16x16x32_bf16 v[76:79], a[24:27], a[60:63], v[76:79]
    v_exp_f32 v15, v15
    v_exp_f32 v16, v16
    v_mfma_f32_16x16x32_bf16 v[92:95], a[28:31], a[60:63], v[92:95]
    ds_read_b64_tr_b16 a[24:25], v5 offset:52256
    v_exp_f32 v17, v17
    v_exp_f32 v18, v18
    v_mfma_f32_16x16x32_bf16 v[88:91], a[28:31], a[56:59], v[88:91]
    ds_read_b64_tr_b16 a[26:27], v5 offset:53344
    v_exp_f32 v19, v19
    v_exp_f32 v20, v20
    v_mfma_f32_16x16x32_bf16 v[84:87], a[28:31], a[52:55], v[84:87]
    v_exp_f32 v21, v21
    v_mul_f32 v172, v172, v188
    v_mul_f32 v173, v173, v189
    v_mfma_f32_16x16x32_bf16 v[80:83], a[28:31], a[48:51], v[80:83]
    v_mul_f32 v174, v174, v190
    v_mul_f32 v175, v175, v191
    v_mul_f32 v204, v204, v220
    v_mul_f32 v205, v205, v221
    v_mfma_f32_16x16x32_bf16 v[32:35], a[0:3], a[96:99], v[32:35]
    ds_read_b64_tr_b16 a[28:29], v5 offset:60960
    v_mul_f32 v206, v206, v222
    v_mul_f32 v207, v207, v223
    v_add_f32 v14, s84, v14
    v_mfma_f32_16x16x32_bf16 v[36:39], a[0:3], a[100:103], v[36:39]
    ds_read_b64_tr_b16 a[30:31], v5 offset:62048
    v_add_f32 v15, s85, v15
    v_add_f32 v16, s84, v16
    v_add_f32 v17, s85, v17
    v_mfma_f32_16x16x32_bf16 v[40:43], a[0:3], a[104:107], v[40:43]
    v_add_f32 v18, s84, v18
    v_add_f32 v19, s85, v19
    v_add_f32 v20, s84, v20
    v_add_f32 v21, s85, v21
    v_mfma_f32_16x16x32_bf16 v[44:47], a[0:3], a[108:111], v[44:47]
    v_rcp_f32 v14, v14
    v_rcp_f32 v15, v15
    v_mfma_f32_16x16x32_bf16 v[60:63], a[4:7], a[108:111], v[60:63]
    v_rcp_f32 v16, v16
    v_rcp_f32 v17, v17
    v_mfma_f32_16x16x32_bf16 v[56:59], a[4:7], a[104:107], v[56:59]
    v_rcp_f32 v18, v18
    v_rcp_f32 v19, v19
    v_mfma_f32_16x16x32_bf16 v[52:55], a[4:7], a[100:103], v[52:55]
    v_rcp_f32 v20, v20
    v_rcp_f32 v21, v21
    v_mfma_f32_16x16x32_bf16 v[48:51], a[4:7], a[96:99], v[48:51]
    v_mul_f32 v172, v172, v14
    v_mul_f32 v173, v173, v15
    v_mul_f32 v174, v174, v16
    v_mul_f32 v175, v175, v17
    s_waitcnt lgkmcnt(4)
    v_mfma_f32_16x16x32_bf16 v[64:67], a[8:11], a[96:99], v[64:67]
    v_mul_f32 v204, v204, v18
    v_mul_f32 v205, v205, v19
    v_mul_f32 v206, v206, v20
    v_mul_f32 v207, v207, v21
    v_mfma_f32_16x16x32_bf16 v[68:71], a[8:11], a[100:103], v[68:71]
    v_cvt_pk_bf16_f32 v172, v172, v173
    v_cvt_pk_bf16_f32 v173, v174, v175
    v_cvt_pk_bf16_f32 v174, v204, v205
    v_cvt_pk_bf16_f32 v175, v206, v207
    v_mfma_f32_16x16x32_bf16 v[72:75], a[8:11], a[104:107], v[72:75]
    buffer_store_dwordx4 v[172:175], v11, s[44:47], s76 offen sc1
    v_mfma_f32_16x16x32_bf16 v[76:79], a[8:11], a[108:111], v[76:79]
    v_mfma_f32_16x16x32_bf16 v[92:95], a[12:15], a[108:111], v[92:95]
    v_mfma_f32_16x16x32_bf16 v[88:91], a[12:15], a[104:107], v[88:91]
    v_mfma_f32_16x16x32_bf16 v[84:87], a[12:15], a[100:103], v[84:87]
    v_mfma_f32_16x16x32_bf16 v[80:83], a[12:15], a[96:99], v[80:83]
    v_mfma_f32_16x16x32_bf16 v[32:35], a[16:19], a[112:115], v[32:35]
    v_mfma_f32_16x16x32_bf16 v[36:39], a[16:19], a[116:119], v[36:39]
    v_mfma_f32_16x16x32_bf16 v[40:43], a[16:19], a[120:123], v[40:43]
    v_mfma_f32_16x16x32_bf16 v[44:47], a[16:19], a[124:127], v[44:47]
    v_mfma_f32_16x16x32_bf16 v[60:63], a[20:23], a[124:127], v[60:63]
    v_mfma_f32_16x16x32_bf16 v[56:59], a[20:23], a[120:123], v[56:59]
    v_mfma_f32_16x16x32_bf16 v[52:55], a[20:23], a[116:119], v[52:55]
    v_mfma_f32_16x16x32_bf16 v[48:51], a[20:23], a[112:115], v[48:51]
    s_waitcnt lgkmcnt(0)
    v_mfma_f32_16x16x32_bf16 v[64:67], a[24:27], a[112:115], v[64:67]
    v_mfma_f32_16x16x32_bf16 v[68:71], a[24:27], a[116:119], v[68:71]
    v_mfma_f32_16x16x32_bf16 v[72:75], a[24:27], a[120:123], v[72:75]
    v_mfma_f32_16x16x32_bf16 v[76:79], a[24:27], a[124:127], v[76:79]
    v_mfma_f32_16x16x32_bf16 v[92:95], a[28:31], a[124:127], v[92:95]
    v_mfma_f32_16x16x32_bf16 v[88:91], a[28:31], a[120:123], v[88:91]
    v_mfma_f32_16x16x32_bf16 v[84:87], a[28:31], a[116:119], v[84:87]
    v_mfma_f32_16x16x32_bf16 v[80:83], a[28:31], a[112:115], v[80:83]
    s_cmp_lg_u32 s2, 0
    s_cbranch_scc1 L_noepoch
    s_mov_b32 s64, 0x1700000
    s_mov_b64 exec, 1
    buffer_store_dword v28, off, s[44:47], s64 sc0 sc1
    s_mov_b64 exec, -1
L_noepoch:
    s_barrier
L_g1_epi:
    v_pk_mul_f32 v[14:15], v[96:97], v[96:97]
    v_pk_mul_f32 v[16:17], v[98:99], v[98:99]
    v_pk_mul_f32 v[18:19], v[128:129], v[128:129]
    v_pk_mul_f32 v[20:21], v[130:131], v[130:131]
    v_pk_fma_f32 v[14:15], v[14:15], s[82:83], v[12:13]
    v_pk_fma_f32 v[16:17], v[16:17], s[82:83], v[12:13]
    v_pk_fma_f32 v[18:19], v[18:19], s[82:83], v[12:13]
    v_pk_fma_f32 v[20:21], v[20:21], s[82:83], v[12:13]
    v_pk_mul_f32 v[14:15], v[14:15], v[96:97]
    v_pk_mul_f32 v[16:17], v[16:17], v[98:99]
    v_pk_mul_f32 v[18:19], v[18:19], v[128:129]
    v_pk_mul_f32 v[20:21], v[20:21], v[130:131]
    v_exp_f32 v14, v14
    v_exp_f32 v15, v15
    v_exp_f32 v16, v16
    v_exp_f32 v17, v17
    v_readlane_b32 s95, v2, 4
    s_nop 0
    s_mov_b32 s90, s95
    s_add_u32 m0, s89, 65536
    s_nop 0
    buffer_load_dwordx4 v22, s[36:39], s90 offen sc1 lds
    v_exp_f32 v18, v18
    v_exp_f32 v19, v19
    v_exp_f32 v20, v20
    v_exp_f32 v21, v21
    v_pk_mul_f32 v[96:97], v[96:97], v[112:113]
    v_pk_mul_f32 v[98:99], v[98:99], v[114:115]
    v_pk_mul_f32 v[128:129], v[128:129], v[144:145]
    v_pk_mul_f32 v[130:131], v[130:131], v[146:147]
    v_pk_add_f32 v[14:15], v[14:15], s[84:85]
    v_pk_add_f32 v[16:17], v[16:17], s[84:85]
    v_pk_add_f32 v[18:19], v[18:19], s[84:85]
    v_pk_add_f32 v[20:21], v[20:21], s[84:85]
    v_rcp_f32 v14, v14
    v_rcp_f32 v15, v15
    v_rcp_f32 v16, v16
    v_rcp_f32 v17, v17
    s_add_u32 m0, s89, 66560
    s_nop 0
    buffer_load_dwordx4 v23, s[36:39], s90 offen sc1 lds
    v_rcp_f32 v18, v18
    v_rcp_f32 v19, v19
    v_rcp_f32 v20, v20
    v_rcp_f32 v21, v21
    v_pk_mul_f32 v[96:97], v[96:97], v[14:15]
    v_pk_mul_f32 v[98:99], v[98:99], v[16:17]
    v_pk_mul_f32 v[128:129], v[128:129], v[18:19]
    v_pk_mul_f32 v[130:131], v[130:131], v[20:21]
    v_cvt_pk_bf16_f32 v96, v96, v97
    v_cvt_pk_bf16_f32 v97, v98, v99
    v_cvt_pk_bf16_f32 v98, v128, v129
    v_cvt_pk_bf16_f32 v99, v130, v131
    buffer_store_dwordx4 v[96:99], v8, s[44:47], s75 offen sc1
    v_pk_mul_f32 v[14:15], v[100:101], v[100:101]
    v_pk_mul_f32 v[16:17], v[102:103], v[102:103]
    v_pk_mul_f32 v[18:19], v[132:133], v[132:133]
    s_add_u32 m0, s89, 67584
    s_nop 0
    buffer_load_dwordx4 v24, s[36:39], s90 offen sc1 lds
    v_pk_mul_f32 v[20:21], v[134:135], v[134:135]
    v_pk_fma_f32 v[14:15], v[14:15], s[82:83], v[12:13]
    v_pk_fma_f32 v[16:17], v[16:17], s[82:83], v[12:13]
    v_pk_fma_f32 v[18:19], v[18:19], s[82:83], v[12:13]
    v_pk_fma_f32 v[20:21], v[20:21], s[82:83], v[12:13]
    v_pk_mul_f32 v[14:15], v[14:15], v[100:101]
    v_pk_mul_f32 v[16:17], v[16:17], v[102:103]
    v_pk_mul_f32 v[18:19], v[18:19], v[132:133]
    v_pk_mul_f32 v[20:21], v[20:21], v[134:135]
    v_exp_f32 v14, v14
    v_exp_f32 v15, v15
    v_exp_f32 v16, v16
    v_exp_f32 v17, v17
    v_exp_f32 v18, v18
    v_exp_f32 v19, v19
    v_exp_f32 v20, v20
    s_add_u32 m0, s89, 68608
    s_nop 0
    buffer_load_dwordx4 v25, s[36:39], s90 offen sc1 lds
    v_exp_f32 v21, v21
    v_pk_mul_f32 v[100:101], v[100:101], v[116:117]
    v_pk_mul_f32 v[102:103], v[102:103], v[118:119]
    v_pk_mul_f32 v[132:133], v[132:133], v[148:149]
    v_pk_mul_f32 v[134:135], v[134:135], v[150:151]
    v_pk_add_f32 v[14:15], v[14:15], s[84:85]
    v_pk_add_f32 v[16:17], v[16:17], s[84:85]
    v_pk_add_f32 v[18:19], v[18:19], s[84:85]
    v_pk_add_f32 v[20:21], v[20:21], s[84:85]
    v_rcp_f32 v14, v14
    v_rcp_f32 v15, v15
    v_rcp_f32 v16, v16
    v_rcp_f32 v17, v17
    v_rcp_f32 v18, v18
    v_rcp_f32 v19, v19
    v_rcp_f32 v20, v20
    v_readlane_b32 s95, v2, 5
    s_nop 0
    s_mov_b32 s90, s95
    s_add_u32 m0, s89, 81920
    s_nop 0
    buffer_load_dwordx4 v22, s[36:39], s90 offen sc1 lds
    v_rcp_f32 v21, v21
    v_pk_mul_f32 v[100:101], v[100:101], v[14:15]
    v_pk_mul_f32 v[102:103], v[102:103], v[16:17]
    v_pk_mul_f32 v[132:133], v[132:133], v[18:19]
    v_pk_mul_f32 v[134:135], v[134:135], v[20:21]
    v_cvt_pk_bf16_f32 v100, v100, v101
    v_cvt_pk_bf16_f32 v101, v102, v103
    v_cvt_pk_bf16_f32 v102, v132, v133
    v_cvt_pk_bf16_f32 v103, v134, v135
    s_waitcnt vmcnt(6)
    s_barrier
    s_cmp_lg_u32 s5, 1
    s_cbranch_scc1 L_sig4
    s_lshl_b32 s100, s72, 13
    s_lshl_b32 s101, s71, 2
    s_add_u32 s100, s100, s101
    s_add_u32 s100, s100, 0x1740000
    v_lshlrev_b32 v29, 8, v1
    s_mov_b32 exec_lo, 0xffffffff
    s_mov_b32 exec_hi, 0
    buffer_store_dword v28, v29, s[44:47], s100 offen sc1
    s_mov_b64 exec, -1
    v_and_b32 v29, 31, v1
    v_lshlrev_b32 v29, 2, v29
L_sig4:
    buffer_store_dwordx4 v[100:103], v9, s[44:47], s75 offen sc1
    v_pk_mul_f32 v[14:15], v[104:105], v[104:105]
    v_pk_mul_f32 v[16:17], v[106:107], v[106:107]
    v_pk_mul_f32 v[18:19], v[136:137], v[136:137]
    v_pk_mul_f32 v[20:21], v[138:139], v[138:139]
    v_pk_fma_f32 v[14:15], v[14:15], s[82:83], v[12:13]
    v_pk_fma_f32 v[16:17], v[16:17], s[82:83], v[12:13]
    s_add_u32 m0, s89, 82944
    s_nop 0
    buffer_load_dwordx4 v23, s[36:39], s90 offen sc1 lds
    v_pk_fma_f32 v[18:19], v[18:19], s[82:83], v[12:13]
    v_pk_fma_f32 v[20:21], v[20:21], s[82:83], v[12:13]
    v_pk_mul_f32 v[14:15], v[14:15], v[104:105]
    v_pk_mul_f32 v[16:17], v[16:17], v[106:107]
    v_pk_mul_f32 v[18:19], v[18:19], v[136:137]
    v_pk_mul_f32 v[20:21], v[20:21], v[138:139]
    v_exp_f32 v14, v14
    v_exp_f32 v15, v15
    v_exp_f32 v16, v16
    v_exp_f32 v17, v17
    v_exp_f32 v18, v18
    v_exp_f32 v19, v19
    v_exp_f32 v20, v20
    v_exp_f32 v21, v21
    v_pk_mul_f32 v[104:105], v[104:105], v[120:121]
    v_pk_mul_f32 v[106:107], v[106:107], v[122:123]
    s_add_u32 m0, s89, 83968
    s_nop 0
    buffer_load_dwordx4 v24, s[36:39], s90 offen sc1 lds
    v_pk_mul_f32 v[136:137], v[136:137], v[152:153]
    v_pk_mul_f32 v[138:139], v[138:139], v[154:155]
    v_pk_add_f32 v[14:15], v[14:15], s[84:85]
    v_pk_add_f32 v[16:17], v[16:17], s[84:85]
    v_pk_add_f32 v[18:19], v[18:19], s[84:85]
    v_pk_add_f32 v[20:21], v[20:21], s[84:85]
    v_rcp_f32 v14, v14
    v_rcp_f32 v15, v15
    v_rcp_f32 v16, v16
    v_rcp_f32 v17, v17
    v_rcp_f32 v18, v18
    v_rcp_f32 v19, v19
    v_rcp_f32 v20, v20
    v_rcp_f32 v21, v21
    v_pk_mul_f32 v[104:105], v[104:105], v[14:15]
    v_pk_mul_f32 v[106:107], v[106:107], v[16:17]
    s_add_u32 m0, s89, 84992
    s_nop 0
    buffer_load_dwordx4 v25, s[36:39], s90 offen sc1 lds
    v_pk_mul_f32 v[136:137], v[136:137], v[18:19]
    v_pk_mul_f32 v[138:139], v[138:139], v[20:21]
    v_cvt_pk_bf16_f32 v104, v104, v105
    v_cvt_pk_bf16_f32 v105, v106, v107
    v_cvt_pk_bf16_f32 v106, v136, v137
    v_cvt_pk_bf16_f32 v107, v138, v139
    buffer_store_dwordx4 v[104:107], v10, s[44:47], s75 offen sc1
    v_pk_mul_f32 v[14:15], v[108:109], v[108:109]
    v_pk_mul_f32 v[16:17], v[110:111], v[110:111]
    v_pk_mul_f32 v[18:19], v[140:141], v[140:141]
    v_pk_mul_f32 v[20:21], v[142:143], v[142:143]
    v_pk_fma_f32 v[14:15], v[14:15], s[82:83], v[12:13]
    v_pk_fma_f32 v[16:17], v[16:17], s[82:83], v[12:13]
    v_pk_fma_f32 v[18:19], v[18:19], s[82:83], v[12:13]
    v_pk_fma_f32 v[20:21], v[20:21], s[82:83], v[12:13]
    v_pk_mul_f32 v[14:15], v[14:15], v[108:109]
    v_readlane_b32 s95, v2, 6
    s_nop 0
    s_mov_b32 s90, s95
    s_add_u32 m0, s89, 98304
    s_nop 0
    buffer_load_dwordx4 v22, s[36:39], s90 offen sc1 lds
    v_pk_mul_f32 v[16:17], v[16:17], v[110:111]
    v_pk_mul_f32 v[18:19], v[18:19], v[140:141]
    v_pk_mul_f32 v[20:21], v[20:21], v[142:143]
    v_exp_f32 v14, v14
    v_exp_f32 v15, v15
    v_exp_f32 v16, v16
    v_exp_f32 v17, v17
    v_exp_f32 v18, v18
    v_exp_f32 v19, v19
    v_exp_f32 v20, v20
    v_exp_f32 v21, v21
    v_pk_mul_f32 v[108:109], v[108:109], v[124:125]
    v_pk_mul_f32 v[110:111], v[110:111], v[126:127]
    v_pk_mul_f32 v[140:141], v[140:141], v[156:157]
    v_pk_mul_f32 v[142:143], v[142:143], v[158:159]
    v_pk_add_f32 v[14:15], v[14:15], s[84:85]
    s_add_u32 m0, s89, 99328
    s_nop 0
    buffer_load_dwordx4 v23, s[36:39], s90 offen sc1 lds
    v_pk_add_f32 v[16:17], v[16:17], s[84:85]
    v_pk_add_f32 v[18:19], v[18:19], s[84:85]
    v_pk_add_f32 v[20:21], v[20:21], s[84:85]
    v_rcp_f32 v14, v14
    v_rcp_f32 v15, v15
    v_rcp_f32 v16, v16
    v_rcp_f32 v17, v17
    v_rcp_f32 v18, v18
    v_rcp_f32 v19, v19
    v_rcp_f32 v20, v20
    v_rcp_f32 v21, v21
    v_pk_mul_f32 v[108:109], v[108:109], v[14:15]
    v_pk_mul_f32 v[110:111], v[110:111], v[16:17]
    v_pk_mul_f32 v[140:141], v[140:141], v[18:19]
    v_pk_mul_f32 v[142:143], v[142:143], v[20:21]
    v_cvt_pk_bf16_f32 v108, v108, v109
    s_add_u32 m0, s89, 100352
    s_nop 0
    buffer_load_dwordx4 v24, s[36:39], s90 offen sc1 lds
    v_cvt_pk_bf16_f32 v109, v110, v111
    v_cvt_pk_bf16_f32 v110, v140, v141
    v_cvt_pk_bf16_f32 v111, v142, v143
    buffer_store_dwordx4 v[108:111], v11, s[44:47], s75 offen sc1
    v_pk_mul_f32 v[14:15], v[32:33], v[32:33]
    v_pk_mul_f32 v[16:17], v[34:35], v[34:35]
    v_pk_mul_f32 v[18:19], v[64:65], v[64:65]
    v_pk_mul_f32 v[20:21], v[66:67], v[66:67]
    v_pk_fma_f32 v[14:15], v[14:15], s[82:83], v[12:13]
    v_pk_fma_f32 v[16:17], v[16:17], s[82:83], v[12:13]
    v_pk_fma_f32 v[18:19], v[18:19], s[82:83], v[12:13]
    v_pk_fma_f32 v[20:21], v[20:21], s[82:83], v[12:13]
    v_pk_mul_f32 v[14:15], v[14:15], v[32:33]
    v_pk_mul_f32 v[16:17], v[16:17], v[34:35]
    v_pk_mul_f32 v[18:19], v[18:19], v[64:65]
    v_pk_mul_f32 v[20:21], v[20:21], v[66:67]
    s_add_u32 m0, s89, 101376
    s_nop 0
    buffer_load_dwordx4 v25, s[36:39], s90 offen sc1 lds
    v_exp_f32 v14, v14
    v_exp_f32 v15, v15
    v_exp_f32 v16, v16
    v_exp_f32 v17, v17
    v_exp_f32 v18, v18
    v_exp_f32 v19, v19
    v_exp_f32 v20, v20
    v_exp_f32 v21, v21
    v_pk_mul_f32 v[32:33], v[32:33], v[48:49]
    v_pk_mul_f32 v[34:35], v[34:35], v[50:51]
    v_pk_mul_f32 v[64:65], v[64:65], v[80:81]
    v_pk_mul_f32 v[66:67], v[66:67], v[82:83]
    v_pk_add_f32 v[14:15], v[14:15], s[84:85]
    v_pk_add_f32 v[16:17], v[16:17], s[84:85]
    v_pk_add_f32 v[18:19], v[18:19], s[84:85]
    v_pk_add_f32 v[20:21], v[20:21], s[84:85]
    v_rcp_f32 v14, v14
    v_rcp_f32 v15, v15
    v_rcp_f32 v16, v16
    v_rcp_f32 v17, v17
    v_rcp_f32 v18, v18
    v_rcp_f32 v19, v19
    v_rcp_f32 v20, v20
    v_rcp_f32 v21, v21
    v_pk_mul_f32 v[32:33], v[32:33], v[14:15]
    v_pk_mul_f32 v[34:35], v[34:35], v[16:17]
    v_pk_mul_f32 v[64:65], v[64:65], v[18:19]
    v_pk_mul_f32 v[66:67], v[66:67], v[20:21]
    v_cvt_pk_bf16_f32 v32, v32, v33
    v_cvt_pk_bf16_f32 v33, v34, v35
    v_cvt_pk_bf16_f32 v34, v64, v65
    v_cvt_pk_bf16_f32 v35, v66, v67
    buffer_store_dwordx4 v[32:35], v8, s[44:47], s74 offen sc1
    v_pk_mul_f32 v[14:15], v[36:37], v[36:37]
    v_pk_mul_f32 v[16:17], v[38:39], v[38:39]
    v_pk_mul_f32 v[18:19], v[68:69], v[68:69]
    v_pk_mul_f32 v[20:21], v[70:71], v[70:71]
    v_pk_fma_f32 v[14:15], v[14:15], s[82:83], v[12:13]
    v_pk_fma_f32 v[16:17], v[16:17], s[82:83], v[12:13]
    v_pk_fma_f32 v[18:19], v[18:19], s[82:83], v[12:13]
    v_pk_fma_f32 v[20:21], v[20:21], s[82:83], v[12:13]
    v_pk_mul_f32 v[14:15], v[14:15], v[36:37]
    v_pk_mul_f32 v[16:17], v[16:17], v[38:39]
    v_pk_mul_f32 v[18:19], v[18:19], v[68:69]
    v_pk_mul_f32 v[20:21], v[20:21], v[70:71]
    v_exp_f32 v14, v14
    v_exp_f32 v15, v15
    v_exp_f32 v16, v16
    v_exp_f32 v17, v17
    v_exp_f32 v18, v18
    v_exp_f32 v19, v19
    v_exp_f32 v20, v20
    v_exp_f32 v21, v21
    v_pk_mul_f32 v[36:37], v[36:37], v[52:53]
    v_pk_mul_f32 v[38:39], v[38:39], v[54:55]
    v_pk_mul_f32 v[68:69], v[68:69], v[84:85]
    v_pk_mul_f32 v[70:71], v[70:71], v[86:87]
    v_pk_add_f32 v[14:15], v[14:15], s[84:85]
    v_pk_add_f32 v[16:17], v[16:17], s[84:85]
    v_pk_add_f32 v[18:19], v[18:19], s[84:85]
    v_pk_add_f32 v[20:21], v[20:21], s[84:85]
    v_rcp_f32 v14, v14
    v_rcp_f32 v15, v15
    v_rcp_f32 v16, v16
    v_rcp_f32 v17, v17
    v_rcp_f32 v18, v18
    v_rcp_f32 v19, v19
    v_rcp_f32 v20, v20
    v_rcp_f32 v21, v21
    v_pk_mul_f32 v[36:37], v[36:37], v[14:15]
    v_pk_mul_f32 v[38:39], v[38:39], v[16:17]
    v_pk_mul_f32 v[68:69], v[68:69], v[18:19]
    v_pk_mul_f32 v[70:71], v[70:71], v[20:21]
    v_cvt_pk_bf16_f32 v36, v36, v37
    v_cvt_pk_bf16_f32 v37, v38, v39
    v_cvt_pk_bf16_f32 v38, v68, v69
    v_cvt_pk_bf16_f32 v39, v70, v71
    buffer_store_dwordx4 v[36:39], v9, s[44:47], s74 offen sc1
    v_pk_mul_f32 v[14:15], v[40:41], v[40:41]
    v_pk_mul_f32 v[16:17], v[42:43], v[42:43]
    v_pk_mul_f32 v[18:19], v[72:73], v[72:73]
    v_pk_mul_f32 v[20:21], v[74:75], v[74:75]
    v_pk_fma_f32 v[14:15], v[14:15], s[82:83], v[12:13]
    v_pk_fma_f32 v[16:17], v[16:17], s[82:83], v[12:13]
    v_pk_fma_f32 v[18:19], v[18:19], s[82:83], v[12:13]
    v_pk_fma_f32 v[20:21], v[20:21], s[82:83], v[12:13]
    v_pk_mul_f32 v[14:15], v[14:15], v[40:41]
    v_pk_mul_f32 v[16:17], v[16:17], v[42:43]
    v_pk_mul_f32 v[18:19], v[18:19], v[72:73]
    v_pk_mul_f32 v[20:21], v[20:21], v[74:75]
    v_exp_f32 v14, v14
    v_exp_f32 v15, v15
    v_exp_f32 v16, v16
    v_exp_f32 v17, v17
    v_exp_f32 v18, v18
    v_exp_f32 v19, v19
    v_exp_f32 v20, v20
    v_exp_f32 v21, v21
    v_pk_mul_f32 v[40:41], v[40:41], v[56:57]
    v_pk_mul_f32 v[42:43], v[42:43], v[58:59]
    v_pk_mul_f32 v[72:73], v[72:73], v[88:89]
    v_pk_mul_f32 v[74:75], v[74:75], v[90:91]
    v_pk_add_f32 v[14:15], v[14:15], s[84:85]
    v_pk_add_f32 v[16:17], v[16:17], s[84:85]
    v_pk_add_f32 v[18:19], v[18:19], s[84:85]
    v_pk_add_f32 v[20:21], v[20:21], s[84:85]
    v_rcp_f32 v14, v14
    v_rcp_f32 v15, v15
    v_rcp_f32 v16, v16
    v_rcp_f32 v17, v17
    v_rcp_f32 v18, v18
    v_rcp_f32 v19, v19
    v_rcp_f32 v20, v20
    v_rcp_f32 v21, v21
    v_pk_mul_f32 v[40:41], v[40:41], v[14:15]
    v_pk_mul_f32 v[42:43], v[42:43], v[16:17]
    v_pk_mul_f32 v[72:73], v[72:73], v[18:19]
    v_pk_mul_f32 v[74:75], v[74:75], v[20:21]
    v_cvt_pk_bf16_f32 v40, v40, v41
    v_cvt_pk_bf16_f32 v41, v42, v43
    v_cvt_pk_bf16_f32 v42, v72, v73
    v_cvt_pk_bf16_f32 v43, v74, v75
    buffer_load_dword v30, v29, s[44:47], s66 offen sc1
    buffer_store_dwordx4 v[40:43], v10, s[44:47], s74 offen sc1
    v_pk_mul_f32 v[14:15], v[44:45], v[44:45]
    v_pk_mul_f32 v[16:17], v[46:47], v[46:47]
    v_pk_mul_f32 v[18:19], v[76:77], v[76:77]
    v_pk_mul_f32 v[20:21], v[78:79], v[78:79]
    v_pk_fma_f32 v[14:15], v[14:15], s[82:83], v[12:13]
    v_pk_fma_f32 v[16:17], v[16:17], s[82:83], v[12:13]
    v_pk_fma_f32 v[18:19], v[18:19], s[82:83], v[12:13]
    v_pk_fma_f32 v[20:21], v[20:21], s[82:83], v[12:13]
    v_pk_mul_f32 v[14:15], v[14:15], v[44:45]
    v_pk_mul_f32 v[16:17], v[16:17], v[46:47]
    v_pk_mul_f32 v[18:19], v[18:19], v[76:77]
    v_pk_mul_f32 v[20:21], v[20:21], v[78:79]
    v_exp_f32 v14, v14
    v_exp_f32 v15, v15
    v_exp_f32 v16, v16
    v_exp_f32 v17, v17
    v_exp_f32 v18, v18
    v_exp_f32 v19, v19
    v_exp_f32 v20, v20
    v_exp_f32 v21, v21
    v_pk_mul_f32 v[44:45], v[44:45], v[60:61]
    v_pk_mul_f32 v[46:47], v[46:47], v[62:63]
    v_pk_mul_f32 v[76:77], v[76:77], v[92:93]
    v_pk_mul_f32 v[78:79], v[78:79], v[94:95]
    v_pk_add_f32 v[14:15], v[14:15], s[84:85]
    v_pk_add_f32 v[16:17], v[16:17], s[84:85]
    v_pk_add_f32 v[18:19], v[18:19], s[84:85]
    v_pk_add_f32 v[20:21], v[20:21], s[84:85]
    v_rcp_f32 v14, v14
    v_rcp_f32 v15, v15
    v_rcp_f32 v16, v16
    v_rcp_f32 v17, v17
    v_rcp_f32 v18, v18
    v_rcp_f32 v19, v19
    v_rcp_f32 v20, v20
    v_rcp_f32 v21, v21
    v_pk_mul_f32 v[44:45], v[44:45], v[14:15]
    v_pk_mul_f32 v[46:47], v[46:47], v[16:17]
    v_pk_mul_f32 v[76:77], v[76:77], v[18:19]
    v_pk_mul_f32 v[78:79], v[78:79], v[20:21]
    v_cvt_pk_bf16_f32 v44, v44, v45
    v_cvt_pk_bf16_f32 v45, v46, v47
    v_cvt_pk_bf16_f32 v46, v76, v77
    v_cvt_pk_bf16_f32 v47, v78, v79
    buffer_store_dwordx4 v[44:47], v11, s[44:47], s74 offen sc1
    s_and_b32 s64, s3, 1
    s_lshl_b32 s64, s64, 1
    s_lshr_b32 s67, s5, 1
    s_add_u32 s64, s64, s67
    s_lshl_b32 s67, s67, 13
    s_lshl_b32 s68, s64, 6
    v_lshrrev_b32 v3, 2, v1
    v_lshlrev_b32 v4, 8, v3
    v_and_b32 v5, 3, v1
    v_lshl_add_u32 v4, v5, 3, v4
    v_add_u32 v4, s67, v4
    v_and_b32 v3, 7, v3
    v_lshlrev_b32 v3, 5, v3
    v_xor_b32 v3, s68, v3
    v_xor_b32 v5, 0, v3
    v_add_u32 v12, v4, v5
    v_xor_b32 v5, 32, v3
    v_add_u32 v13, v4, v5
    v_xor_b32 v5, 64, v3
    v_add_u32 v14, v4, v5
    v_xor_b32 v5, 96, v3
    v_add_u32 v15, v4, v5
    v_xor_b32 v5, 128, v3
    v_add_u32 v16, v4, v5
    v_xor_b32 v5, 160, v3
    v_add_u32 v17, v4, v5
    v_xor_b32 v5, 192, v3
    v_add_u32 v18, v4, v5
    v_xor_b32 v5, 224, v3
    v_add_u32 v19, v4, v5
    ds_read_b64_tr_b16 a[0:1], v12 offset:0
    ds_read_b64_tr_b16 a[2:3], v12 offset:4096
    ds_read_b64_tr_b16 a[4:5], v13 offset:0
    ds_read_b64_tr_b16 a[6:7], v13 offset:4096
    ds_read_b64_tr_b16 a[8:9], v14 offset:0
    ds_read_b64_tr_b16 a[10:11], v14 offset:4096
    ds_read_b64_tr_b16 a[12:13], v15 offset:0
    ds_read_b64_tr_b16 a[14:15], v15 offset:4096
    ds_read_b64_tr_b16 a[16:17], v16 offset:0
    ds_read_b64_tr_b16 a[18:19], v16 offset:4096
    ds_read_b64_tr_b16 a[20:21], v17 offset:0
    ds_read_b64_tr_b16 a[22:23], v17 offset:4096
    s_mov_b32 s101, 0
    s_waitcnt vmcnt(2)
L_poll4:
    v_cmp_ne_u32 vcc, s34, v30
    s_nop 4
    s_cbranch_vccz L_got4
    buffer_load_dword v30, v29, s[44:47], s66 offen sc1
    s_add_u32 s101, s101, 1
    s_cmp_lt_u32 s101, 0x8000
    s_waitcnt vmcnt(0)
    s_cbranch_scc1 L_poll4
L_got4:
    s_add_u32 s69, s30, 0
    buffer_load_dwordx4 a[32:35], v8, s[44:47], s69 offen sc1
    buffer_load_dwordx4 a[36:39], v9, s[44:47], s69 offen sc1
    buffer_load_dwordx4 a[40:43], v10, s[44:47], s69 offen sc1
    buffer_load_dwordx4 a[44:47], v11, s[44:47], s69 offen sc1
    s_add_u32 s69, s30, 20480
    buffer_load_dwordx4 v[160:163], v8, s[44:47], s69 offen sc1
    buffer_load_dwordx4 v[168:171], v9, s[44:47], s69 offen sc1
    buffer_load_dwordx4 v[164:167], v10, s[44:47], s69 offen sc1
    buffer_load_dwordx4 v[172:175], v11, s[44:47], s69 offen sc1
    s_add_u32 s69, s30, 40960
    buffer_load_dwordx4 a[48:51], v8, s[44:47], s69 offen sc1
    buffer_load_dwordx4 a[52:55], v9, s[44:47], s69 offen sc1
    buffer_load_dwordx4 a[56:59], v10, s[44:47], s69 offen sc1
    buffer_load_dwordx4 a[60:63], v11, s[44:47], s69 offen sc1
    s_mov_b32 s60, s28
    s_mov_b32 s61, s29
    s_mov_b32 s62, 0x400000
    s_mov_b32 s63, 0x20000
    v_lshlrev_b32 v5, 4, v1
    v_add_u32 v20, s89, v5
    s_lshl_b32 s78, s5, 13
    s_add_u32 s78, s78, 131072
    v_add_u32 v3, s78, v5
    s_xor_b32 s78, s78, 0x4000
    v_add_u32 v4, s78, v5
    s_and_b32 s78, s5, 1
    s_lshl_b32 s79, s92, 1
    s_add_u32 s78, s78, s79
    s_lshl_b32 s79, s91, 2
    s_add_u32 s79, s79, s64
    s_lshl_b32 s77, s78, 5
    s_add_u32 s77, s77, s79
    s_mul_i32 s77, s77, 5120
    s_add_u32 s77, s77, 0x500000
    s_lshl_b32 s78, s78, 17
    s_lshl_b32 s79, s79, 6
    s_add_u32 s78, s78, s79
    v_and_b32 v21, 15, v1
    v_lshlrev_b32 v6, 11, v21
    v_add_u32 v6, s78, v6
    v_bfe_u32 v5, v1, 4, 1
    v_lshl_add_u32 v6, v5, 5, v6
    v_lshl_add_u32 v21, v5, 5, v21
    v_lshrrev_b32 v5, 5, v1
    v_lshl_add_u32 v6, v5, 4, v6
    v_lshl_add_u32 v21, v5, 4, v21
    s_mov_b32 s74, 32768
    s_mov_b32 s75, 65536
    s_mov_b32 s76, 98304
    s_lshl_b32 s78, s2, 2
    s_add_u32 s78, s78, s5
    s_xor_b32 s79, s78, 4
    s_mul_i32 s78, s78, 5120
    s_add_u32 s78, s78, 0x3400000
    s_mul_i32 s79, s79, 5120
    s_add_u32 s79, s79, 0x3400000
    s_lshl_b32 s80, s2, 8
    s_add_u32 s80, s80, 0x1760000
    s_xor_b32 s81, s80, 256
L_g2_s0:
    s_waitcnt vmcnt(8) lgkmcnt(4)
    v_mfma_f32_16x16x32_bf16 v[32:35], a[0:3], a[32:35], 0
    ds_read_b64_tr_b16 a[24:25], v18 offset:0
    v_mfma_f32_16x16x32_bf16 v[36:39], a[0:3], a[36:39], 0
    s_add_u32 s69, s30, 61440
    ds_read_b64_tr_b16 a[26:27], v18 offset:4096
    v_mfma_f32_16x16x32_bf16 v[40:43], a[0:3], a[40:43], 0
    buffer_load_dwordx4 v[176:179], v8, s[44:47], s69 offen sc1
    v_mfma_f32_16x16x32_bf16 v[44:47], a[0:3], a[44:47], 0
    v_readlane_b32 s95, v2, 7
    v_mfma_f32_16x16x32_bf16 v[60:63], a[4:7], a[44:47], 0
    s_mov_b32 s90, s95
    ds_read_b64_tr_b16 a[28:29], v19 offset:0
    v_mfma_f32_16x16x32_bf16 v[56:59], a[4:7], a[40:43], 0
    s_add_u32 m0, s89, 114688
    ds_read_b64_tr_b16 a[30:31], v19 offset:4096
    v_mfma_f32_16x16x32_bf16 v[52:55], a[4:7], a[36:39], 0
    buffer_load_dwordx4 v22, s[36:39], s90 offen sc1 lds
    v_mfma_f32_16x16x32_bf16 v[48:51], a[4:7], a[32:35], 0
    v_mfma_f32_16x16x32_bf16 v[64:67], a[8:11], a[32:35], 0
    ds_read_b64_tr_b16 a[0:1], v12 offset:16384
    v_mfma_f32_16x16x32_bf16 v[68:71], a[8:11], a[36:39], 0
    ds_read_b64_tr_b16 a[2:3], v12 offset:20480
    v_mfma_f32_16x16x32_bf16 v[72:75], a[8:11], a[40:43], 0
    buffer_load_dwordx4 v[184:187], v9, s[44:47], s69 offen sc1
    v_mfma_f32_16x16x32_bf16 v[76:79], a[8:11], a[44:47], 0
    v_mfma_f32_16x16x32_bf16 v[92:95], a[12:15], a[44:47], 0
    ds_read_b64_tr_b16 a[4:5], v13 offset:16384
    v_mfma_f32_16x16x32_bf16 v[88:91], a[12:15], a[40:43], 0
    s_add_u32 m0, s89, 115712
    ds_read_b64_tr_b16 a[6:7], v13 offset:20480
    v_mfma_f32_16x16x32_bf16 v[84:87], a[12:15], a[36:39], 0
    buffer_load_dwordx4 v23, s[36:39], s90 offen sc1 lds
    v_mfma_f32_16x16x32_bf16 v[80:83], a[12:15], a[32:35], 0
    s_waitcnt lgkmcnt(4)
    v_mfma_f32_16x16x32_bf16 v[96:99], a[16:19], a[32:35], 0
    ds_read_b64_tr_b16 a[8:9], v14 offset:16384
    v_mfma_f32_16x16x32_bf16 v[100:103], a[16:19], a[36:39], 0
    ds_read_b64_tr_b16 a[10:11], v14 offset:20480
    v_mfma_f32_16x16x32_bf16 v[104:107], a[16:19], a[40:43], 0
    buffer_load_dwordx4 v[180:183], v10, s[44:47], s69 offen sc1
    v_mfma_f32_16x16x32_bf16 v[108:111], a[16:19], a[44:47], 0
    v_mfma_f32_16x16x32_bf16 v[124:127], a[20:23], a[44:47], 0
    ds_read_b64_tr_b16 a[12:13], v15 offset:16384
    v_mfma_f32_16x16x32_bf16 v[120:123], a[20:23], a[40:43], 0
    s_add_u32 m0, s89, 116736
    ds_read_b64_tr_b16 a[14:15], v15 offset:20480
    v_mfma_f32_16x16x32_bf16 v[116:119], a[20:23], a[36:39], 0
    buffer_load_dwordx4 v24, s[36:39], s90 offen sc1 lds
    v_mfma_f32_16x16x32_bf16 v[112:115], a[20:23], a[32:35], 0
    v_mfma_f32_16x16x32_bf16 v[128:131], a[24:27], a[32:35], 0
    ds_read_b64_tr_b16 a[16:17], v16 offset:16384
    v_mfma_f32_16x16x32_bf16 v[132:135], a[24:27], a[36:39], 0
    ds_read_b64_tr_b16 a[18:19], v16 offset:20480
    v_mfma_f32_16x16x32_bf16 v[136:139], a[24:27], a[40:43], 0
    buffer_load_dwordx4 v[188:191], v11, s[44:47], s69 offen sc1
    v_mfma_f32_16x16x32_bf16 v[140:143], a[24:27], a[44:47], 0
    s_waitcnt vmcnt(11)
    v_swap_b32 v162, v164
    v_mfma_f32_16x16x32_bf16 v[156:159], a[28:31], a[44:47], 0
    v_swap_b32 v163, v165
    ds_read_b64_tr_b16 a[20:21], v17 offset:16384
    v_mfma_f32_16x16x32_bf16 v[152:155], a[28:31], a[40:43], 0
    s_add_u32 m0, s89, 117760
    v_swap_b32 v170, v172
    ds_read_b64_tr_b16 a[22:23], v17 offset:20480
    v_mfma_f32_16x16x32_bf16 v[148:151], a[28:31], a[36:39], 0
    v_swap_b32 v171, v173
    buffer_load_dwordx4 v25, s[36:39], s90 offen sc1 lds
    v_mfma_f32_16x16x32_bf16 v[144:147], a[28:31], a[32:35], 0
L_g2_s1:
    s_waitcnt vmcnt(12) lgkmcnt(4)
    s_barrier
    s_cmp_lg_u32 s5, 1
    s_cbranch_scc1 L_sig5
    s_lshl_b32 s100, s72, 8
    s_lshl_b32 s101, s71, 2
    s_add_u32 s100, s100, s101
    s_add_u32 s100, s100, 0x1750000
    v_lshlrev_b32 v29, 8, v1
    s_mov_b32 exec_lo, 0x1
    s_mov_b32 exec_hi, 0
    buffer_store_dword v28, v29, s[44:47], s100 offen sc1
    s_mov_b64 exec, -1
    v_and_b32 v29, 31, v1
    v_lshlrev_b32 v29, 2, v29
L_sig5:
    v_mfma_f32_16x16x32_bf16 v[32:35], a[0:3], v[160:163], v[32:35]
    ds_read_b64_tr_b16 a[24:25], v18 offset:16384
    v_mfma_f32_16x16x32_bf16 v[36:39], a[0:3], v[164:167], v[36:39]
    s_add_u32 s69, s30, 81920
    ds_read_b64_tr_b16 a[26:27], v18 offset:20480
    v_mfma_f32_16x16x32_bf16 v[40:43], a[0:3], v[168:171], v[40:43]
    buffer_load_dwordx4 a[96:99], v8, s[44:47], s69 offen sc1
    v_mfma_f32_16x16x32_bf16 v[44:47], a[0:3], v[172:175], v[44:47]
    v_readlane_b32 s95, v2, 8
    v_mfma_f32_16x16x32_bf16 v[60:63], a[4:7], v[172:175], v[60:63]
    s_mov_b32 s90, s95
    ds_read_b64_tr_b16 a[28:29], v19 offset:16384
    v_mfma_f32_16x16x32_bf16 v[56:59], a[4:7], v[168:171], v[56:59]
    s_add_u32 m0, s89, 131072
    ds_read_b64_tr_b16 a[30:31], v19 offset:20480
    v_mfma_f32_16x16x32_bf16 v[52:55], a[4:7], v[164:167], v[52:55]
    buffer_load_dwordx4 v22, s[36:39], s90 offen sc1 lds
    v_mfma_f32_16x16x32_bf16 v[48:51], a[4:7], v[160:163], v[48:51]
    v_mfma_f32_16x16x32_bf16 v[64:67], a[8:11], v[160:163], v[64:67]
    ds_read_b64_tr_b16 a[0:1], v12 offset:32768
    v_mfma_f32_16x16x32_bf16 v[68:71], a[8:11], v[164:167], v[68:71]
    ds_read_b64_tr_b16 a[2:3], v12 offset:36864
    v_mfma_f32_16x16x32_bf16 v[72:75], a[8:11], v[168:171], v[72:75]
    buffer_load_dwordx4 a[100:103], v9, s[44:47], s69 offen sc1
    v_mfma_f32_16x16x32_bf16 v[76:79], a[8:11], v[172:175], v[76:79]
    v_mfma_f32_16x16x32_bf16 v[92:95], a[12:15], v[172:175], v[92:95]
    ds_read_b64_tr_b16 a[4:5], v13 offset:32768
    v_mfma_f32_16x16x32_bf16 v[88:91], a[12:15], v[168:171], v[88:91]
    s_add_u32 m0, s89, 132096
    ds_read_b64_tr_b16 a[6:7], v13 offset:36864
    v_mfma_f32_16x16x32_bf16 v[84:87], a[12:15], v[164:167], v[84:87]
    buffer_load_dwordx4 v23, s[36:39], s90 offen sc1 lds
    v_mfma_f32_16x16x32_bf16 v[80:83], a[12:15], v[160:163], v[80:83]
    s_waitcnt lgkmcnt(4)
    v_mfma_f32_16x16x32_bf16 v[96:99], a[16:19], v[160:163], v[96:99]
    ds_read_b64_tr_b16 a[8:9], v14 offset:32768
    v_mfma_f32_16x16x32_bf16 v[100:103], a[16:19], v[164:167], v[100:103]
    ds_read_b64_tr_b16 a[10:11], v14 offset:36864
    v_mfma_f32_16x16x32_bf16 v[104:107], a[16:19], v[168:171], v[104:107]
    buffer_load_dwordx4 a[104:107], v10, s[44:47], s69 offen sc1
    v_mfma_f32_16x16x32_bf16 v[108:111], a[16:19], v[172:175], v[108:111]
    v_mfma_f32_16x16x32_bf16 v[124:127], a[20:23], v[172:175], v[124:127]
    ds_read_b64_tr_b16 a[12:13], v15 offset:32768
    v_mfma_f32_16x16x32_bf16 v[120:123], a[20:23], v[168:171], v[120:123]
    s_add_u32 m0, s89, 133120
    ds_read_b64_tr_b16 a[14:15], v15 offset:36864
    v_mfma_f32_16x16x32_bf16 v[116:119], a[20:23], v[164:167], v[116:119]
    buffer_load_dwordx4 v24, s[36:39], s90 offen sc1 lds
    v_mfma_f32_16x16x32_bf16 v[112:115], a[20:23], v[160:163], v[112:115]
    v_mfma_f32_16x16x32_bf16 v[128:131], a[24:27], v[160:163], v[128:131]
    ds_read_b64_tr_b16 a[16:17], v16 offset:32768
    v_mfma_f32_16x16x32_bf16 v[132:135], a[24:27], v[164:167], v[132:135]
    ds_read_b64_tr_b16 a[18:19], v16 offset:36864
    v_mfma_f32_16x16x32_bf16 v[136:139], a[24:27], v[168:171], v[136:139]
    buffer_load_dwordx4 a[108:111], v11, s[44:47], s69 offen sc1
    v_mfma_f32_16x16x32_bf16 v[140:143], a[24:27], v[172:175], v[140:143]
    v_mfma_f32_16x16x32_bf16 v[156:159], a[28:31], v[172:175], v[156:159]
    ds_read_b64_tr_b16 a[20:21], v17 offset:32768
    v_mfma_f32_16x16x32_bf16 v[152:155], a[28:31], v[168:171], v[152:155]
    s_add_u32 m0, s89, 134144
    ds_read_b64_tr_b16 a[22:23], v17 offset:36864
    v_mfma_f32_16x16x32_bf16 v[148:151], a[28:31], v[164:167], v[148:151]
    buffer_load_dwordx4 v25, s[36:39], s90 offen sc1 lds
    v_mfma_f32_16x16x32_bf16 v[144:147], a[28:31], v[160:163], v[144:147]
L_g2_s2:
    s_cmp_lg_u32 s5, 3
    s_cbranch_scc1 L_ctg2
    s_add_u32 s52, s6, L_g2_s4-L_pc
    s_addc_u32 s53, s7, 0
    s_mov_b32 s54, L_code_end-L_g2_s4
    s_mov_b32 s55, 0x20000
    s_lshl_b32 s100, s4, 7
    v_lshlrev_b32 v26, 12, v1
    buffer_load_dword v26, v26, s[52:55], s100 offen
L_ctg2:
    s_waitcnt vmcnt(16) lgkmcnt(4)
    v_mfma_f32_16x16x32_bf16 v[32:35], a[0:3], a[48:51], v[32:35]
    ds_read_b64_tr_b16 a[24:25], v18 offset:32768
    v_mfma_f32_16x16x32_bf16 v[36:39], a[0:3], a[52:55], v[36:39]
    s_add_u32 s69, s30, 102400
    ds_read_b64_tr_b16 a[26:27], v18 offset:36864
    v_mfma_f32_16x16x32_bf16 v[40:43], a[0:3], a[56:59], v[40:43]
    buffer_load_dwordx4 v[192:195], v8, s[44:47], s69 offen sc1
    v_mfma_f32_16x16x32_bf16 v[44:47], a[0:3], a[60:63], v[44:47]
    v_mfma_f32_16x16x32_bf16 v[60:63], a[4:7], a[60:63], v[60:63]
    ds_read_b64_tr_b16 a[28:29], v19 offset:32768
    v_mfma_f32_16x16x32_bf16 v[56:59], a[4:7], a[56:59], v[56:59]
    ds_read_b64_tr_b16 a[30:31], v19 offset:36864
    v_mfma_f32_16x16x32_bf16 v[52:55], a[4:7], a[52:55], v[52:55]
    v_mfma_f32_16x16x32_bf16 v[48:51], a[4:7], a[48:51], v[48:51]
    v_mfma_f32_16x16x32_bf16 v[64:67], a[8:11], a[48:51], v[64:67]
    ds_read_b64_tr_b16 a[0:1], v12 offset:49152
    v_mfma_f32_16x16x32_bf16 v[68:71], a[8:11], a[52:55], v[68:71]
    ds_read_b64_tr_b16 a[2:3], v12 offset:53248
    v_mfma_f32_16x16x32_bf16 v[72:75], a[8:11], a[56:59], v[72:75]
    buffer_load_dwordx4 v[200:203], v9, s[44:47], s69 offen sc1
    v_mfma_f32_16x16x32_bf16 v[76:79], a[8:11], a[60:63], v[76:79]
    v_mfma_f32_16x16x32_bf16 v[92:95], a[12:15], a[60:63], v[92:95]
    ds_read_b64_tr_b16 a[4:5], v13 offset:49152
    v_mfma_f32_16x16x32_bf16 v[88:91], a[12:15], a[56:59], v[88:91]
    ds_read_b64_tr_b16 a[6:7], v13 offset:53248
    v_mfma_f32_16x16x32_bf16 v[84:87], a[12:15], a[52:55], v[84:87]
    v_mfma_f32_16x16x32_bf16 v[80:83], a[12:15], a[48:51], v[80:83]
    s_waitcnt lgkmcnt(4)
    v_mfma_f32_16x16x32_bf16 v[96:99], a[16:19], a[48:51], v[96:99]
    ds_read_b64_tr_b16 a[8:9], v14 offset:49152
    v_mfma_f32_16x16x32_bf16 v[100:103], a[16:19], a[52:55], v[100:103]
    ds_read_b64_tr_b16 a[10:11], v14 offset:53248
    v_mfma_f32_16x16x32_bf16 v[104:107], a[16:19], a[56:59], v[104:107]
    buffer_load_dwordx4 v[196:199], v10, s[44:47], s69 offen sc1
    v_mfma_f32_16x16x32_bf16 v[108:111], a[16:19], a[60:63], v[108:111]
    v_mfma_f32_16x16x32_bf16 v[124:127], a[20:23], a[60:63], v[124:127]
    ds_read_b64_tr_b16 a[12:13], v15 offset:49152
    v_mfma_f32_16x16x32_bf16 v[120:123], a[20:23], a[56:59], v[120:123]
    ds_read_b64_tr_b16 a[14:15], v15 offset:53248
    v_mfma_f32_16x16x32_bf16 v[116:119], a[20:23], a[52:55], v[116:119]
    v_mfma_f32_16x16x32_bf16 v[112:115], a[20:23], a[48:51], v[112:115]
    v_mfma_f32_16x16x32_bf16 v[128:131], a[24:27], a[48:51], v[128:131]
    ds_read_b64_tr_b16 a[16:17], v16 offset:49152
    v_mfma_f32_16x16x32_bf16 v[132:135], a[24:27], a[52:55], v[132:135]
    ds_read_b64_tr_b16 a[18:19], v16 offset:53248
    v_mfma_f32_16x16x32_bf16 v[136:139], a[24:27], a[56:59], v[136:139]
    buffer_load_dwordx4 v[204:207], v11, s[44:47], s69 offen sc1
    v_mfma_f32_16x16x32_bf16 v[140:143], a[24:27], a[60:63], v[140:143]
    s_waitcnt vmcnt(13)
    v_swap_b32 v178, v180
    v_mfma_f32_16x16x32_bf16 v[156:159], a[28:31], a[60:63], v[156:159]
    v_swap_b32 v179, v181
    ds_read_b64_tr_b16 a[20:21], v17 offset:49152
    v_mfma_f32_16x16x32_bf16 v[152:155], a[28:31], a[56:59], v[152:155]
    v_swap_b32 v186, v188
    ds_read_b64_tr_b16 a[22:23], v17 offset:53248
    v_mfma_f32_16x16x32_bf16 v[148:151], a[28:31], a[52:55], v[148:151]
    v_swap_b32 v187, v189
    v_mfma_f32_16x16x32_bf16 v[144:147], a[28:31], a[48:51], v[144:147]
L_g2_s3:
    s_waitcnt vmcnt(13) lgkmcnt(4)
    v_mfma_f32_16x16x32_bf16 v[32:35], a[0:3], v[176:179], v[32:35]
    ds_read_b64_tr_b16 a[24:25], v18 offset:49152
    v_mfma_f32_16x16x32_bf16 v[36:39], a[0:3], v[180:183], v[36:39]
    s_add_u32 s69, s30, 122880
    ds_read_b64_tr_b16 a[26:27], v18 offset:53248
    v_mfma_f32_16x16x32_bf16 v[40:43], a[0:3], v[184:187], v[40:43]
    buffer_load_dwordx4 a[112:115], v8, s[44:47], s69 offen sc1
    v_mfma_f32_16x16x32_bf16 v[44:47], a[0:3], v[188:191], v[44:47]
    v_mfma_f32_16x16x32_bf16 v[60:63], a[4:7], v[188:191], v[60:63]
    ds_read_b64_tr_b16 a[28:29], v19 offset:49152
    v_mfma_f32_16x16x32_bf16 v[56:59], a[4:7], v[184:187], v[56:59]
    ds_read_b64_tr_b16 a[30:31], v19 offset:53248
    v_mfma_f32_16x16x32_bf16 v[52:55], a[4:7], v[180:183], v[52:55]
    v_mfma_f32_16x16x32_bf16 v[48:51], a[4:7], v[176:179], v[48:51]
    v_mfma_f32_16x16x32_bf16 v[64:67], a[8:11], v[176:179], v[64:67]
    v_add_u32 v12, 0x10000, v12
    ds_read_b64_tr_b16 a[0:1], v12 offset:0
    v_mfma_f32_16x16x32_bf16 v[68:71], a[8:11], v[180:183], v[68:71]
    ds_read_b64_tr_b16 a[2:3], v12 offset:4096
    v_mfma_f32_16x16x32_bf16 v[72:75], a[8:11], v[184:187], v[72:75]
    buffer_load_dwordx4 a[116:119], v9, s[44:47], s69 offen sc1
    v_mfma_f32_16x16x32_bf16 v[76:79], a[8:11], v[188:191], v[76:79]
    v_mfma_f32_16x16x32_bf16 v[92:95], a[12:15], v[188:191], v[92:95]
    v_add_u32 v13, 0x10000, v13
    ds_read_b64_tr_b16 a[4:5], v13 offset:0
    v_mfma_f32_16x16x32_bf16 v[88:91], a[12:15], v[184:187], v[88:91]
    ds_read_b64_tr_b16 a[6:7], v13 offset:4096
    v_mfma_f32_16x16x32_bf16 v[84:87], a[12:15], v[180:183], v[84:87]
    v_mfma_f32_16x16x32_bf16 v[80:83], a[12:15], v[176:179], v[80:83]
    s_waitcnt lgkmcnt(4)
    v_mfma_f32_16x16x32_bf16 v[96:99], a[16:19], v[176:179], v[96:99]
    v_add_u32 v14, 0x10000, v14
    ds_read_b64_tr_b16 a[8:9], v14 offset:0
    v_mfma_f32_16x16x32_bf16 v[100:103], a[16:19], v[180:183], v[100:103]
    ds_read_b64_tr_b16 a[10:11], v14 offset:4096
    v_mfma_f32_16x16x32_bf16 v[104:107], a[16:19], v[184:187], v[104:107]
    buffer_load_dwordx4 a[120:123], v10, s[44:47], s69 offen sc1
    v_mfma_f32_16x16x32_bf16 v[108:111], a[16:19], v[188:191], v[108:111]
    v_mfma_f32_16x16x32_bf16 v[124:127], a[20:23], v[188:191], v[124:127]
    v_add_u32 v15, 0x10000, v15
    ds_read_b64_tr_b16 a[12:13], v15 offset:0
    v_mfma_f32_16x16x32_bf16 v[120:123], a[20:23], v[184:187], v[120:123]
    ds_read_b64_tr_b16 a[14:15], v15 offset:4096
    v_mfma_f32_16x16x32_bf16 v[116:119], a[20:23], v[180:183], v[116:119]
    v_mfma_f32_16x16x32_bf16 v[112:115], a[20:23], v[176:179], v[112:115]
    v_mfma_f32_16x16x32_bf16 v[128:131], a[24:27], v[176:179], v[128:131]
    v_add_u32 v16, 0x10000, v16
    ds_read_b64_tr_b16 a[16:17], v16 offset:0
    v_mfma_f32_16x16x32_bf16 v[132:135], a[24:27], v[180:183], v[132:135]
    ds_read_b64_tr_b16 a[18:19], v16 offset:4096
    v_mfma_f32_16x16x32_bf16 v[136:139], a[24:27], v[184:187], v[136:139]
    buffer_load_dwordx4 a[124:127], v11, s[44:47], s69 offen sc1
    v_mfma_f32_16x16x32_bf16 v[140:143], a[24:27], v[188:191], v[140:143]
    v_mfma_f32_16x16x32_bf16 v[156:159], a[28:31], v[188:191], v[156:159]
    v_add_u32 v17, 0x10000, v17
    ds_read_b64_tr_b16 a[20:21], v17 offset:0
    v_mfma_f32_16x16x32_bf16 v[152:155], a[28:31], v[184:187], v[152:155]
    ds_read_b64_tr_b16 a[22:23], v17 offset:4096
    v_mfma_f32_16x16x32_bf16 v[148:151], a[28:31], v[180:183], v[148:151]
    v_mfma_f32_16x16x32_bf16 v[144:147], a[28:31], v[176:179], v[144:147]
L_g2_s4:
    s_waitcnt vmcnt(8) lgkmcnt(4)
    s_barrier
    v_mfma_f32_16x16x32_bf16 v[32:35], a[0:3], a[96:99], v[32:35]
    v_add_u32 v18, 0x10000, v18
    ds_read_b64_tr_b16 a[24:25], v18 offset:0
    v_mfma_f32_16x16x32_bf16 v[36:39], a[0:3], a[100:103], v[36:39]
    s_add_u32 s69, s30, 143360
    ds_read_b64_tr_b16 a[26:27], v18 offset:4096
    v_mfma_f32_16x16x32_bf16 v[40:43], a[0:3], a[104:107], v[40:43]
    buffer_load_dwordx4 v[208:211], v8, s[44:47], s69 offen sc1
    v_mfma_f32_16x16x32_bf16 v[44:47], a[0:3], a[108:111], v[44:47]
    v_readlane_b32 s95, v2, 10
    v_mfma_f32_16x16x32_bf16 v[60:63], a[4:7], a[108:111], v[60:63]
    s_mov_b32 s90, s95
    v_add_u32 v19, 0x10000, v19
    ds_read_b64_tr_b16 a[28:29], v19 offset:0
    v_mfma_f32_16x16x32_bf16 v[56:59], a[4:7], a[104:107], v[56:59]
    s_add_u32 m0, s89, 0
    ds_read_b64_tr_b16 a[30:31], v19 offset:4096
    v_mfma_f32_16x16x32_bf16 v[52:55], a[4:7], a[100:103], v[52:55]
    buffer_load_dwordx4 v22, s[36:39], s90 offen sc1 lds
    v_mfma_f32_16x16x32_bf16 v[48:51], a[4:7], a[96:99], v[48:51]
    v_mfma_f32_16x16x32_bf16 v[64:67], a[8:11], a[96:99], v[64:67]
    ds_read_b64_tr_b16 a[0:1], v12 offset:16384
    v_mfma_f32_16x16x32_bf16 v[68:71], a[8:11], a[100:103], v[68:71]
    ds_read_b64_tr_b16 a[2:3], v12 offset:20480
    v_mfma_f32_16x16x32_bf16 v[72:75], a[8:11], a[104:107], v[72:75]
    buffer_load_dwordx4 v[216:219], v9, s[44:47], s69 offen sc1
    v_mfma_f32_16x16x32_bf16 v[76:79], a[8:11], a[108:111], v[76:79]
    v_mfma_f32_16x16x32_bf16 v[92:95], a[12:15], a[108:111], v[92:95]
    ds_read_b64_tr_b16 a[4:5], v13 offset:16384
    v_mfma_f32_16x16x32_bf16 v[88:91], a[12:15], a[104:107], v[88:91]
    s_add_u32 m0, s89, 1024
    ds_read_b64_tr_b16 a[6:7], v13 offset:20480
    v_mfma_f32_16x16x32_bf16 v[84:87], a[12:15], a[100:103], v[84:87]
    buffer_load_dwordx4 v23, s[36:39], s90 offen sc1 lds
    v_mfma_f32_16x16x32_bf16 v[80:83], a[12:15], a[96:99], v[80:83]
    s_waitcnt lgkmcnt(4)
    v_mfma_f32_16x16x32_bf16 v[96:99], a[16:19], a[96:99], v[96:99]
    ds_read_b64_tr_b16 a[8:9], v14 offset:16384
    v_mfma_f32_16x16x32_bf16 v[100:103], a[16:19], a[100:103], v[100:103]
    ds_read_b64_tr_b16 a[10:11], v14 offset:20480
    v_mfma_f32_16x16x32_bf16 v[104:107], a[16:19], a[104:107], v[104:107]
    buffer_load_dwordx4 v[212:215], v10, s[44:47], s69 offen sc1
    v_mfma_f32_16x16x32_bf16 v[108:111], a[16:19], a[108:111], v[108:111]
    v_mfma_f32_16x16x32_bf16 v[124:127], a[20:23], a[108:111], v[124:127]
    ds_read_b64_tr_b16 a[12:13], v15 offset:16384
    v_mfma_f32_16x16x32_bf16 v[120:123], a[20:23], a[104:107], v[120:123]
    s_add_u32 m0, s89, 2048
    ds_read_b64_tr_b16 a[14:15], v15 offset:20480
    v_mfma_f32_16x16x32_bf16 v[116:119], a[20:23], a[100:103], v[116:119]
    buffer_load_dwordx4 v24, s[36:39], s90 offen sc1 lds
    v_mfma_f32_16x16x32_bf16 v[112:115], a[20:23], a[96:99], v[112:115]
    v_mfma_f32_16x16x32_bf16 v[128:131], a[24:27], a[96:99], v[128:131]
    ds_read_b64_tr_b16 a[16:17], v16 offset:16384
    v_mfma_f32_16x16x32_bf16 v[132:135], a[24:27], a[100:103], v[132:135]
    ds_read_b64_tr_b16 a[18:19], v16 offset:20480
    v_mfma_f32_16x16x32_bf16 v[136:139], a[24:27], a[104:107], v[136:139]
    buffer_load_dwordx4 v[220:223], v11, s[44:47], s69 offen sc1
    v_mfma_f32_16x16x32_bf16 v[140:143], a[24:27], a[108:111], v[140:143]
    s_waitcnt vmcnt(11)
    v_swap_b32 v194, v196
    v_mfma_f32_16x16x32_bf16 v[156:159], a[28:31], a[108:111], v[156:159]
    v_swap_b32 v195, v197
    ds_read_b64_tr_b16 a[20:21], v17 offset:16384
    v_mfma_f32_16x16x32_bf16 v[152:155], a[28:31], a[104:107], v[152:155]
    s_add_u32 m0, s89, 3072
    v_swap_b32 v202, v204
    ds_read_b64_tr_b16 a[22:23], v17 offset:20480
    v_mfma_f32_16x16x32_bf16 v[148:151], a[28:31], a[100:103], v[148:151]
    v_swap_b32 v203, v205
    buffer_load_dwordx4 v25, s[36:39], s90 offen sc1 lds
    v_mfma_f32_16x16x32_bf16 v[144:147], a[28:31], a[96:99], v[144:147]
L_g2_s5:
    s_waitcnt vmcnt(12) lgkmcnt(4)
    v_mfma_f32_16x16x32_bf16 v[32:35], a[0:3], v[192:195], v[32:35]
    ds_read_b64_tr_b16 a[24:25], v18 offset:16384
    v_mfma_f32_16x16x32_bf16 v[36:39], a[0:3], v[196:199], v[36:39]
    s_add_u32 s69, s30, 163840
    ds_read_b64_tr_b16 a[26:27], v18 offset:20480
    v_mfma_f32_16x16x32_bf16 v[40:43], a[0:3], v[200:203], v[40:43]
    buffer_load_dwordx4 a[32:35], v8, s[44:47], s69 offen sc1
    v_mfma_f32_16x16x32_bf16 v[44:47], a[0:3], v[204:207], v[44:47]
    v_readlane_b32 s95, v2, 11
    v_mfma_f32_16x16x32_bf16 v[60:63], a[4:7], v[204:207], v[60:63]
    s_mov_b32 s90, s95
    ds_read_b64_tr_b16 a[28:29], v19 offset:16384
    v_mfma_f32_16x16x32_bf16 v[56:59], a[4:7], v[200:203], v[56:59]
    s_add_u32 m0, s89, 16384
    ds_read_b64_tr_b16 a[30:31], v19 offset:20480
    v_mfma_f32_16x16x32_bf16 v[52:55], a[4:7], v[196:199], v[52:55]
    buffer_load_dwordx4 v22, s[36:39], s90 offen sc1 lds
    v_mfma_f32_16x16x32_bf16 v[48:51], a[4:7], v[192:195], v[48:51]
    v_mfma_f32_16x16x32_bf16 v[64:67], a[8:11], v[192:195], v[64:67]
    ds_read_b64_tr_b16 a[0:1], v12 offset:32768
    v_mfma_f32_16x16x32_bf16 v[68:71], a[8:11], v[196:199], v[68:71]
    ds_read_b64_tr_b16 a[2:3], v12 offset:36864
    v_mfma_f32_16x16x32_bf16 v[72:75], a[8:11], v[200:203], v[72:75]
    buffer_load_dwordx4 a[36:39], v9, s[44:47], s69 offen sc1
    v_mfma_f32_16x16x32_bf16 v[76:79], a[8:11], v[204:207], v[76:79]
    v_mfma_f32_16x16x32_bf16 v[92:95], a[12:15], v[204:207], v[92:95]
    ds_read_b64_tr_b16 a[4:5], v13 offset:32768
    v_mfma_f32_16x16x32_bf16 v[88:91], a[12:15], v[200:203], v[88:91]
    s_add_u32 m0, s89, 17408
    ds_read_b64_tr_b16 a[6:7], v13 offset:36864
    v_mfma_f32_16x16x32_bf16 v[84:87], a[12:15], v[196:199], v[84:87]
    buffer_load_dwordx4 v23, s[36:39], s90 offen sc1 lds
    v_mfma_f32_16x16x32_bf16 v[80:83], a[12:15], v[192:195], v[80:83]
    s_waitcnt lgkmcnt(4)
    v_mfma_f32_16x16x32_bf16 v[96:99], a[16:19], v[192:195], v[96:99]
    ds_read_b64_tr_b16 a[8:9], v14 offset:32768
    v_mfma_f32_16x16x32_bf16 v[100:103], a[16:19], v[196:199], v[100:103]
    ds_read_b64_tr_b16 a[10:11], v14 offset:36864
    v_mfma_f32_16x16x32_bf16 v[104:107], a[16:19], v[200:203], v[104:107]
    buffer_load_dwordx4 a[40:43], v10, s[44:47], s69 offen sc1
    v_mfma_f32_16x16x32_bf16 v[108:111], a[16:19], v[204:207], v[108:111]
    v_mfma_f32_16x16x32_bf16 v[124:127], a[20:23], v[204:207], v[124:127]
    ds_read_b64_tr_b16 a[12:13], v15 offset:32768
    v_mfma_f32_16x16x32_bf16 v[120:123], a[20:23], v[200:203], v[120:123]
    s_add_u32 m0, s89, 18432
    ds_read_b64_tr_b16 a[14:15], v15 offset:36864
    v_mfma_f32_16x16x32_bf16 v[116:119], a[20:23], v[196:199], v[116:119]
    buffer_load_dwordx4 v24, s[36:39], s90 offen sc1 lds
    v_mfma_f32_16x16x32_bf16 v[112:115], a[20:23], v[192:195], v[112:115]
    v_mfma_f32_16x16x32_bf16 v[128:131], a[24:27], v[192:195], v[128:131]
    ds_read_b64_tr_b16 a[16:17], v16 offset:32768
    v_mfma_f32_16x16x32_bf16 v[132:135], a[24:27], v[196:199], v[132:135]
    ds_read_b64_tr_b16 a[18:19], v16 offset:36864
    v_mfma_f32_16x16x32_bf16 v[136:139], a[24:27], v[200:203], v[136:139]
    buffer_load_dwordx4 a[44:47], v11, s[44:47], s69 offen sc1
    v_mfma_f32_16x16x32_bf16 v[140:143], a[24:27], v[204:207], v[140:143]
    v_mfma_f32_16x16x32_bf16 v[156:159], a[28:31], v[204:207], v[156:159]
    ds_read_b64_tr_b16 a[20:21], v17 offset:32768
    v_mfma_f32_16x16x32_bf16 v[152:155], a[28:31], v[200:203], v[152:155]
    s_add_u32 m0, s89, 19456
    ds_read_b64_tr_b16 a[22:23], v17 offset:36864
    v_mfma_f32_16x16x32_bf16 v[148:151], a[28:31], v[196:199], v[148:151]
    buffer_load_dwordx4 v25, s[36:39], s90 offen sc1 lds
    v_mfma_f32_16x16x32_bf16 v[144:147], a[28:31], v[192:195], v[144:147]
L_g2_s6:
    s_waitcnt vmcnt(16) lgkmcnt(4)
    v_mfma_f32_16x16x32_bf16 v[32:35], a[0:3], a[112:115], v[32:35]
    ds_read_b64_tr_b16 a[24:25], v18 offset:32768
    v_mfma_f32_16x16x32_bf16 v[36:39], a[0:3], a[116:119], v[36:39]
    ds_read_b64_tr_b16 a[26:27], v18 offset:36864
    v_mfma_f32_16x16x32_bf16 v[40:43], a[0:3], a[120:123], v[40:43]
    buffer_load_dword v30, v29, s[44:47], s65 offen sc1
    v_mfma_f32_16x16x32_bf16 v[44:47], a[0:3], a[124:127], v[44:47]
    s_add_u32 s69, s30, 184320
    buffer_load_dwordx4 v[160:163], v8, s[44:47], s69 offen sc1
    v_mfma_f32_16x16x32_bf16 v[60:63], a[4:7], a[124:127], v[60:63]
    v_readlane_b32 s95, v2, 12
    ds_read_b64_tr_b16 a[28:29], v19 offset:32768
    v_mfma_f32_16x16x32_bf16 v[56:59], a[4:7], a[120:123], v[56:59]
    s_mov_b32 s90, s95
    ds_read_b64_tr_b16 a[30:31], v19 offset:36864
    v_mfma_f32_16x16x32_bf16 v[52:55], a[4:7], a[116:119], v[52:55]
    s_add_u32 m0, s89, 32768
    v_mfma_f32_16x16x32_bf16 v[48:51], a[4:7], a[112:115], v[48:51]
    buffer_load_dwordx4 v22, s[36:39], s90 offen sc1 lds
    v_mfma_f32_16x16x32_bf16 v[64:67], a[8:11], a[112:115], v[64:67]
    ds_read_b64_tr_b16 a[0:1], v12 offset:49152
    v_mfma_f32_16x16x32_bf16 v[68:71], a[8:11], a[116:119], v[68:71]
    ds_read_b64_tr_b16 a[2:3], v12 offset:53248
    v_mfma_f32_16x16x32_bf16 v[72:75], a[8:11], a[120:123], v[72:75]
    v_mfma_f32_16x16x32_bf16 v[76:79], a[8:11], a[124:127], v[76:79]
    buffer_load_dwordx4 v[164:167], v9, s[44:47], s69 offen sc1
    v_mfma_f32_16x16x32_bf16 v[92:95], a[12:15], a[124:127], v[92:95]
    ds_read_b64_tr_b16 a[4:5], v13 offset:49152
    v_mfma_f32_16x16x32_bf16 v[88:91], a[12:15], a[120:123], v[88:91]
    ds_read_b64_tr_b16 a[6:7], v13 offset:53248
    v_mfma_f32_16x16x32_bf16 v[84:87], a[12:15], a[116:119], v[84:87]
    s_add_u32 m0, s89, 33792
    v_mfma_f32_16x16x32_bf16 v[80:83], a[12:15], a[112:115], v[80:83]
    buffer_load_dwordx4 v23, s[36:39], s90 offen sc1 lds
    s_waitcnt lgkmcnt(4)
    v_mfma_f32_16x16x32_bf16 v[96:99], a[16:19], a[112:115], v[96:99]
    ds_read_b64_tr_b16 a[8:9], v14 offset:49152
    v_mfma_f32_16x16x32_bf16 v[100:103], a[16:19], a[116:119], v[100:103]
    ds_read_b64_tr_b16 a[10:11], v14 offset:53248
    v_mfma_f32_16x16x32_bf16 v[104:107], a[16:19], a[120:123], v[104:107]
    buffer_load_dwordx4 v[168:171], v10, s[44:47], s69 offen sc1
    v_mfma_f32_16x16x32_bf16 v[108:111], a[16:19], a[124:127], v[108:111]
    v_mfma_f32_16x16x32_bf16 v[124:127], a[20:23], a[124:127], v[124:127]
    ds_read_b64_tr_b16 a[12:13], v15 offset:49152
    v_mfma_f32_16x16x32_bf16 v[120:123], a[20:23], a[120:123], v[120:123]
    s_add_u32 m0, s89, 34816
    ds_read_b64_tr_b16 a[14:15], v15 offset:53248
    v_mfma_f32_16x16x32_bf16 v[116:119], a[20:23], a[116:119], v[116:119]
    buffer_load_dwordx4 v24, s[36:39], s90 offen sc1 lds
    v_mfma_f32_16x16x32_bf16 v[112:115], a[20:23], a[112:115], v[112:115]
    v_mfma_f32_16x16x32_bf16 v[128:131], a[24:27], a[112:115], v[128:131]
    ds_read_b64_tr_b16 a[16:17], v16 offset:49152
    v_mfma_f32_16x16x32_bf16 v[132:135], a[24:27], a[116:119], v[132:135]
    ds_read_b64_tr_b16 a[18:19], v16 offset:53248
    v_mfma_f32_16x16x32_bf16 v[136:139], a[24:27], a[120:123], v[136:139]
    buffer_load_dwordx4 v[172:175], v11, s[44:47], s69 offen sc1
    v_mfma_f32_16x16x32_bf16 v[140:143], a[24:27], a[124:127], v[140:143]
    s_waitcnt vmcnt(17)
    v_swap_b32 v210, v212
    v_mfma_f32_16x16x32_bf16 v[156:159], a[28:31], a[124:127], v[156:159]
    v_swap_b32 v211, v213
    ds_read_b64_tr_b16 a[20:21], v17 offset:49152
    v_mfma_f32_16x16x32_bf16 v[152:155], a[28:31], a[120:123], v[152:155]
    s_add_u32 m0, s89, 35840
    v_swap_b32 v218, v220
    ds_read_b64_tr_b16 a[22:23], v17 offset:53248
    v_mfma_f32_16x16x32_bf16 v[148:151], a[28:31], a[116:119], v[148:151]
    v_swap_b32 v219, v221
    buffer_load_dwordx4 v25, s[36:39], s90 offen sc1 lds
    v_mfma_f32_16x16x32_bf16 v[144:147], a[28:31], a[112:115], v[144:147]
L_g2_s7:
    s_waitcnt vmcnt(18) lgkmcnt(4)
    v_mfma_f32_16x16x32_bf16 v[32:35], a[0:3], v[208:211], v[32:35]
    ds_read_b64_tr_b16 a[24:25], v18 offset:49152
    v_mfma_f32_16x16x32_bf16 v[36:39], a[0:3], v[212:215], v[36:39]
    s_add_u32 s69, s30, 204800
    ds_read_b64_tr_b16 a[26:27], v18 offset:53248
    v_mfma_f32_16x16x32_bf16 v[40:43], a[0:3], v[216:219], v[40:43]
    buffer_load_dwordx4 a[48:51], v8, s[44:47], s69 offen sc1
    v_mfma_f32_16x16x32_bf16 v[44:47], a[0:3], v[220:223], v[44:47]
    v_readlane_b32 s95, v2, 13
    v_mfma_f32_16x16x32_bf16 v[60:63], a[4:7], v[220:223], v[60:63]
    s_mov_b32 s90, s95
    ds_read_b64_tr_b16 a[28:29], v19 offset:49152
    v_mfma_f32_16x16x32_bf16 v[56:59], a[4:7], v[216:219], v[56:59]
    s_add_u32 m0, s89, 49152
    ds_read_b64_tr_b16 a[30:31], v19 offset:53248
    v_mfma_f32_16x16x32_bf16 v[52:55], a[4:7], v[212:215], v[52:55]
    buffer_load_dwordx4 v22, s[36:39], s90 offen sc1 lds
    v_mfma_f32_16x16x32_bf16 v[48:51], a[4:7], v[208:211], v[48:51]
    v_mfma_f32_16x16x32_bf16 v[64:67], a[8:11], v[208:211], v[64:67]
    v_add_u32 v12, 0x10000, v12
    ds_read_b64_tr_b16 a[0:1], v12 offset:0
    v_mfma_f32_16x16x32_bf16 v[68:71], a[8:11], v[212:215], v[68:71]
    ds_read_b64_tr_b16 a[2:3], v12 offset:4096
    v_mfma_f32_16x16x32_bf16 v[72:75], a[8:11], v[216:219], v[72:75]
    buffer_load_dwordx4 a[52:55], v9, s[44:47], s69 offen sc1
    v_mfma_f32_16x16x32_bf16 v[76:79], a[8:11], v[220:223], v[76:79]
    v_mfma_f32_16x16x32_bf16 v[92:95], a[12:15], v[220:223], v[92:95]
    v_add_u32 v13, 0x10000, v13
    ds_read_b64_tr_b16 a[4:5], v13 offset:0
    v_mfma_f32_16x16x32_bf16 v[88:91], a[12:15], v[216:219], v[88:91]
    s_add_u32 m0, s89, 50176
    ds_read_b64_tr_b16 a[6:7], v13 offset:4096
    v_mfma_f32_16x16x32_bf16 v[84:87], a[12:15], v[212:215], v[84:87]
    buffer_load_dwordx4 v23, s[36:39], s90 offen sc1 lds
    v_mfma_f32_16x16x32_bf16 v[80:83], a[12:15], v[208:211], v[80:83]
    s_waitcnt lgkmcnt(4)
    v_mfma_f32_16x16x32_bf16 v[96:99], a[16:19], v[208:211], v[96:99]
    v_add_u32 v14, 0x10000, v14
    ds_read_b64_tr_b16 a[8:9], v14 offset:0
    v_mfma_f32_16x16x32_bf16 v[100:103], a[16:19], v[212:215], v[100:103]
    ds_read_b64_tr_b16 a[10:11], v14 offset:4096
    v_mfma_f32_16x16x32_bf16 v[104:107], a[16:19], v[216:219], v[104:107]
    buffer_load_dwordx4 a[56:59], v10, s[44:47], s69 offen sc1
    v_mfma_f32_16x16x32_bf16 v[108:111], a[16:19], v[220:223], v[108:111]
    v_mfma_f32_16x16x32_bf16 v[124:127], a[20:23], v[220:223], v[124:127]
    v_add_u32 v15, 0x10000, v15
    ds_read_b64_tr_b16 a[12:13], v15 offset:0
    v_mfma_f32_16x16x32_bf16 v[120:123], a[20:23], v[216:219], v[120:123]
    s_add_u32 m0, s89, 51200
    ds_read_b64_tr_b16 a[14:15], v15 offset:4096
    v_mfma_f32_16x16x32_bf16 v[116:119], a[20:23], v[212:215], v[116:119]
    buffer_load_dwordx4 v24, s[36:39], s90 offen sc1 lds
    v_mfma_f32_16x16x32_bf16 v[112:115], a[20:23], v[208:211], v[112:115]
    v_mfma_f32_16x16x32_bf16 v[128:131], a[24:27], v[208:211], v[128:131]
    v_add_u32 v16, 0x10000, v16
    ds_read_b64_tr_b16 a[16:17], v16 offset:0
    v_mfma_f32_16x16x32_bf16 v[132:135], a[24:27], v[212:215], v[132:135]
    ds_read_b64_tr_b16 a[18:19], v16 offset:4096
    v_mfma_f32_16x16x32_bf16 v[136:139], a[24:27], v[216:219], v[136:139]
    buffer_load_dwordx4 a[60:63], v11, s[44:47], s69 offen sc1
    v_mfma_f32_16x16x32_bf16 v[140:143], a[24:27], v[220:223], v[140:143]
    v_mfma_f32_16x16x32_bf16 v[156:159], a[28:31], v[220:223], v[156:159]
    v_add_u32 v17, 0x10000, v17
    ds_read_b64_tr_b16 a[20:21], v17 offset:0
    v_mfma_f32_16x16x32_bf16 v[152:155], a[28:31], v[216:219], v[152:155]
    s_add_u32 m0, s89, 52224
    ds_read_b64_tr_b16 a[22:23], v17 offset:4096
    v_mfma_f32_16x16x32_bf16 v[148:151], a[28:31], v[212:215], v[148:151]
    buffer_load_dwordx4 v25, s[36:39], s90 offen sc1 lds
    v_mfma_f32_16x16x32_bf16 v[144:147], a[28:31], v[208:211], v[144:147]
L_g2_s8:
    s_mov_b32 s101, 0
    s_waitcnt vmcnt(16)
L_poll5:
    v_cmp_ne_u32 vcc, s34, v30
    s_nop 4
    s_cbranch_vccz L_got5
    buffer_load_dword v30, v29, s[44:47], s65 offen sc1
    s_add_u32 s101, s101, 1
    s_cmp_lt_u32 s101, 0x8000
    s_waitcnt vmcnt(0)
    s_cbranch_scc1 L_poll5
L_got5:
    s_waitcnt vmcnt(8) lgkmcnt(4)
    s_barrier
    v_mfma_f32_16x16x32_bf16 v[32:35], a[0:3], a[32:35], v[32:35]
    v_add_u32 v18, 0x10000, v18
    ds_read_b64_tr_b16 a[24:25], v18 offset:0
    v_mfma_f32_16x16x32_bf16 v[36:39], a[0:3], a[36:39], v[36:39]
    s_add_u32 s69, s30, 225280
    ds_read_b64_tr_b16 a[26:27], v18 offset:4096
    v_mfma_f32_16x16x32_bf16 v[40:43], a[0:3], a[40:43], v[40:43]
    buffer_load_dwordx4 v[176:179], v8, s[44:47], s69 offen sc1
    v_mfma_f32_16x16x32_bf16 v[44:47], a[0:3], a[44:47], v[44:47]
    v_readlane_b32 s95, v2, 14
    v_mfma_f32_16x16x32_bf16 v[60:63], a[4:7], a[44:47], v[60:63]
    s_mov_b32 s90, s95
    v_add_u32 v19, 0x10000, v19
    ds_read_b64_tr_b16 a[28:29], v19 offset:0
    v_mfma_f32_16x16x32_bf16 v[56:59], a[4:7], a[40:43], v[56:59]
    s_add_u32 m0, s89, 65536
    ds_read_b64_tr_b16 a[30:31], v19 offset:4096
    v_mfma_f32_16x16x32_bf16 v[52:55], a[4:7], a[36:39], v[52:55]
    buffer_load_dwordx4 v22, s[36:39], s90 offen sc1 lds
    v_mfma_f32_16x16x32_bf16 v[48:51], a[4:7], a[32:35], v[48:51]
    v_mfma_f32_16x16x32_bf16 v[64:67], a[8:11], a[32:35], v[64:67]
    ds_read_b64_tr_b16 a[0:1], v12 offset:16384
    v_mfma_f32_16x16x32_bf16 v[68:71], a[8:11], a[36:39], v[68:71]
    ds_read_b64_tr_b16 a[2:3], v12 offset:20480
    v_mfma_f32_16x16x32_bf16 v[72:75], a[8:11], a[40:43], v[72:75]
    buffer_load_dwordx4 v[180:183], v9, s[44:47], s69 offen sc1
    v_mfma_f32_16x16x32_bf16 v[76:79], a[8:11], a[44:47], v[76:79]
    v_mfma_f32_16x16x32_bf16 v[92:95], a[12:15], a[44:47], v[92:95]
    ds_read_b64_tr_b16 a[4:5], v13 offset:16384
    v_mfma_f32_16x16x32_bf16 v[88:91], a[12:15], a[40:43], v[88:91]
    s_add_u32 m0, s89, 66560
    ds_read_b64_tr_b16 a[6:7], v13 offset:20480
    v_mfma_f32_16x16x32_bf16 v[84:87], a[12:15], a[36:39], v[84:87]
    buffer_load_dwordx4 v23, s[36:39], s90 offen sc1 lds
    v_mfma_f32_16x16x32_bf16 v[80:83], a[12:15], a[32:35], v[80:83]
    s_waitcnt lgkmcnt(4)
    v_mfma_f32_16x16x32_bf16 v[96:99], a[16:19], a[32:35], v[96:99]
    ds_read_b64_tr_b16 a[8:9], v14 offset:16384
    v_mfma_f32_16x16x32_bf16 v[100:103], a[16:19], a[36:39], v[100:103]
    ds_read_b64_tr_b16 a[10:11], v14 offset:20480
    v_mfma_f32_16x16x32_bf16 v[104:107], a[16:19], a[40:43], v[104:107]
    buffer_load_dwordx4 v[184:187], v10, s[44:47], s69 offen sc1
    v_mfma_f32_16x16x32_bf16 v[108:111], a[16:19], a[44:47], v[108:111]
    v_mfma_f32_16x16x32_bf16 v[124:127], a[20:23], a[44:47], v[124:127]
    ds_read_b64_tr_b16 a[12:13], v15 offset:16384
    v_mfma_f32_16x16x32_bf16 v[120:123], a[20:23], a[40:43], v[120:123]
    s_add_u32 m0, s89, 67584
    ds_read_b64_tr_b16 a[14:15], v15 offset:20480
    v_mfma_f32_16x16x32_bf16 v[116:119], a[20:23], a[36:39], v[116:119]
    buffer_load_dwordx4 v24, s[36:39], s90 offen sc1 lds
    v_mfma_f32_16x16x32_bf16 v[112:115], a[20:23], a[32:35], v[112:115]
    v_mfma_f32_16x16x32_bf16 v[128:131], a[24:27], a[32:35], v[128:131]
    ds_read_b64_tr_b16 a[16:17], v16 offset:16384
    v_mfma_f32_16x16x32_bf16 v[132:135], a[24:27], a[36:39], v[132:135]
    ds_read_b64_tr_b16 a[18:19], v16 offset:20480
    v_mfma_f32_16x16x32_bf16 v[136:139], a[24:27], a[40:43], v[136:139]
    buffer_load_dwordx4 v[188:191], v11, s[44:47], s69 offen sc1
    v_mfma_f32_16x16x32_bf16 v[140:143], a[24:27], a[44:47], v[140:143]
    v_mfma_f32_16x16x32_bf16 v[156:159], a[28:31], a[44:47], v[156:159]
    ds_read_b64_tr_b16 a[20:21], v17 offset:16384
    v_mfma_f32_16x16x32_bf16 v[152:155], a[28:31], a[40:43], v[152:155]
    s_add_u32 m0, s89, 68608
    ds_read_b64_tr_b16 a[22:23], v17 offset:20480
    v_mfma_f32_16x16x32_bf16 v[148:151], a[28:31], a[36:39], v[148:151]
    buffer_load_dwordx4 v25, s[36:39], s90 offen sc1 lds
    v_mfma_f32_16x16x32_bf16 v[144:147], a[28:31], a[32:35], v[144:147]
L_g2_s9:
    s_waitcnt vmcnt(17) lgkmcnt(4)
    v_mfma_f32_16x16x32_bf16 v[32:35], a[0:3], v[160:163], v[32:35]
    ds_read_b64_tr_b16 a[24:25], v18 offset:16384
    v_mfma_f32_16x16x32_bf16 v[36:39], a[0:3], v[164:167], v[36:39]
    s_add_u32 s69, s30, 245760
    ds_read_b64_tr_b16 a[26:27], v18 offset:20480
    v_mfma_f32_16x16x32_bf16 v[40:43], a[0:3], v[168:171], v[40:43]
    buffer_load_dwordx4 a[96:99], v8, s[44:47], s69 offen sc1
    v_mfma_f32_16x16x32_bf16 v[44:47], a[0:3], v[172:175], v[44:47]
    v_readlane_b32 s95, v2, 15
    v_mfma_f32_16x16x32_bf16 v[60:63], a[4:7], v[172:175], v[60:63]
    s_mov_b32 s90, s95
    ds_read_b64_tr_b16 a[28:29], v19 offset:16384
    v_mfma_f32_16x16x32_bf16 v[56:59], a[4:7], v[168:171], v[56:59]
    s_add_u32 m0, s89, 81920
    ds_read_b64_tr_b16 a[30:31], v19 offset:20480
    v_mfma_f32_16x16x32_bf16 v[52:55], a[4:7], v[164:167], v[52:55]
    buffer_load_dwordx4 v22, s[36:39], s90 offen sc1 lds
    v_mfma_f32_16x16x32_bf16 v[48:51], a[4:7], v[160:163], v[48:51]
    v_mfma_f32_16x16x32_bf16 v[64:67], a[8:11], v[160:163], v[64:67]
    v_add_u32 v12, 0xfffe0000, v12
    ds_read_b64_tr_b16 a[0:1], v12 offset:0
    v_mfma_f32_16x16x32_bf16 v[68:71], a[8:11], v[164:167], v[68:71]
    ds_read_b64_tr_b16 a[2:3], v12 offset:4096
    v_mfma_f32_16x16x32_bf16 v[72:75], a[8:11], v[168:171], v[72:75]
    buffer_load_dwordx4 a[100:103], v9, s[44:47], s69 offen sc1
    v_mfma_f32_16x16x32_bf16 v[76:79], a[8:11], v[172:175], v[76:79]
    v_mfma_f32_16x16x32_bf16 v[92:95], a[12:15], v[172:175], v[92:95]
    v_add_u32 v13, 0xfffe0000, v13
    ds_read_b64_tr_b16 a[4:5], v13 offset:0
    v_mfma_f32_16x16x32_bf16 v[88:91], a[12:15], v[168:171], v[88:91]
    s_add_u32 m0, s89, 82944
    ds_read_b64_tr_b16 a[6:7], v13 offset:4096
    v_mfma_f32_16x16x32_bf16 v[84:87], a[12:15], v[164:167], v[84:87]
    buffer_load_dwordx4 v23, s[36:39], s90 offen sc1 lds
    v_mfma_f32_16x16x32_bf16 v[80:83], a[12:15], v[160:163], v[80:83]
    s_waitcnt lgkmcnt(4)
    v_mfma_f32_16x16x32_bf16 v[96:99], a[16:19], v[160:163], v[96:99]
    v_add_u32 v14, 0xfffe0000, v14
    ds_read_b64_tr_b16 a[8:9], v14 offset:0
    v_mfma_f32_16x16x32_bf16 v[100:103], a[16:19], v[164:167], v[100:103]
    ds_read_b64_tr_b16 a[10:11], v14 offset:4096
    v_mfma_f32_16x16x32_bf16 v[104:107], a[16:19], v[168:171], v[104:107]
    buffer_load_dwordx4 a[104:107], v10, s[44:47], s69 offen sc1
    v_mfma_f32_16x16x32_bf16 v[108:111], a[16:19], v[172:175], v[108:111]
    v_mfma_f32_16x16x32_bf16 v[124:127], a[20:23], v[172:175], v[124:127]
    v_add_u32 v15, 0xfffe0000, v15
    ds_read_b64_tr_b16 a[12:13], v15 offset:0
    v_mfma_f32_16x16x32_bf16 v[120:123], a[20:23], v[168:171], v[120:123]
    s_add_u32 m0, s89, 83968
    ds_read_b64_tr_b16 a[14:15], v15 offset:4096
    v_mfma_f32_16x16x32_bf16 v[116:119], a[20:23], v[164:167], v[116:119]
    buffer_load_dwordx4 v24, s[36:39], s90 offen sc1 lds
    v_mfma_f32_16x16x32_bf16 v[112:115], a[20:23], v[160:163], v[112:115]
    v_mfma_f32_16x16x32_bf16 v[128:131], a[24:27], v[160:163], v[128:131]
    v_add_u32 v16, 0xfffe0000, v16
    ds_read_b64_tr_b16 a[16:17], v16 offset:0
    v_mfma_f32_16x16x32_bf16 v[132:135], a[24:27], v[164:167], v[132:135]
    ds_read_b64_tr_b16 a[18:19], v16 offset:4096
    v_mfma_f32_16x16x32_bf16 v[136:139], a[24:27], v[168:171], v[136:139]
    buffer_load_dwordx4 a[108:111], v11, s[44:47], s69 offen sc1
    v_mfma_f32_16x16x32_bf16 v[140:143], a[24:27], v[172:175], v[140:143]
    v_mfma_f32_16x16x32_bf16 v[156:159], a[28:31], v[172:175], v[156:159]
    v_add_u32 v17, 0xfffe0000, v17
    ds_read_b64_tr_b16 a[20:21], v17 offset:0
    v_mfma_f32_16x16x32_bf16 v[152:155], a[28:31], v[168:171], v[152:155]
    s_add_u32 m0, s89, 84992
    ds_read_b64_tr_b16 a[22:23], v17 offset:4096
    v_mfma_f32_16x16x32_bf16 v[148:151], a[28:31], v[164:167], v[148:151]
    buffer_load_dwordx4 v25, s[36:39], s90 offen sc1 lds
    v_mfma_f32_16x16x32_bf16 v[144:147], a[28:31], v[160:163], v[144:147]
L_g2_s10:
    s_cmp_lg_u32 s5, 3
    s_cbranch_scc1 L_ctg10
    s_add_u32 s52, s6, L_g2_s12-L_pc
    s_addc_u32 s53, s7, 0
    s_mov_b32 s54, L_code_end-L_g2_s12
    s_mov_b32 s55, 0x20000
    s_lshl_b32 s100, s4, 7
    v_lshlrev_b32 v26, 12, v1
    buffer_load_dword v26, v26, s[52:55], s100 offen
L_ctg10:
    s_waitcnt vmcnt(17) lgkmcnt(4)
    v_mfma_f32_16x16x32_bf16 v[32:35], a[0:3], a[48:51], v[32:35]
    v_add_u32 v18, 0xfffe0000, v18
    ds_read_b64_tr_b16 a[24:25], v18 offset:0
    v_mfma_f32_16x16x32_bf16 v[36:39], a[0:3], a[52:55], v[36:39]
    s_add_u32 s69, s30, 266240
    ds_read_b64_tr_b16 a[26:27], v18 offset:4096
    v_mfma_f32_16x16x32_bf16 v[40:43], a[0:3], a[56:59], v[40:43]
    buffer_load_dwordx4 v[192:195], v8, s[44:47], s69 offen sc1
    v_mfma_f32_16x16x32_bf16 v[44:47], a[0:3], a[60:63], v[44:47]
    v_add_u32 v20, 0x10000, v20
    ds_write_b64 v20, a[64:65] offset:32768
    v_mfma_f32_16x16x32_bf16 v[60:63], a[4:7], a[60:63], v[60:63]
    v_add_u32 v19, 0xfffe0000, v19
    ds_read_b64_tr_b16 a[28:29], v19 offset:0
    v_mfma_f32_16x16x32_bf16 v[56:59], a[4:7], a[56:59], v[56:59]
    ds_read_b64_tr_b16 a[30:31], v19 offset:4096
    v_mfma_f32_16x16x32_bf16 v[52:55], a[4:7], a[52:55], v[52:55]
    buffer_load_dwordx4 v[196:199], v9, s[44:47], s69 offen sc1
    v_mfma_f32_16x16x32_bf16 v[48:51], a[4:7], a[48:51], v[48:51]
    ds_write_b64 v20, a[66:67] offset:32776
    v_mfma_f32_16x16x32_bf16 v[64:67], a[8:11], a[48:51], v[64:67]
    ds_read_b64_tr_b16 a[0:1], v12 offset:16384
    v_mfma_f32_16x16x32_bf16 v[68:71], a[8:11], a[52:55], v[68:71]
    ds_read_b64_tr_b16 a[2:3], v12 offset:20480
    v_mfma_f32_16x16x32_bf16 v[72:75], a[8:11], a[56:59], v[72:75]
    buffer_load_dwordx4 v[200:203], v10, s[44:47], s69 offen sc1
    v_mfma_f32_16x16x32_bf16 v[76:79], a[8:11], a[60:63], v[76:79]
    ds_write_b64 v20, a[68:69] offset:33792
    v_mfma_f32_16x16x32_bf16 v[92:95], a[12:15], a[60:63], v[92:95]
    ds_read_b64_tr_b16 a[4:5], v13 offset:16384
    v_mfma_f32_16x16x32_bf16 v[88:91], a[12:15], a[56:59], v[88:91]
    ds_read_b64_tr_b16 a[6:7], v13 offset:20480
    v_mfma_f32_16x16x32_bf16 v[84:87], a[12:15], a[52:55], v[84:87]
    v_lshlrev_b32 v5, 4, v21
    v_mfma_f32_16x16x32_bf16 v[80:83], a[12:15], a[48:51], v[80:83]
    ds_write_b64 v20, a[70:71] offset:33800
    s_waitcnt lgkmcnt(7)
    v_mfma_f32_16x16x32_bf16 v[96:99], a[16:19], a[48:51], v[96:99]
    ds_read_b64_tr_b16 a[8:9], v14 offset:16384
    v_mfma_f32_16x16x32_bf16 v[100:103], a[16:19], a[52:55], v[100:103]
    ds_read_b64_tr_b16 a[10:11], v14 offset:20480
    v_mfma_f32_16x16x32_bf16 v[104:107], a[16:19], a[56:59], v[104:107]
    buffer_load_dwordx4 v[204:207], v11, s[44:47], s69 offen sc1
    v_mfma_f32_16x16x32_bf16 v[108:111], a[16:19], a[60:63], v[108:111]
    ds_write_b64 v20, a[72:73] offset:34816
    v_mfma_f32_16x16x32_bf16 v[124:127], a[20:23], a[60:63], v[124:127]
    ds_read_b64_tr_b16 a[12:13], v15 offset:16384
    v_mfma_f32_16x16x32_bf16 v[120:123], a[20:23], a[56:59], v[120:123]
    s_add_u32 s69, s30, 286720
    ds_read_b64_tr_b16 a[14:15], v15 offset:20480
    v_mfma_f32_16x16x32_bf16 v[116:119], a[20:23], a[52:55], v[116:119]
    buffer_load_dwordx4 a[112:115], v8, s[44:47], s69 offen sc1
    v_mfma_f32_16x16x32_bf16 v[112:115], a[20:23], a[48:51], v[112:115]
    ds_write_b64 v20, a[74:75] offset:34824
    v_mfma_f32_16x16x32_bf16 v[128:131], a[24:27], a[48:51], v[128:131]
    ds_read_b64_tr_b16 a[16:17], v16 offset:16384
    v_mfma_f32_16x16x32_bf16 v[132:135], a[24:27], a[52:55], v[132:135]
    ds_read_b64_tr_b16 a[18:19], v16 offset:20480
    v_mfma_f32_16x16x32_bf16 v[136:139], a[24:27], a[56:59], v[136:139]
    buffer_load_dwordx4 a[116:119], v9, s[44:47], s69 offen sc1
    v_mfma_f32_16x16x32_bf16 v[140:143], a[24:27], a[60:63], v[140:143]
    ds_write_b64 v20, a[76:77] offset:35840
    v_mfma_f32_16x16x32_bf16 v[156:159], a[28:31], a[60:63], v[156:159]
    ds_read_b64_tr_b16 a[20:21], v17 offset:16384
    v_mfma_f32_16x16x32_bf16 v[152:155], a[28:31], a[56:59], v[152:155]
    ds_read_b64_tr_b16 a[22:23], v17 offset:20480
    v_mfma_f32_16x16x32_bf16 v[148:151], a[28:31], a[52:55], v[148:151]
    v_and_b32 v7, 0x70, v5
    v_mfma_f32_16x16x32_bf16 v[144:147], a[28:31], a[48:51], v[144:147]
    ds_write_b64 v20, a[78:79] offset:35848
L_g2_s11:
    s_waitcnt vmcnt(15) lgkmcnt(7)
    v_mfma_f32_16x16x32_bf16 v[32:35], a[0:3], v[176:179], v[32:35]
    ds_read_b64_tr_b16 a[24:25], v18 offset:16384
    v_mfma_f32_16x16x32_bf16 v[36:39], a[0:3], v[180:183], v[36:39]
    ds_read_b64_tr_b16 a[26:27], v18 offset:20480
    v_mfma_f32_16x16x32_bf16 v[40:43], a[0:3], v[184:187], v[40:43]
    buffer_load_dwordx4 a[120:123], v10, s[44:47], s69 offen sc1
    v_mfma_f32_16x16x32_bf16 v[44:47], a[0:3], v[188:191], v[44:47]
    ds_write_b64 v20, a[80:81] offset:49152
    v_mfma_f32_16x16x32_bf16 v[60:63], a[4:7], v[188:191], v[60:63]
    ds_read_b64_tr_b16 a[28:29], v19 offset:16384
    v_mfma_f32_16x16x32_bf16 v[56:59], a[4:7], v[184:187], v[56:59]
    ds_read_b64_tr_b16 a[30:31], v19 offset:20480
    v_mfma_f32_16x16x32_bf16 v[52:55], a[4:7], v[180:183], v[52:55]
    buffer_load_dwordx4 a[124:127], v11, s[44:47], s69 offen sc1
    v_mfma_f32_16x16x32_bf16 v[48:51], a[4:7], v[176:179], v[48:51]
    ds_write_b64 v20, a[82:83] offset:49160
    v_mfma_f32_16x16x32_bf16 v[64:67], a[8:11], v[176:179], v[64:67]
    ds_read_b64_tr_b16 a[0:1], v12 offset:32768
    v_mfma_f32_16x16x32_bf16 v[68:71], a[8:11], v[180:183], v[68:71]
    s_add_u32 s69, s30, 307200
    ds_read_b64_tr_b16 a[2:3], v12 offset:36864
    v_mfma_f32_16x16x32_bf16 v[72:75], a[8:11], v[184:187], v[72:75]
    buffer_load_dwordx4 v[208:211], v8, s[44:47], s69 offen sc1
    v_mfma_f32_16x16x32_bf16 v[76:79], a[8:11], v[188:191], v[76:79]
    ds_write_b64 v20, a[84:85] offset:50176
    v_mfma_f32_16x16x32_bf16 v[92:95], a[12:15], v[188:191], v[92:95]
    ds_read_b64_tr_b16 a[4:5], v13 offset:32768
    v_mfma_f32_16x16x32_bf16 v[88:91], a[12:15], v[184:187], v[88:91]
    ds_read_b64_tr_b16 a[6:7], v13 offset:36864
    v_mfma_f32_16x16x32_bf16 v[84:87], a[12:15], v[180:183], v[84:87]
    v_and_b32 v22, 56, v21
    v_mfma_f32_16x16x32_bf16 v[80:83], a[12:15], v[176:179], v[80:83]
    ds_write_b64 v20, a[86:87] offset:50184
    s_waitcnt lgkmcnt(7)
    v_mfma_f32_16x16x32_bf16 v[96:99], a[16:19], v[176:179], v[96:99]
    ds_read_b64_tr_b16 a[8:9], v14 offset:32768
    v_mfma_f32_16x16x32_bf16 v[100:103], a[16:19], v[180:183], v[100:103]
    ds_read_b64_tr_b16 a[10:11], v14 offset:36864
    v_mfma_f32_16x16x32_bf16 v[104:107], a[16:19], v[184:187], v[104:107]
    buffer_load_dwordx4 v[212:215], v9, s[44:47], s69 offen sc1
    v_mfma_f32_16x16x32_bf16 v[108:111], a[16:19], v[188:191], v[108:111]
    ds_write_b64 v20, a[88:89] offset:51200
    v_mfma_f32_16x16x32_bf16 v[124:127], a[20:23], v[188:191], v[124:127]
    ds_read_b64_tr_b16 a[12:13], v15 offset:32768
    v_mfma_f32_16x16x32_bf16 v[120:123], a[20:23], v[184:187], v[120:123]
    ds_read_b64_tr_b16 a[14:15], v15 offset:36864
    v_mfma_f32_16x16x32_bf16 v[116:119], a[20:23], v[180:183], v[116:119]
    buffer_load_dwordx4 v[216:219], v10, s[44:47], s69 offen sc1
    v_mfma_f32_16x16x32_bf16 v[112:115], a[20:23], v[176:179], v[112:115]
    ds_write_b64 v20, a[90:91] offset:51208
    v_mfma_f32_16x16x32_bf16 v[128:131], a[24:27], v[176:179], v[128:131]
    ds_read_b64_tr_b16 a[16:17], v16 offset:32768
    v_mfma_f32_16x16x32_bf16 v[132:135], a[24:27], v[180:183], v[132:135]
    ds_read_b64_tr_b16 a[18:19], v16 offset:36864
    v_mfma_f32_16x16x32_bf16 v[136:139], a[24:27], v[184:187], v[136:139]
    buffer_load_dwordx4 v[220:223], v11, s[44:47], s69 offen sc1
    v_mfma_f32_16x16x32_bf16 v[140:143], a[24:27], v[188:191], v[140:143]
    ds_write_b64 v20, a[92:93] offset:52224
    v_mfma_f32_16x16x32_bf16 v[156:159], a[28:31], v[188:191], v[156:159]
    ds_read_b64_tr_b16 a[20:21], v17 offset:32768
    v_mfma_f32_16x16x32_bf16 v[152:155], a[28:31], v[184:187], v[152:155]
    ds_read_b64_tr_b16 a[22:23], v17 offset:36864
    v_mfma_f32_16x16x32_bf16 v[148:151], a[28:31], v[180:183], v[148:151]
    v_cmp_eq_u32 vcc, 24, v22
    v_mfma_f32_16x16x32_bf16 v[144:147], a[28:31], v[176:179], v[144:147]
    ds_write_b64 v20, a[94:95] offset:52232
L_g2_s12:
    s_waitcnt vmcnt(12) lgkmcnt(0)
    s_barrier
    v_mfma_f32_16x16x32_bf16 v[32:35], a[0:3], a[96:99], v[32:35]
    ds_read_b64_tr_b16 a[24:25], v18 offset:32768
    v_mfma_f32_16x16x32_bf16 v[36:39], a[0:3], a[100:103], v[36:39]
    s_add_u32 s69, s30, 327680
    ds_read_b64_tr_b16 a[26:27], v18 offset:36864
    v_mfma_f32_16x16x32_bf16 v[40:43], a[0:3], a[104:107], v[40:43]
    buffer_load_dwordx4 a[32:35], v8, s[44:47], s69 offen sc1
    v_mfma_f32_16x16x32_bf16 v[44:47], a[0:3], a[108:111], v[44:47]
    v_add_u32 v20, 0x10000, v20
    ds_write_b64 v20, a[128:129] offset:0
    v_mfma_f32_16x16x32_bf16 v[60:63], a[4:7], a[108:111], v[60:63]
    ds_read_b64_tr_b16 a[28:29], v19 offset:32768
    v_mfma_f32_16x16x32_bf16 v[56:59], a[4:7], a[104:107], v[56:59]
    ds_read_b64_tr_b16 a[30:31], v19 offset:36864
    v_mfma_f32_16x16x32_bf16 v[52:55], a[4:7], a[100:103], v[52:55]
    buffer_load_dwordx4 a[36:39], v9, s[44:47], s69 offen sc1
    v_mfma_f32_16x16x32_bf16 v[48:51], a[4:7], a[96:99], v[48:51]
    ds_write_b64 v20, a[130:131] offset:8
    v_mfma_f32_16x16x32_bf16 v[64:67], a[8:11], a[96:99], v[64:67]
    ds_read_b64_tr_b16 a[0:1], v12 offset:49152
    v_mfma_f32_16x16x32_bf16 v[68:71], a[8:11], a[100:103], v[68:71]
    ds_read_b64_tr_b16 a[2:3], v12 offset:53248
    v_mfma_f32_16x16x32_bf16 v[72:75], a[8:11], a[104:107], v[72:75]
    buffer_load_dwordx4 a[40:43], v10, s[44:47], s69 offen sc1
    v_mfma_f32_16x16x32_bf16 v[76:79], a[8:11], a[108:111], v[76:79]
    ds_write_b64 v20, a[132:133] offset:1024
    v_mfma_f32_16x16x32_bf16 v[92:95], a[12:15], a[108:111], v[92:95]
    ds_read_b64_tr_b16 a[4:5], v13 offset:49152
    v_mfma_f32_16x16x32_bf16 v[88:91], a[12:15], a[104:107], v[88:91]
    ds_read_b64_tr_b16 a[6:7], v13 offset:53248
    v_mfma_f32_16x16x32_bf16 v[84:87], a[12:15], a[100:103], v[84:87]
    v_add_u32 v22, 0, v5
    v_mfma_f32_16x16x32_bf16 v[80:83], a[12:15], a[96:99], v[80:83]
    ds_write_b64 v20, a[134:135] offset:1032
    s_waitcnt lgkmcnt(7)
    v_mfma_f32_16x16x32_bf16 v[96:99], a[16:19], a[96:99], v[96:99]
    ds_read_b64_tr_b16 a[8:9], v14 offset:49152
    v_mfma_f32_16x16x32_bf16 v[100:103], a[16:19], a[100:103], v[100:103]
    ds_read_b64_tr_b16 a[10:11], v14 offset:53248
    v_mfma_f32_16x16x32_bf16 v[104:107], a[16:19], a[104:107], v[104:107]
    buffer_load_dwordx4 a[44:47], v11, s[44:47], s69 offen sc1
    v_mfma_f32_16x16x32_bf16 v[108:111], a[16:19], a[108:111], v[108:111]
    ds_write_b64 v20, a[136:137] offset:2048
    v_mfma_f32_16x16x32_bf16 v[124:127], a[20:23], a[108:111], v[124:127]
    ds_read_b64_tr_b16 a[12:13], v15 offset:49152
    v_mfma_f32_16x16x32_bf16 v[120:123], a[20:23], a[104:107], v[120:123]
    s_add_u32 s69, s30, 348160
    ds_read_b64_tr_b16 a[14:15], v15 offset:53248
    v_mfma_f32_16x16x32_bf16 v[116:119], a[20:23], a[100:103], v[116:119]
    buffer_load_dwordx4 v[160:163], v8, s[44:47], s69 offen sc1
    v_mfma_f32_16x16x32_bf16 v[112:115], a[20:23], a[96:99], v[112:115]
    ds_write_b64 v20, a[138:139] offset:2056
    v_mfma_f32_16x16x32_bf16 v[128:131], a[24:27], a[96:99], v[128:131]
    ds_read_b64_tr_b16 a[16:17], v16 offset:49152
    v_mfma_f32_16x16x32_bf16 v[132:135], a[24:27], a[100:103], v[132:135]
    ds_read_b64_tr_b16 a[18:19], v16 offset:53248
    v_mfma_f32_16x16x32_bf16 v[136:139], a[24:27], a[104:107], v[136:139]
    buffer_load_dwordx4 v[164:167], v9, s[44:47], s69 offen sc1
    v_mfma_f32_16x16x32_bf16 v[140:143], a[24:27], a[108:111], v[140:143]
    ds_write_b64 v20, a[140:141] offset:3072
    v_mfma_f32_16x16x32_bf16 v[156:159], a[28:31], a[108:111], v[156:159]
    ds_read_b64_tr_b16 a[20:21], v17 offset:49152
    v_mfma_f32_16x16x32_bf16 v[152:155], a[28:31], a[104:107], v[152:155]
    ds_read_b64_tr_b16 a[22:23], v17 offset:53248
    v_mfma_f32_16x16x32_bf16 v[148:151], a[28:31], a[100:103], v[148:151]
    v_add_u32 v23, 1024, v5
    v_mfma_f32_16x16x32_bf16 v[144:147], a[28:31], a[96:99], v[144:147]
    ds_write_b64 v20, a[142:143] offset:3080
L_g2_s13:
    s_waitcnt vmcnt(14) lgkmcnt(7)
    v_mfma_f32_16x16x32_bf16 v[32:35], a[0:3], v[192:195], v[32:35]
    ds_read_b64_tr_b16 a[24:25], v18 offset:49152
    v_mfma_f32_16x16x32_bf16 v[36:39], a[0:3], v[196:199], v[36:39]
    ds_read_b64_tr_b16 a[26:27], v18 offset:53248
    v_mfma_f32_16x16x32_bf16 v[40:43], a[0:3], v[200:203], v[40:43]
    buffer_load_dwordx4 v[168:171], v10, s[44:47], s69 offen sc1
    v_mfma_f32_16x16x32_bf16 v[44:47], a[0:3], v[204:207], v[44:47]
    ds_write_b64 v20, a[144:145] offset:16384
    v_mfma_f32_16x16x32_bf16 v[60:63], a[4:7], v[204:207], v[60:63]
    ds_read_b64_tr_b16 a[28:29], v19 offset:49152
    v_mfma_f32_16x16x32_bf16 v[56:59], a[4:7], v[200:203], v[56:59]
    ds_read_b64_tr_b16 a[30:31], v19 offset:53248
    v_mfma_f32_16x16x32_bf16 v[52:55], a[4:7], v[196:199], v[52:55]
    buffer_load_dwordx4 v[172:175], v11, s[44:47], s69 offen sc1
    v_mfma_f32_16x16x32_bf16 v[48:51], a[4:7], v[192:195], v[48:51]
    ds_write_b64 v20, a[146:147] offset:16392
    v_mfma_f32_16x16x32_bf16 v[64:67], a[8:11], v[192:195], v[64:67]
    v_add_u32 v12, 0x10000, v12
    ds_read_b64_tr_b16 a[0:1], v12 offset:0
    v_mfma_f32_16x16x32_bf16 v[68:71], a[8:11], v[196:199], v[68:71]
    s_add_u32 s69, s30, 368640
    ds_read_b64_tr_b16 a[2:3], v12 offset:4096
    v_mfma_f32_16x16x32_bf16 v[72:75], a[8:11], v[200:203], v[72:75]
    buffer_load_dwordx4 a[48:51], v8, s[44:47], s69 offen sc1
    v_mfma_f32_16x16x32_bf16 v[76:79], a[8:11], v[204:207], v[76:79]
    ds_write_b64 v20, a[148:149] offset:17408
    v_mfma_f32_16x16x32_bf16 v[92:95], a[12:15], v[204:207], v[92:95]
    v_add_u32 v13, 0x10000, v13
    ds_read_b64_tr_b16 a[4:5], v13 offset:0
    v_mfma_f32_16x16x32_bf16 v[88:91], a[12:15], v[200:203], v[88:91]
    ds_read_b64_tr_b16 a[6:7], v13 offset:4096
    v_mfma_f32_16x16x32_bf16 v[84:87], a[12:15], v[196:199], v[84:87]
    v_add_u32 v24, 2048, v5
    v_mfma_f32_16x16x32_bf16 v[80:83], a[12:15], v[192:195], v[80:83]
    ds_write_b64 v20, a[150:151] offset:17416
    s_waitcnt lgkmcnt(7)
    v_mfma_f32_16x16x32_bf16 v[96:99], a[16:19], v[192:195], v[96:99]
    v_add_u32 v14, 0x10000, v14
    ds_read_b64_tr_b16 a[8:9], v14 offset:0
    v_mfma_f32_16x16x32_bf16 v[100:103], a[16:19], v[196:199], v[100:103]
    ds_read_b64_tr_b16 a[10:11], v14 offset:4096
    v_mfma_f32_16x16x32_bf16 v[104:107], a[16:19], v[200:203], v[104:107]
    buffer_load_dwordx4 a[52:55], v9, s[44:47], s69 offen sc1
    v_mfma_f32_16x16x32_bf16 v[108:111], a[16:19], v[204:207], v[108:111]
    ds_write_b64 v20, a[152:153] offset:18432
    v_mfma_f32_16x16x32_bf16 v[124:127], a[20:23], v[204:207], v[124:127]
    v_add_u32 v15, 0x10000, v15
    ds_read_b64_tr_b16 a[12:13], v15 offset:0
    v_mfma_f32_16x16x32_bf16 v[120:123], a[20:23], v[200:203], v[120:123]
    ds_read_b64_tr_b16 a[14:15], v15 offset:4096
    v_mfma_f32_16x16x32_bf16 v[116:119], a[20:23], v[196:199], v[116:119]
    buffer_load_dwordx4 a[56:59], v10, s[44:47], s69 offen sc1
    v_mfma_f32_16x16x32_bf16 v[112:115], a[20:23], v[192:195], v[112:115]
    ds_write_b64 v20, a[154:155] offset:18440
    v_mfma_f32_16x16x32_bf16 v[128:131], a[24:27], v[192:195], v[128:131]
    v_add_u32 v16, 0x10000, v16
    ds_read_b64_tr_b16 a[16:17], v16 offset:0
    v_mfma_f32_16x16x32_bf16 v[132:135], a[24:27], v[196:199], v[132:135]
    ds_read_b64_tr_b16 a[18:19], v16 offset:4096
    v_mfma_f32_16x16x32_bf16 v[136:139], a[24:27], v[200:203], v[136:139]
    buffer_load_dwordx4 a[60:63], v11, s[44:47], s69 offen sc1
    v_mfma_f32_16x16x32_bf16 v[140:143], a[24:27], v[204:207], v[140:143]
    ds_write_b64 v20, a[156:157] offset:19456
    v_mfma_f32_16x16x32_bf16 v[156:159], a[28:31], v[204:207], v[156:159]
    v_add_u32 v17, 0x10000, v17
    ds_read_b64_tr_b16 a[20:21], v17 offset:0
    v_mfma_f32_16x16x32_bf16 v[152:155], a[28:31], v[200:203], v[152:155]
    ds_read_b64_tr_b16 a[22:23], v17 offset:4096
    v_mfma_f32_16x16x32_bf16 v[148:151], a[28:31], v[196:199], v[148:151]
    v_add_u32 v25, 3072, v5
    v_mfma_f32_16x16x32_bf16 v[144:147], a[28:31], v[192:195], v[144:147]
    ds_write_b64 v20, a[158:159] offset:19464
L_g2_s14:
    s_waitcnt vmcnt(16) lgkmcnt(7)
    v_mfma_f32_16x16x32_bf16 v[32:35], a[0:3], a[112:115], v[32:35]
    v_add_u32 v18, 0x10000, v18
    ds_read_b64_tr_b16 a[24:25], v18 offset:0
    v_mfma_f32_16x16x32_bf16 v[36:39], a[0:3], a[116:119], v[36:39]
    s_add_u32 s69, s30, 389120
    ds_read_b64_tr_b16 a[26:27], v18 offset:4096
    v_mfma_f32_16x16x32_bf16 v[40:43], a[0:3], a[120:123], v[40:43]
    buffer_load_dwordx4 v[176:179], v8, s[44:47], s69 offen sc1
    v_mfma_f32_16x16x32_bf16 v[44:47], a[0:3], a[124:127], v[44:47]
    v_add_u32 v20, 0xfffe0000, v20
    ds_write_b64 v20, a[160:161] offset:0
    v_mfma_f32_16x16x32_bf16 v[60:63], a[4:7], a[124:127], v[60:63]
    v_add_u32 v19, 0x10000, v19
    ds_read_b64_tr_b16 a[28:29], v19 offset:0
    v_mfma_f32_16x16x32_bf16 v[56:59], a[4:7], a[120:123], v[56:59]
    ds_read_b64_tr_b16 a[30:31], v19 offset:4096
    v_mfma_f32_16x16x32_bf16 v[52:55], a[4:7], a[116:119], v[52:55]
    buffer_load_dwordx4 v[180:183], v9, s[44:47], s69 offen sc1
    v_mfma_f32_16x16x32_bf16 v[48:51], a[4:7], a[112:115], v[48:51]
    ds_write_b64 v20, a[162:163] offset:8
    v_mfma_f32_16x16x32_bf16 v[64:67], a[8:11], a[112:115], v[64:67]
    ds_read_b64_tr_b16 a[0:1], v12 offset:16384
    v_mfma_f32_16x16x32_bf16 v[68:71], a[8:11], a[116:119], v[68:71]
    ds_read_b64_tr_b16 a[2:3], v12 offset:20480
    v_mfma_f32_16x16x32_bf16 v[72:75], a[8:11], a[120:123], v[72:75]
    buffer_load_dwordx4 v[184:187], v10, s[44:47], s69 offen sc1
    v_mfma_f32_16x16x32_bf16 v[76:79], a[8:11], a[124:127], v[76:79]
    ds_write_b64 v20, a[164:165] offset:1024
    v_mfma_f32_16x16x32_bf16 v[92:95], a[12:15], a[124:127], v[92:95]
    ds_read_b64_tr_b16 a[4:5], v13 offset:16384
    v_mfma_f32_16x16x32_bf16 v[88:91], a[12:15], a[120:123], v[88:91]
    ds_read_b64_tr_b16 a[6:7], v13 offset:20480
    v_mfma_f32_16x16x32_bf16 v[84:87], a[12:15], a[116:119], v[84:87]
    v_add_u32 v5, 4096, v7
    v_mfma_f32_16x16x32_bf16 v[80:83], a[12:15], a[112:115], v[80:83]
    ds_write_b64 v20, a[166:167] offset:1032
    s_waitcnt lgkmcnt(7)
    v_mfma_f32_16x16x32_bf16 v[96:99], a[16:19], a[112:115], v[96:99]
    ds_read_b64_tr_b16 a[8:9], v14 offset:16384
    v_mfma_f32_16x16x32_bf16 v[100:103], a[16:19], a[116:119], v[100:103]
    ds_read_b64_tr_b16 a[10:11], v14 offset:20480
    v_mfma_f32_16x16x32_bf16 v[104:107], a[16:19], a[120:123], v[104:107]
    buffer_load_dwordx4 v[188:191], v11, s[44:47], s69 offen sc1
    v_mfma_f32_16x16x32_bf16 v[108:111], a[16:19], a[124:127], v[108:111]
    ds_write_b64 v20, a[168:169] offset:2048
    v_mfma_f32_16x16x32_bf16 v[124:127], a[20:23], a[124:127], v[124:127]
    ds_read_b64_tr_b16 a[12:13], v15 offset:16384
    v_mfma_f32_16x16x32_bf16 v[120:123], a[20:23], a[120:123], v[120:123]
    s_add_u32 s69, s30, 409600
    ds_read_b64_tr_b16 a[14:15], v15 offset:20480
    v_mfma_f32_16x16x32_bf16 v[116:119], a[20:23], a[116:119], v[116:119]
    buffer_load_dwordx4 a[96:99], v8, s[44:47], s69 offen sc1
    v_mfma_f32_16x16x32_bf16 v[112:115], a[20:23], a[112:115], v[112:115]
    ds_write_b64 v20, a[170:171] offset:2056
    v_mfma_f32_16x16x32_bf16 v[128:131], a[24:27], a[112:115], v[128:131]
    ds_read_b64_tr_b16 a[16:17], v16 offset:16384
    v_mfma_f32_16x16x32_bf16 v[132:135], a[24:27], a[116:119], v[132:135]
    ds_read_b64_tr_b16 a[18:19], v16 offset:20480
    v_mfma_f32_16x16x32_bf16 v[136:139], a[24:27], a[120:123], v[136:139]
    buffer_load_dwordx4 a[100:103], v9, s[44:47], s69 offen sc1
    v_mfma_f32_16x16x32_bf16 v[140:143], a[24:27], a[124:127], v[140:143]
    ds_write_b64 v20, a[172:173] offset:3072
    v_mfma_f32_16x16x32_bf16 v[156:159], a[28:31], a[124:127], v[156:159]
    ds_read_b64_tr_b16 a[20:21], v17 offset:16384
    v_mfma_f32_16x16x32_bf16 v[152:155], a[28:31], a[120:123], v[152:155]
    ds_read_b64_tr_b16 a[22:23], v17 offset:20480
    v_mfma_f32_16x16x32_bf16 v[148:151], a[28:31], a[116:119], v[148:151]
    v_cndmask_b32 v22, v22, v5, vcc
    v_mfma_f32_16x16x32_bf16 v[144:147], a[28:31], a[112:115], v[144:147]
    ds_write_b64 v20, a[174:175] offset:3080
L_g2_s15:
    s_waitcnt vmcnt(18) lgkmcnt(7)
    v_mfma_f32_16x16x32_bf16 v[32:35], a[0:3], v[208:211], v[32:35]
    ds_read_b64_tr_b16 a[24:25], v18 offset:16384
    v_mfma_f32_16x16x32_bf16 v[36:39], a[0:3], v[212:215], v[36:39]
    ds_read_b64_tr_b16 a[26:27], v18 offset:20480
    v_mfma_f32_16x16x32_bf16 v[40:43], a[0:3], v[216:219], v[40:43]
    buffer_load_dwordx4 a[104:107], v10, s[44:47], s69 offen sc1
    v_mfma_f32_16x16x32_bf16 v[44:47], a[0:3], v[220:223], v[44:47]
    ds_write_b64 v20, a[176:177] offset:16384
    v_mfma_f32_16x16x32_bf16 v[60:63], a[4:7], v[220:223], v[60:63]
    ds_read_b64_tr_b16 a[28:29], v19 offset:16384
    v_mfma_f32_16x16x32_bf16 v[56:59], a[4:7], v[216:219], v[56:59]
    ds_read_b64_tr_b16 a[30:31], v19 offset:20480
    v_mfma_f32_16x16x32_bf16 v[52:55], a[4:7], v[212:215], v[52:55]
    buffer_load_dwordx4 a[108:111], v11, s[44:47], s69 offen sc1
    v_mfma_f32_16x16x32_bf16 v[48:51], a[4:7], v[208:211], v[48:51]
    ds_write_b64 v20, a[178:179] offset:16392
    v_mfma_f32_16x16x32_bf16 v[64:67], a[8:11], v[208:211], v[64:67]
    ds_read_b64_tr_b16 a[0:1], v12 offset:32768
    v_mfma_f32_16x16x32_bf16 v[68:71], a[8:11], v[212:215], v[68:71]
    s_add_u32 s69, s30, 430080
    ds_read_b64_tr_b16 a[2:3], v12 offset:36864
    v_mfma_f32_16x16x32_bf16 v[72:75], a[8:11], v[216:219], v[72:75]
    buffer_load_dwordx4 a[64:67], v8, s[44:47], s69 offen sc1
    v_mfma_f32_16x16x32_bf16 v[76:79], a[8:11], v[220:223], v[76:79]
    ds_write_b64 v20, a[180:181] offset:17408
    v_mfma_f32_16x16x32_bf16 v[92:95], a[12:15], v[220:223], v[92:95]
    ds_read_b64_tr_b16 a[4:5], v13 offset:32768
    v_mfma_f32_16x16x32_bf16 v[88:91], a[12:15], v[216:219], v[88:91]
    ds_read_b64_tr_b16 a[6:7], v13 offset:36864
    v_mfma_f32_16x16x32_bf16 v[84:87], a[12:15], v[212:215], v[84:87]
    v_add_u32 v5, 4224, v7
    v_mfma_f32_16x16x32_bf16 v[80:83], a[12:15], v[208:211], v[80:83]
    ds_write_b64 v20, a[182:183] offset:17416
    s_waitcnt lgkmcnt(7)
    v_mfma_f32_16x16x32_bf16 v[96:99], a[16:19], v[208:211], v[96:99]
    ds_read_b64_tr_b16 a[8:9], v14 offset:32768
    v_mfma_f32_16x16x32_bf16 v[100:103], a[16:19], v[212:215], v[100:103]
    ds_read_b64_tr_b16 a[10:11], v14 offset:36864
    v_mfma_f32_16x16x32_bf16 v[104:107], a[16:19], v[216:219], v[104:107]
    buffer_load_dwordx4 a[68:71], v9, s[44:47], s69 offen sc1
    v_mfma_f32_16x16x32_bf16 v[108:111], a[16:19], v[220:223], v[108:111]
    ds_write_b64 v20, a[184:185] offset:18432
    v_mfma_f32_16x16x32_bf16 v[124:127], a[20:23], v[220:223], v[124:127]
    ds_read_b64_tr_b16 a[12:13], v15 offset:32768
    v_mfma_f32_16x16x32_bf16 v[120:123], a[20:23], v[216:219], v[120:123]
    ds_read_b64_tr_b16 a[14:15], v15 offset:36864
    v_mfma_f32_16x16x32_bf16 v[116:119], a[20:23], v[212:215], v[116:119]
    buffer_load_dwordx4 a[72:75], v10, s[44:47], s69 offen sc1
    v_mfma_f32_16x16x32_bf16 v[112:115], a[20:23], v[208:211], v[112:115]
    ds_write_b64 v20, a[186:187] offset:18440
    v_mfma_f32_16x16x32_bf16 v[128:131], a[24:27], v[208:211], v[128:131]
    ds_read_b64_tr_b16 a[16:17], v16 offset:32768
    v_mfma_f32_16x16x32_bf16 v[132:135], a[24:27], v[212:215], v[132:135]
    ds_read_b64_tr_b16 a[18:19], v16 offset:36864
    v_mfma_f32_16x16x32_bf16 v[136:139], a[24:27], v[216:219], v[136:139]
    buffer_load_dwordx4 a[76:79], v11, s[44:47], s69 offen sc1
    v_mfma_f32_16x16x32_bf16 v[140:143], a[24:27], v[220:223], v[140:143]
    ds_write_b64 v20, a[188:189] offset:19456
    v_mfma_f32_16x16x32_bf16 v[156:159], a[28:31], v[220:223], v[156:159]
    ds_read_b64_tr_b16 a[20:21], v17 offset:32768
    v_mfma_f32_16x16x32_bf16 v[152:155], a[28:31], v[216:219], v[152:155]
    ds_read_b64_tr_b16 a[22:23], v17 offset:36864
    v_mfma_f32_16x16x32_bf16 v[148:151], a[28:31], v[212:215], v[148:151]
    v_cndmask_b32 v23, v23, v5, vcc
    v_mfma_f32_16x16x32_bf16 v[144:147], a[28:31], v[208:211], v[144:147]
    ds_write_b64 v20, a[190:191] offset:19464
L_g2_s16:
    s_waitcnt vmcnt(20) lgkmcnt(0)
    s_barrier
    v_mfma_f32_16x16x32_bf16 v[32:35], a[0:3], a[32:35], v[32:35]
    ds_read_b64_tr_b16 a[24:25], v18 offset:32768
    v_mfma_f32_16x16x32_bf16 v[36:39], a[0:3], a[36:39], v[36:39]
    s_add_u32 s69, s30, 450560
    ds_read_b64_tr_b16 a[26:27], v18 offset:36864
    v_mfma_f32_16x16x32_bf16 v[40:43], a[0:3], a[40:43], v[40:43]
    buffer_load_dwordx4 v[192:195], v8, s[44:47], s69 offen sc1
    v_mfma_f32_16x16x32_bf16 v[44:47], a[0:3], a[44:47], v[44:47]
    ds_write_b64 v20, a[192:193] offset:32768
    v_mfma_f32_16x16x32_bf16 v[60:63], a[4:7], a[44:47], v[60:63]
    ds_read_b64_tr_b16 a[28:29], v19 offset:32768
    v_mfma_f32_16x16x32_bf16 v[56:59], a[4:7], a[40:43], v[56:59]
    ds_read_b64_tr_b16 a[30:31], v19 offset:36864
    v_mfma_f32_16x16x32_bf16 v[52:55], a[4:7], a[36:39], v[52:55]
    buffer_load_dwordx4 v[196:199], v9, s[44:47], s69 offen sc1
    v_mfma_f32_16x16x32_bf16 v[48:51], a[4:7], a[32:35], v[48:51]
    ds_write_b64 v20, a[194:195] offset:32776
    v_mfma_f32_16x16x32_bf16 v[64:67], a[8:11], a[32:35], v[64:67]
    ds_read_b64_tr_b16 a[0:1], v12 offset:49152
    v_mfma_f32_16x16x32_bf16 v[68:71], a[8:11], a[36:39], v[68:71]
    ds_read_b64_tr_b16 a[2:3], v12 offset:53248
    v_mfma_f32_16x16x32_bf16 v[72:75], a[8:11], a[40:43], v[72:75]
    buffer_load_dwordx4 v[200:203], v10, s[44:47], s69 offen sc1
    v_mfma_f32_16x16x32_bf16 v[76:79], a[8:11], a[44:47], v[76:79]
    ds_write_b64 v20, a[196:197] offset:33792
    v_mfma_f32_16x16x32_bf16 v[92:95], a[12:15], a[44:47], v[92:95]
    ds_read_b64_tr_b16 a[4:5], v13 offset:49152
    v_mfma_f32_16x16x32_bf16 v[88:91], a[12:15], a[40:43], v[88:91]
    ds_read_b64_tr_b16 a[6:7], v13 offset:53248
    v_mfma_f32_16x16x32_bf16 v[84:87], a[12:15], a[36:39], v[84:87]
    v_add_u32 v5, 4352, v7
    v_mfma_f32_16x16x32_bf16 v[80:83], a[12:15], a[32:35], v[80:83]
    ds_write_b64 v20, a[198:199] offset:33800
    s_waitcnt lgkmcnt(7)
    v_mfma_f32_16x16x32_bf16 v[96:99], a[16:19], a[32:35], v[96:99]
    ds_read_b64_tr_b16 a[8:9], v14 offset:49152
    v_mfma_f32_16x16x32_bf16 v[100:103], a[16:19], a[36:39], v[100:103]
    ds_read_b64_tr_b16 a[10:11], v14 offset:53248
    v_mfma_f32_16x16x32_bf16 v[104:107], a[16:19], a[40:43], v[104:107]
    buffer_load_dwordx4 v[204:207], v11, s[44:47], s69 offen sc1
    v_mfma_f32_16x16x32_bf16 v[108:111], a[16:19], a[44:47], v[108:111]
    ds_write_b64 v20, a[200:201] offset:34816
    v_mfma_f32_16x16x32_bf16 v[124:127], a[20:23], a[44:47], v[124:127]
    ds_read_b64_tr_b16 a[12:13], v15 offset:49152
    v_mfma_f32_16x16x32_bf16 v[120:123], a[20:23], a[40:43], v[120:123]
    s_add_u32 s69, s30, 471040
    ds_read_b64_tr_b16 a[14:15], v15 offset:53248
    v_mfma_f32_16x16x32_bf16 v[116:119], a[20:23], a[36:39], v[116:119]
    buffer_load_dwordx4 a[112:115], v8, s[44:47], s69 offen sc1
    v_mfma_f32_16x16x32_bf16 v[112:115], a[20:23], a[32:35], v[112:115]
    ds_write_b64 v20, a[202:203] offset:34824
    v_mfma_f32_16x16x32_bf16 v[128:131], a[24:27], a[32:35], v[128:131]
    ds_read_b64_tr_b16 a[16:17], v16 offset:49152
    v_mfma_f32_16x16x32_bf16 v[132:135], a[24:27], a[36:39], v[132:135]
    ds_read_b64_tr_b16 a[18:19], v16 offset:53248
    v_mfma_f32_16x16x32_bf16 v[136:139], a[24:27], a[40:43], v[136:139]
    buffer_load_dwordx4 a[116:119], v9, s[44:47], s69 offen sc1
    v_mfma_f32_16x16x32_bf16 v[140:143], a[24:27], a[44:47], v[140:143]
    ds_write_b64 v20, a[204:205] offset:35840
    v_mfma_f32_16x16x32_bf16 v[156:159], a[28:31], a[44:47], v[156:159]
    ds_read_b64_tr_b16 a[20:21], v17 offset:49152
    v_mfma_f32_16x16x32_bf16 v[152:155], a[28:31], a[40:43], v[152:155]
    ds_read_b64_tr_b16 a[22:23], v17 offset:53248
    v_mfma_f32_16x16x32_bf16 v[148:151], a[28:31], a[36:39], v[148:151]
    v_cndmask_b32 v24, v24, v5, vcc
    v_mfma_f32_16x16x32_bf16 v[144:147], a[28:31], a[32:35], v[144:147]
    ds_write_b64 v20, a[206:207] offset:35848
L_g2_s17:
    s_waitcnt vmcnt(22) lgkmcnt(7)
    v_mfma_f32_16x16x32_bf16 v[32:35], a[0:3], v[160:163], v[32:35]
    ds_read_b64_tr_b16 a[24:25], v18 offset:49152
    v_mfma_f32_16x16x32_bf16 v[36:39], a[0:3], v[164:167], v[36:39]
    ds_read_b64_tr_b16 a[26:27], v18 offset:53248
    v_mfma_f32_16x16x32_bf16 v[40:43], a[0:3], v[168:171], v[40:43]
    buffer_load_dwordx4 a[120:123], v10, s[44:47], s69 offen sc1
    v_mfma_f32_16x16x32_bf16 v[44:47], a[0:3], v[172:175], v[44:47]
    ds_write_b64 v20, a[208:209] offset:49152
    v_mfma_f32_16x16x32_bf16 v[60:63], a[4:7], v[172:175], v[60:63]
    ds_read_b64_tr_b16 a[28:29], v19 offset:49152
    v_mfma_f32_16x16x32_bf16 v[56:59], a[4:7], v[168:171], v[56:59]
    ds_read_b64_tr_b16 a[30:31], v19 offset:53248
    v_mfma_f32_16x16x32_bf16 v[52:55], a[4:7], v[164:167], v[52:55]
    buffer_load_dwordx4 a[124:127], v11, s[44:47], s69 offen sc1
    v_mfma_f32_16x16x32_bf16 v[48:51], a[4:7], v[160:163], v[48:51]
    ds_write_b64 v20, a[210:211] offset:49160
    v_mfma_f32_16x16x32_bf16 v[64:67], a[8:11], v[160:163], v[64:67]
    v_add_u32 v12, 0x10000, v12
    ds_read_b64_tr_b16 a[0:1], v12 offset:0
    v_mfma_f32_16x16x32_bf16 v[68:71], a[8:11], v[164:167], v[68:71]
    s_add_u32 s69, s30, 491520
    ds_read_b64_tr_b16 a[2:3], v12 offset:4096
    v_mfma_f32_16x16x32_bf16 v[72:75], a[8:11], v[168:171], v[72:75]
    buffer_load_dwordx4 a[80:83], v8, s[44:47], s69 offen sc1
    v_mfma_f32_16x16x32_bf16 v[76:79], a[8:11], v[172:175], v[76:79]
    ds_write_b64 v20, a[212:213] offset:50176
    v_mfma_f32_16x16x32_bf16 v[92:95], a[12:15], v[172:175], v[92:95]
    v_add_u32 v13, 0x10000, v13
    ds_read_b64_tr_b16 a[4:5], v13 offset:0
    v_mfma_f32_16x16x32_bf16 v[88:91], a[12:15], v[168:171], v[88:91]
    ds_read_b64_tr_b16 a[6:7], v13 offset:4096
    v_mfma_f32_16x16x32_bf16 v[84:87], a[12:15], v[164:167], v[84:87]
    v_add_u32 v5, 4608, v7
    v_mfma_f32_16x16x32_bf16 v[80:83], a[12:15], v[160:163], v[80:83]
    ds_write_b64 v20, a[214:215] offset:50184
    s_waitcnt lgkmcnt(7)
    v_mfma_f32_16x16x32_bf16 v[96:99], a[16:19], v[160:163], v[96:99]
    v_add_u32 v14, 0x10000, v14
    ds_read_b64_tr_b16 a[8:9], v14 offset:0
    v_mfma_f32_16x16x32_bf16 v[100:103], a[16:19], v[164:167], v[100:103]
    ds_read_b64_tr_b16 a[10:11], v14 offset:4096
    v_mfma_f32_16x16x32_bf16 v[104:107], a[16:19], v[168:171], v[104:107]
    buffer_load_dwordx4 a[84:87], v9, s[44:47], s69 offen sc1
    v_mfma_f32_16x16x32_bf16 v[108:111], a[16:19], v[172:175], v[108:111]
    ds_write_b64 v20, a[216:217] offset:51200
    v_mfma_f32_16x16x32_bf16 v[124:127], a[20:23], v[172:175], v[124:127]
    v_add_u32 v15, 0x10000, v15
    ds_read_b64_tr_b16 a[12:13], v15 offset:0
    v_mfma_f32_16x16x32_bf16 v[120:123], a[20:23], v[168:171], v[120:123]
    ds_read_b64_tr_b16 a[14:15], v15 offset:4096
    v_mfma_f32_16x16x32_bf16 v[116:119], a[20:23], v[164:167], v[116:119]
    buffer_load_dwordx4 a[88:91], v10, s[44:47], s69 offen sc1
    v_mfma_f32_16x16x32_bf16 v[112:115], a[20:23], v[160:163], v[112:115]
    ds_write_b64 v20, a[218:219] offset:51208
    v_mfma_f32_16x16x32_bf16 v[128:131], a[24:27], v[160:163], v[128:131]
    v_add_u32 v16, 0x10000, v16
    ds_read_b64_tr_b16 a[16:17], v16 offset:0
    v_mfma_f32_16x16x32_bf16 v[132:135], a[24:27], v[164:167], v[132:135]
    ds_read_b64_tr_b16 a[18:19], v16 offset:4096
    v_mfma_f32_16x16x32_bf16 v[136:139], a[24:27], v[168:171], v[136:139]
    buffer_load_dwordx4 a[92:95], v11, s[44:47], s69 offen sc1
    v_mfma_f32_16x16x32_bf16 v[140:143], a[24:27], v[172:175], v[140:143]
    ds_write_b64 v20, a[220:221] offset:52224
    v_mfma_f32_16x16x32_bf16 v[156:159], a[28:31], v[172:175], v[156:159]
    v_add_u32 v17, 0x10000, v17
    ds_read_b64_tr_b16 a[20:21], v17 offset:0
    v_mfma_f32_16x16x32_bf16 v[152:155], a[28:31], v[168:171], v[152:155]
    ds_read_b64_tr_b16 a[22:23], v17 offset:4096
    v_mfma_f32_16x16x32_bf16 v[148:151], a[28:31], v[164:167], v[148:151]
    v_cndmask_b32 v25, v25, v5, vcc
    v_mfma_f32_16x16x32_bf16 v[144:147], a[28:31], v[160:163], v[144:147]
    ds_write_b64 v20, a[222:223] offset:52232
L_g2_s18:
    s_waitcnt vmcnt(24) lgkmcnt(7)
    v_mfma_f32_16x16x32_bf16 v[32:35], a[0:3], a[48:51], v[32:35]
    v_add_u32 v18, 0x10000, v18
    ds_read_b64_tr_b16 a[24:25], v18 offset:0
    v_mfma_f32_16x16x32_bf16 v[36:39], a[0:3], a[52:55], v[36:39]
    s_add_u32 s69, s30, 512000
    ds_read_b64_tr_b16 a[26:27], v18 offset:4096
    v_mfma_f32_16x16x32_bf16 v[40:43], a[0:3], a[56:59], v[40:43]
    buffer_load_dwordx4 v[208:211], v8, s[44:47], s69 offen sc1
    v_mfma_f32_16x16x32_bf16 v[44:47], a[0:3], a[60:63], v[44:47]
    v_add_u32 v20, 0x10000, v20
    ds_write_b64 v20, a[224:225] offset:0
    v_mfma_f32_16x16x32_bf16 v[60:63], a[4:7], a[60:63], v[60:63]
    v_add_u32 v19, 0x10000, v19
    ds_read_b64_tr_b16 a[28:29], v19 offset:0
    v_mfma_f32_16x16x32_bf16 v[56:59], a[4:7], a[56:59], v[56:59]
    ds_read_b64_tr_b16 a[30:31], v19 offset:4096
    v_mfma_f32_16x16x32_bf16 v[52:55], a[4:7], a[52:55], v[52:55]
    buffer_load_dwordx4 v[212:215], v9, s[44:47], s69 offen sc1
    v_mfma_f32_16x16x32_bf16 v[48:51], a[4:7], a[48:51], v[48:51]
    ds_write_b64 v20, a[226:227] offset:8
    v_mfma_f32_16x16x32_bf16 v[64:67], a[8:11], a[48:51], v[64:67]
    ds_read_b64_tr_b16 a[0:1], v12 offset:16384
    v_mfma_f32_16x16x32_bf16 v[68:71], a[8:11], a[52:55], v[68:71]
    ds_read_b64_tr_b16 a[2:3], v12 offset:20480
    v_mfma_f32_16x16x32_bf16 v[72:75], a[8:11], a[56:59], v[72:75]
    buffer_load_dwordx4 v[216:219], v10, s[44:47], s69 offen sc1
    v_mfma_f32_16x16x32_bf16 v[76:79], a[8:11], a[60:63], v[76:79]
    ds_write_b64 v20, a[228:229] offset:1024
    v_mfma_f32_16x16x32_bf16 v[92:95], a[12:15], a[60:63], v[92:95]
    ds_read_b64_tr_b16 a[4:5], v13 offset:16384
    v_mfma_f32_16x16x32_bf16 v[88:91], a[12:15], a[56:59], v[88:91]
    ds_read_b64_tr_b16 a[6:7], v13 offset:20480
    v_mfma_f32_16x16x32_bf16 v[84:87], a[12:15], a[52:55], v[84:87]
    v_mfma_f32_16x16x32_bf16 v[80:83], a[12:15], a[48:51], v[80:83]
    ds_write_b64 v20, a[230:231] offset:1032
    s_waitcnt lgkmcnt(7)
    v_mfma_f32_16x16x32_bf16 v[96:99], a[16:19], a[48:51], v[96:99]
    ds_read_b64_tr_b16 a[8:9], v14 offset:16384
    v_mfma_f32_16x16x32_bf16 v[100:103], a[16:19], a[52:55], v[100:103]
    ds_read_b64_tr_b16 a[10:11], v14 offset:20480
    v_mfma_f32_16x16x32_bf16 v[104:107], a[16:19], a[56:59], v[104:107]
    buffer_load_dwordx4 v[220:223], v11, s[44:47], s69 offen sc1
    v_mfma_f32_16x16x32_bf16 v[108:111], a[16:19], a[60:63], v[108:111]
    ds_write_b64 v20, a[232:233] offset:2048
    v_mfma_f32_16x16x32_bf16 v[124:127], a[20:23], a[60:63], v[124:127]
    ds_read_b64_tr_b16 a[12:13], v15 offset:16384
    v_mfma_f32_16x16x32_bf16 v[120:123], a[20:23], a[56:59], v[120:123]
    s_add_u32 s69, s30, 532480
    ds_read_b64_tr_b16 a[14:15], v15 offset:20480
    v_mfma_f32_16x16x32_bf16 v[116:119], a[20:23], a[52:55], v[116:119]
    buffer_load_dwordx4 a[128:131], v8, s[44:47], s69 offen sc1
    v_mfma_f32_16x16x32_bf16 v[112:115], a[20:23], a[48:51], v[112:115]
    ds_write_b64 v20, a[234:235] offset:2056
    v_mfma_f32_16x16x32_bf16 v[128:131], a[24:27], a[48:51], v[128:131]
    ds_read_b64_tr_b16 a[16:17], v16 offset:16384
    v_mfma_f32_16x16x32_bf16 v[132:135], a[24:27], a[52:55], v[132:135]
    ds_read_b64_tr_b16 a[18:19], v16 offset:20480
    v_mfma_f32_16x16x32_bf16 v[136:139], a[24:27], a[56:59], v[136:139]
    buffer_load_dwordx4 a[132:135], v9, s[44:47], s69 offen sc1
    v_mfma_f32_16x16x32_bf16 v[140:143], a[24:27], a[60:63], v[140:143]
    ds_write_b64 v20, a[236:237] offset:3072
    v_mfma_f32_16x16x32_bf16 v[156:159], a[28:31], a[60:63], v[156:159]
    ds_read_b64_tr_b16 a[20:21], v17 offset:16384
    v_mfma_f32_16x16x32_bf16 v[152:155], a[28:31], a[56:59], v[152:155]
    ds_read_b64_tr_b16 a[22:23], v17 offset:20480
    v_mfma_f32_16x16x32_bf16 v[148:151], a[28:31], a[52:55], v[148:151]
    v_mfma_f32_16x16x32_bf16 v[144:147], a[28:31], a[48:51], v[144:147]
    ds_write_b64 v20, a[238:239] offset:3080
L_g2_s19:
    s_waitcnt vmcnt(26) lgkmcnt(7)
    v_mfma_f32_16x16x32_bf16 v[32:35], a[0:3], v[176:179], v[32:35]
    ds_read_b64_tr_b16 a[24:25], v18 offset:16384
    v_mfma_f32_16x16x32_bf16 v[36:39], a[0:3], v[180:183], v[36:39]
    ds_read_b64_tr_b16 a[26:27], v18 offset:20480
    v_mfma_f32_16x16x32_bf16 v[40:43], a[0:3], v[184:187], v[40:43]
    buffer_load_dwordx4 a[136:139], v10, s[44:47], s69 offen sc1
    v_mfma_f32_16x16x32_bf16 v[44:47], a[0:3], v[188:191], v[44:47]
    ds_write_b64 v20, a[240:241] offset:16384
    v_mfma_f32_16x16x32_bf16 v[60:63], a[4:7], v[188:191], v[60:63]
    ds_read_b64_tr_b16 a[28:29], v19 offset:16384
    v_mfma_f32_16x16x32_bf16 v[56:59], a[4:7], v[184:187], v[56:59]
    ds_read_b64_tr_b16 a[30:31], v19 offset:20480
    v_mfma_f32_16x16x32_bf16 v[52:55], a[4:7], v[180:183], v[52:55]
    buffer_load_dwordx4 a[140:143], v11, s[44:47], s69 offen sc1
    v_mfma_f32_16x16x32_bf16 v[48:51], a[4:7], v[176:179], v[48:51]
    ds_write_b64 v20, a[242:243] offset:16392
    v_mfma_f32_16x16x32_bf16 v[64:67], a[8:11], v[176:179], v[64:67]
    v_add_u32 v18, 0xfffe0000, v18
    ds_read_b64_tr_b16 a[0:1], v18 offset:0
    v_mfma_f32_16x16x32_bf16 v[68:71], a[8:11], v[180:183], v[68:71]
    s_add_u32 s69, s30, 552960
    ds_read_b64_tr_b16 a[2:3], v18 offset:4096
    v_mfma_f32_16x16x32_bf16 v[72:75], a[8:11], v[184:187], v[72:75]
    buffer_load_dwordx4 a[32:35], v8, s[44:47], s69 offen sc1
    v_mfma_f32_16x16x32_bf16 v[76:79], a[8:11], v[188:191], v[76:79]
    ds_write_b64 v20, a[244:245] offset:17408
    v_mfma_f32_16x16x32_bf16 v[92:95], a[12:15], v[188:191], v[92:95]
    v_add_u32 v19, 0xfffe0000, v19
    ds_read_b64_tr_b16 a[4:5], v19 offset:0
    v_mfma_f32_16x16x32_bf16 v[88:91], a[12:15], v[184:187], v[88:91]
    ds_read_b64_tr_b16 a[6:7], v19 offset:4096
    v_mfma_f32_16x16x32_bf16 v[84:87], a[12:15], v[180:183], v[84:87]
    v_mfma_f32_16x16x32_bf16 v[80:83], a[12:15], v[176:179], v[80:83]
    ds_write_b64 v20, a[246:247] offset:17416
    s_waitcnt lgkmcnt(7)
    v_mfma_f32_16x16x32_bf16 v[96:99], a[16:19], v[176:179], v[96:99]
    v_add_u32 v16, 0xfffe0000, v16
    ds_read_b64_tr_b16 a[8:9], v16 offset:0
    v_mfma_f32_16x16x32_bf16 v[100:103], a[16:19], v[180:183], v[100:103]
    ds_read_b64_tr_b16 a[10:11], v16 offset:4096
    v_mfma_f32_16x16x32_bf16 v[104:107], a[16:19], v[184:187], v[104:107]
    buffer_load_dwordx4 a[36:39], v9, s[44:47], s69 offen sc1
    v_mfma_f32_16x16x32_bf16 v[108:111], a[16:19], v[188:191], v[108:111]
    ds_write_b64 v20, a[248:249] offset:18432
    v_mfma_f32_16x16x32_bf16 v[124:127], a[20:23], v[188:191], v[124:127]
    v_add_u32 v17, 0xfffe0000, v17
    ds_read_b64_tr_b16 a[12:13], v17 offset:0
    v_mfma_f32_16x16x32_bf16 v[120:123], a[20:23], v[184:187], v[120:123]
    ds_read_b64_tr_b16 a[14:15], v17 offset:4096
    v_mfma_f32_16x16x32_bf16 v[116:119], a[20:23], v[180:183], v[116:119]
    buffer_load_dwordx4 a[40:43], v10, s[44:47], s69 offen sc1
    v_mfma_f32_16x16x32_bf16 v[112:115], a[20:23], v[176:179], v[112:115]
    ds_write_b64 v20, a[250:251] offset:18440
    v_mfma_f32_16x16x32_bf16 v[128:131], a[24:27], v[176:179], v[128:131]
    ds_read_b64_tr_b16 a[16:17], v18 offset:16384
    v_mfma_f32_16x16x32_bf16 v[132:135], a[24:27], v[180:183], v[132:135]
    ds_read_b64_tr_b16 a[18:19], v18 offset:20480
    v_mfma_f32_16x16x32_bf16 v[136:139], a[24:27], v[184:187], v[136:139]
    buffer_load_dwordx4 a[44:47], v11, s[44:47], s69 offen sc1
    v_mfma_f32_16x16x32_bf16 v[140:143], a[24:27], v[188:191], v[140:143]
    ds_write_b64 v20, a[252:253] offset:19456
    v_mfma_f32_16x16x32_bf16 v[156:159], a[28:31], v[188:191], v[156:159]
    ds_read_b64_tr_b16 a[20:21], v19 offset:16384
    v_mfma_f32_16x16x32_bf16 v[152:155], a[28:31], v[184:187], v[152:155]
    ds_read_b64_tr_b16 a[22:23], v19 offset:20480
    v_mfma_f32_16x16x32_bf16 v[148:151], a[28:31], v[180:183], v[148:151]
    v_mfma_f32_16x16x32_bf16 v[144:147], a[28:31], v[176:179], v[144:147]
    ds_write_b64 v20, a[254:255] offset:19464
L_g2_s20:
    s_waitcnt vmcnt(28) lgkmcnt(0)
    s_barrier
    v_mfma_f32_16x16x32_bf16 v[128:131], a[0:3], a[96:99], v[128:131]
    ds_read_b64_tr_b16 a[24:25], v16 offset:16384
    v_mfma_f32_16x16x32_bf16 v[132:135], a[0:3], a[100:103], v[132:135]
    ds_read_b64_tr_b16 a[26:27], v16 offset:20480
    v_mfma_f32_16x16x32_bf16 v[136:139], a[0:3], a[104:107], v[136:139]
    v_mfma_f32_16x16x32_bf16 v[140:143], a[0:3], a[108:111], v[140:143]
    ds_write_b64 v20, v[240:241] offset:32768
    v_mfma_f32_16x16x32_bf16 v[156:159], a[4:7], a[108:111], v[156:159]
    ds_read_b64_tr_b16 a[28:29], v17 offset:16384
    v_mfma_f32_16x16x32_bf16 v[152:155], a[4:7], a[104:107], v[152:155]
    ds_read_b64_tr_b16 a[30:31], v17 offset:20480
    v_mfma_f32_16x16x32_bf16 v[148:151], a[4:7], a[100:103], v[148:151]
    v_mfma_f32_16x16x32_bf16 v[144:147], a[4:7], a[96:99], v[144:147]
    ds_write_b64 v20, v[242:243] offset:32776
    v_mfma_f32_16x16x32_bf16 v[96:99], a[8:11], a[96:99], v[96:99]
    ds_read_b64_tr_b16 a[0:1], v18 offset:32768
    v_mfma_f32_16x16x32_bf16 v[100:103], a[8:11], a[100:103], v[100:103]
    ds_read_b64_tr_b16 a[2:3], v18 offset:36864
    v_mfma_f32_16x16x32_bf16 v[104:107], a[8:11], a[104:107], v[104:107]
    v_mfma_f32_16x16x32_bf16 v[108:111], a[8:11], a[108:111], v[108:111]
    ds_write_b64 v20, v[244:245] offset:33792
    v_mfma_f32_16x16x32_bf16 v[124:127], a[12:15], a[108:111], v[124:127]
    ds_read_b64_tr_b16 a[4:5], v19 offset:32768
    v_mfma_f32_16x16x32_bf16 v[120:123], a[12:15], a[104:107], v[120:123]
    ds_read_b64_tr_b16 a[6:7], v19 offset:36864
    v_mfma_f32_16x16x32_bf16 v[116:119], a[12:15], a[100:103], v[116:119]
    v_mfma_f32_16x16x32_bf16 v[112:115], a[12:15], a[96:99], v[112:115]
    ds_write_b64 v20, v[246:247] offset:33800
    s_waitcnt vmcnt(24) lgkmcnt(7)
    v_mfma_f32_16x16x32_bf16 v[128:131], a[16:19], a[64:67], v[128:131]
    ds_read_b64_tr_b16 a[8:9], v16 offset:32768
    v_mfma_f32_16x16x32_bf16 v[132:135], a[16:19], a[68:71], v[132:135]
    ds_read_b64_tr_b16 a[10:11], v16 offset:36864
    v_mfma_f32_16x16x32_bf16 v[136:139], a[16:19], a[72:75], v[136:139]
    v_mfma_f32_16x16x32_bf16 v[140:143], a[16:19], a[76:79], v[140:143]
    ds_write_b64 v20, v[248:249] offset:34816
    v_mfma_f32_16x16x32_bf16 v[156:159], a[20:23], a[76:79], v[156:159]
    ds_read_b64_tr_b16 a[12:13], v17 offset:32768
    v_mfma_f32_16x16x32_bf16 v[152:155], a[20:23], a[72:75], v[152:155]
    ds_read_b64_tr_b16 a[14:15], v17 offset:36864
    v_mfma_f32_16x16x32_bf16 v[148:151], a[20:23], a[68:71], v[148:151]
    v_mfma_f32_16x16x32_bf16 v[144:147], a[20:23], a[64:67], v[144:147]
    ds_write_b64 v20, v[250:251] offset:34824
    v_mfma_f32_16x16x32_bf16 v[96:99], a[24:27], a[64:67], v[96:99]
    ds_read_b64_tr_b16 a[16:17], v18 offset:49152
    v_mfma_f32_16x16x32_bf16 v[100:103], a[24:27], a[68:71], v[100:103]
    ds_read_b64_tr_b16 a[18:19], v18 offset:53248
    v_mfma_f32_16x16x32_bf16 v[104:107], a[24:27], a[72:75], v[104:107]
    v_mfma_f32_16x16x32_bf16 v[108:111], a[24:27], a[76:79], v[108:111]
    ds_write_b64 v20, v[252:253] offset:35840
    v_mfma_f32_16x16x32_bf16 v[124:127], a[28:31], a[76:79], v[124:127]
    ds_read_b64_tr_b16 a[20:21], v19 offset:49152
    v_mfma_f32_16x16x32_bf16 v[120:123], a[28:31], a[72:75], v[120:123]
    ds_read_b64_tr_b16 a[22:23], v19 offset:53248
    v_mfma_f32_16x16x32_bf16 v[116:119], a[28:31], a[68:71], v[116:119]
    v_mfma_f32_16x16x32_bf16 v[112:115], a[28:31], a[64:67], v[112:115]
    ds_write_b64 v20, v[254:255] offset:35848
L_g2_s21:
    s_waitcnt vmcnt(20) lgkmcnt(7)
    v_mfma_f32_16x16x32_bf16 v[128:131], a[0:3], v[192:195], v[128:131]
    ds_read_b64_tr_b16 a[24:25], v16 offset:49152
    v_mfma_f32_16x16x32_bf16 v[132:135], a[0:3], v[196:199], v[132:135]
    ds_read_b64_tr_b16 a[26:27], v16 offset:53248
    v_mfma_f32_16x16x32_bf16 v[136:139], a[0:3], v[200:203], v[136:139]
    v_mfma_f32_16x16x32_bf16 v[140:143], a[0:3], v[204:207], v[140:143]
    ds_write_b64 v20, v[224:225] offset:49152
    v_mfma_f32_16x16x32_bf16 v[156:159], a[4:7], v[204:207], v[156:159]
    ds_read_b64_tr_b16 a[28:29], v17 offset:49152
    v_mfma_f32_16x16x32_bf16 v[152:155], a[4:7], v[200:203], v[152:155]
    ds_read_b64_tr_b16 a[30:31], v17 offset:53248
    v_mfma_f32_16x16x32_bf16 v[148:151], a[4:7], v[196:199], v[148:151]
    v_mfma_f32_16x16x32_bf16 v[144:147], a[4:7], v[192:195], v[144:147]
    ds_write_b64 v20, v[226:227] offset:49160
    v_mfma_f32_16x16x32_bf16 v[96:99], a[8:11], v[192:195], v[96:99]
    v_add_u32 v18, 0x10000, v18
    ds_read_b64_tr_b16 a[0:1], v18 offset:0
    v_mfma_f32_16x16x32_bf16 v[100:103], a[8:11], v[196:199], v[100:103]
    ds_read_b64_tr_b16 a[2:3], v18 offset:4096
    v_mfma_f32_16x16x32_bf16 v[104:107], a[8:11], v[200:203], v[104:107]
    v_mfma_f32_16x16x32_bf16 v[108:111], a[8:11], v[204:207], v[108:111]
    ds_write_b64 v20, v[228:229] offset:50176
    v_mfma_f32_16x16x32_bf16 v[124:127], a[12:15], v[204:207], v[124:127]
    v_add_u32 v19, 0x10000, v19
    ds_read_b64_tr_b16 a[4:5], v19 offset:0
    v_mfma_f32_16x16x32_bf16 v[120:123], a[12:15], v[200:203], v[120:123]
    ds_read_b64_tr_b16 a[6:7], v19 offset:4096
    v_mfma_f32_16x16x32_bf16 v[116:119], a[12:15], v[196:199], v[116:119]
    v_mfma_f32_16x16x32_bf16 v[112:115], a[12:15], v[192:195], v[112:115]
    ds_write_b64 v20, v[230:231] offset:50184
    s_waitcnt vmcnt(16) lgkmcnt(7)
    v_mfma_f32_16x16x32_bf16 v[128:131], a[16:19], a[112:115], v[128:131]
    v_add_u32 v16, 0x10000, v16
    ds_read_b64_tr_b16 a[8:9], v16 offset:0
    v_mfma_f32_16x16x32_bf16 v[132:135], a[16:19], a[116:119], v[132:135]
    ds_read_b64_tr_b16 a[10:11], v16 offset:4096
    v_mfma_f32_16x16x32_bf16 v[136:139], a[16:19], a[120:123], v[136:139]
    v_mfma_f32_16x16x32_bf16 v[140:143], a[16:19], a[124:127], v[140:143]
    ds_write_b64 v20, v[232:233] offset:51200
    v_mfma_f32_16x16x32_bf16 v[156:159], a[20:23], a[124:127], v[156:159]
    v_add_u32 v17, 0x10000, v17
    ds_read_b64_tr_b16 a[12:13], v17 offset:0
    v_mfma_f32_16x16x32_bf16 v[152:155], a[20:23], a[120:123], v[152:155]
    ds_read_b64_tr_b16 a[14:15], v17 offset:4096
    v_mfma_f32_16x16x32_bf16 v[148:151], a[20:23], a[116:119], v[148:151]
    v_mfma_f32_16x16x32_bf16 v[144:147], a[20:23], a[112:115], v[144:147]
    ds_write_b64 v20, v[234:235] offset:51208
    v_mfma_f32_16x16x32_bf16 v[96:99], a[24:27], a[112:115], v[96:99]
    ds_read_b64_tr_b16 a[16:17], v18 offset:16384
    v_mfma_f32_16x16x32_bf16 v[100:103], a[24:27], a[116:119], v[100:103]
    ds_read_b64_tr_b16 a[18:19], v18 offset:20480
    v_mfma_f32_16x16x32_bf16 v[104:107], a[24:27], a[120:123], v[104:107]
    v_mfma_f32_16x16x32_bf16 v[108:111], a[24:27], a[124:127], v[108:111]
    ds_write_b64 v20, v[236:237] offset:52224
    v_mfma_f32_16x16x32_bf16 v[124:127], a[28:31], a[124:127], v[124:127]
    ds_read_b64_tr_b16 a[20:21], v19 offset:16384
    v_mfma_f32_16x16x32_bf16 v[120:123], a[28:31], a[120:123], v[120:123]
    ds_read_b64_tr_b16 a[22:23], v19 offset:20480
    v_mfma_f32_16x16x32_bf16 v[116:119], a[28:31], a[116:119], v[116:119]
    v_mfma_f32_16x16x32_bf16 v[112:115], a[28:31], a[112:115], v[112:115]
    ds_write_b64 v20, v[238:239] offset:52232
L_g2_k:
    s_waitcnt vmcnt(60) lgkmcnt(0)
    s_barrier
    s_waitcnt vmcnt(12) lgkmcnt(7)
    v_mfma_f32_16x16x32_bf16 v[128:131], a[0:3], a[80:83], v[128:131]
    ds_read_b64_tr_b16 a[24:25], v18 offset:32768
    v_mfma_f32_16x16x32_bf16 v[132:135], a[0:3], a[84:87], v[132:135]
    ds_read_b64_tr_b16 a[26:27], v18 offset:36864
    v_mfma_f32_16x16x32_bf16 v[136:139], a[0:3], a[88:91], v[136:139]
    v_mfma_f32_16x16x32_bf16 v[140:143], a[0:3], a[92:95], v[140:143]
    v_mfma_f32_16x16x32_bf16 v[156:159], a[4:7], a[92:95], v[156:159]
    ds_read_b64_tr_b16 a[28:29], v19 offset:32768
    v_mfma_f32_16x16x32_bf16 v[152:155], a[4:7], a[88:91], v[152:155]
    ds_read_b64_tr_b16 a[30:31], v19 offset:36864
    v_mfma_f32_16x16x32_bf16 v[148:151], a[4:7], a[84:87], v[148:151]
    buffer_load_dwordx4 v[224:227], v22, s[44:47], s77 offen sc1
    v_mfma_f32_16x16x32_bf16 v[144:147], a[4:7], a[80:83], v[144:147]
    v_mfma_f32_16x16x32_bf16 v[96:99], a[8:11], a[80:83], v[96:99]
    ds_read_b64_tr_b16 a[0:1], v18 offset:49152
    v_mfma_f32_16x16x32_bf16 v[100:103], a[8:11], a[84:87], v[100:103]
    ds_read_b64_tr_b16 a[2:3], v18 offset:53248
    v_mfma_f32_16x16x32_bf16 v[104:107], a[8:11], a[88:91], v[104:107]
    buffer_load_dwordx4 v[228:231], v23, s[44:47], s77 offen sc1
    v_mfma_f32_16x16x32_bf16 v[108:111], a[8:11], a[92:95], v[108:111]
    v_mfma_f32_16x16x32_bf16 v[124:127], a[12:15], a[92:95], v[124:127]
    ds_read_b64_tr_b16 a[4:5], v19 offset:49152
    v_mfma_f32_16x16x32_bf16 v[120:123], a[12:15], a[88:91], v[120:123]
    ds_read_b64_tr_b16 a[6:7], v19 offset:53248
    v_mfma_f32_16x16x32_bf16 v[116:119], a[12:15], a[84:87], v[116:119]
    v_mfma_f32_16x16x32_bf16 v[112:115], a[12:15], a[80:83], v[112:115]
    s_waitcnt vmcnt(10) lgkmcnt(4)
    v_mfma_f32_16x16x32_bf16 v[128:131], a[16:19], v[208:211], v[128:131]
    ds_read_b64_tr_b16 a[8:9], v16 offset:16384
    v_mfma_f32_16x16x32_bf16 v[132:135], a[16:19], v[212:215], v[132:135]
    ds_read_b64_tr_b16 a[10:11], v16 offset:20480
    v_mfma_f32_16x16x32_bf16 v[136:139], a[16:19], v[216:219], v[136:139]
    buffer_load_dwordx4 v[232:235], v24, s[44:47], s77 offen sc1
    v_mfma_f32_16x16x32_bf16 v[140:143], a[16:19], v[220:223], v[140:143]
    v_mfma_f32_16x16x32_bf16 v[156:159], a[20:23], v[220:223], v[156:159]
    ds_read_b64_tr_b16 a[12:13], v17 offset:16384
    v_mfma_f32_16x16x32_bf16 v[152:155], a[20:23], v[216:219], v[152:155]
    ds_read_b64_tr_b16 a[14:15], v17 offset:20480
    v_mfma_f32_16x16x32_bf16 v[148:151], a[20:23], v[212:215], v[148:151]
    v_mfma_f32_16x16x32_bf16 v[144:147], a[20:23], v[208:211], v[144:147]
    s_waitcnt vmcnt(7) lgkmcnt(8)
    v_mfma_f32_16x16x32_bf16 v[128:131], a[24:27], a[128:131], v[128:131]
    ds_read_b64_tr_b16 a[16:17], v16 offset:32768
    v_mfma_f32_16x16x32_bf16 v[132:135], a[24:27], a[132:135], v[132:135]
    ds_read_b64_tr_b16 a[18:19], v16 offset:36864
    v_mfma_f32_16x16x32_bf16 v[136:139], a[24:27], a[136:139], v[136:139]
    buffer_load_dwordx4 v[236:239], v25, s[44:47], s77 offen sc1
    v_mfma_f32_16x16x32_bf16 v[140:143], a[24:27], a[140:143], v[140:143]
    v_mfma_f32_16x16x32_bf16 v[156:159], a[28:31], a[140:143], v[156:159]
    ds_read_b64_tr_b16 a[20:21], v17 offset:32768
    v_mfma_f32_16x16x32_bf16 v[152:155], a[28:31], a[136:139], v[152:155]
    ds_read_b64_tr_b16 a[22:23], v17 offset:36864
    v_mfma_f32_16x16x32_bf16 v[148:151], a[28:31], a[132:135], v[148:151]
    v_mfma_f32_16x16x32_bf16 v[144:147], a[28:31], a[128:131], v[144:147]
    s_waitcnt vmcnt(4) lgkmcnt(4)
    v_mfma_f32_16x16x32_bf16 v[128:131], a[0:3], a[32:35], v[128:131]
    ds_read_b64_tr_b16 a[24:25], v16 offset:49152
    v_mfma_f32_16x16x32_bf16 v[132:135], a[0:3], a[36:39], v[132:135]
    ds_read_b64_tr_b16 a[26:27], v16 offset:53248
    v_mfma_f32_16x16x32_bf16 v[136:139], a[0:3], a[40:43], v[136:139]
    v_mfma_f32_16x16x32_bf16 v[140:143], a[0:3], a[44:47], v[140:143]
    v_mfma_f32_16x16x32_bf16 v[156:159], a[4:7], a[44:47], v[156:159]
    ds_read_b64_tr_b16 a[28:29], v17 offset:49152
    v_mfma_f32_16x16x32_bf16 v[152:155], a[4:7], a[40:43], v[152:155]
    ds_read_b64_tr_b16 a[30:31], v17 offset:53248
    v_mfma_f32_16x16x32_bf16 v[148:151], a[4:7], a[36:39], v[148:151]
    v_mfma_f32_16x16x32_bf16 v[144:147], a[4:7], a[32:35], v[144:147]
    v_mfma_f32_16x16x32_bf16 v[96:99], a[8:11], v[208:211], v[96:99]
    v_add_u32 v14, 0xfffe0000, v14
    ds_read_b64_tr_b16 a[0:1], v14 offset:0
    v_mfma_f32_16x16x32_bf16 v[100:103], a[8:11], v[212:215], v[100:103]
    ds_read_b64_tr_b16 a[2:3], v14 offset:4096
    v_mfma_f32_16x16x32_bf16 v[104:107], a[8:11], v[216:219], v[104:107]
    v_mfma_f32_16x16x32_bf16 v[108:111], a[8:11], v[220:223], v[108:111]
    v_mfma_f32_16x16x32_bf16 v[124:127], a[12:15], v[220:223], v[124:127]
    v_add_u32 v15, 0xfffe0000, v15
    ds_read_b64_tr_b16 a[4:5], v15 offset:0
    v_mfma_f32_16x16x32_bf16 v[120:123], a[12:15], v[216:219], v[120:123]
    ds_read_b64_tr_b16 a[6:7], v15 offset:4096
    v_mfma_f32_16x16x32_bf16 v[116:119], a[12:15], v[212:215], v[116:119]
    ds_write_b128 v3, v[128:131] offset:0
    v_mfma_f32_16x16x32_bf16 v[112:115], a[12:15], v[208:211], v[112:115]
    ds_write_b128 v3, v[132:135] offset:1024
    s_waitcnt lgkmcnt(6)
    v_mfma_f32_16x16x32_bf16 v[96:99], a[16:19], a[128:131], v[96:99]
    ds_read_b64_tr_b16 a[8:9], v14 offset:16384
    v_mfma_f32_16x16x32_bf16 v[100:103], a[16:19], a[132:135], v[100:103]
    ds_read_b64_tr_b16 a[10:11], v14 offset:20480
    v_mfma_f32_16x16x32_bf16 v[104:107], a[16:19], a[136:139], v[104:107]
    ds_write_b128 v3, v[136:139] offset:2048
    v_mfma_f32_16x16x32_bf16 v[108:111], a[16:19], a[140:143], v[108:111]
    ds_write_b128 v3, v[140:143] offset:3072
    v_mfma_f32_16x16x32_bf16 v[124:127], a[20:23], a[140:143], v[124:127]
    ds_read_b64_tr_b16 a[12:13], v15 offset:16384
    v_mfma_f32_16x16x32_bf16 v[120:123], a[20:23], a[136:139], v[120:123]
    ds_read_b64_tr_b16 a[14:15], v15 offset:20480
    v_mfma_f32_16x16x32_bf16 v[116:119], a[20:23], a[132:135], v[116:119]
    v_mfma_f32_16x16x32_bf16 v[112:115], a[20:23], a[128:131], v[112:115]
    ds_write_b128 v3, v[144:147] offset:4096
    v_mfma_f32_16x16x32_bf16 v[96:99], a[24:27], a[32:35], v[96:99]
    ds_read_b64_tr_b16 a[16:17], v14 offset:32768
    v_mfma_f32_16x16x32_bf16 v[100:103], a[24:27], a[36:39], v[100:103]
    ds_read_b64_tr_b16 a[18:19], v14 offset:36864
    v_mfma_f32_16x16x32_bf16 v[104:107], a[24:27], a[40:43], v[104:107]
    ds_write_b128 v3, v[148:151] offset:5120
    v_mfma_f32_16x16x32_bf16 v[108:111], a[24:27], a[44:47], v[108:111]
    ds_write_b128 v3, v[152:155] offset:6144
    v_mfma_f32_16x16x32_bf16 v[124:127], a[28:31], a[44:47], v[124:127]
    ds_read_b64_tr_b16 a[20:21], v15 offset:32768
    v_mfma_f32_16x16x32_bf16 v[120:123], a[28:31], a[40:43], v[120:123]
    ds_read_b64_tr_b16 a[22:23], v15 offset:36864
    v_mfma_f32_16x16x32_bf16 v[116:119], a[28:31], a[36:39], v[116:119]
    ds_write_b128 v3, v[156:159] offset:7168
    v_mfma_f32_16x16x32_bf16 v[112:115], a[28:31], a[32:35], v[112:115]
    s_waitcnt lgkmcnt(0)
    s_barrier
    s_waitcnt lgkmcnt(8)
    v_mfma_f32_16x16x32_bf16 v[64:67], a[0:3], a[96:99], v[64:67]
    ds_read_b64_tr_b16 a[24:25], v14 offset:49152
    v_mfma_f32_16x16x32_bf16 v[68:71], a[0:3], a[100:103], v[68:71]
    ds_read_b64_tr_b16 a[26:27], v14 offset:53248
    v_mfma_f32_16x16x32_bf16 v[72:75], a[0:3], a[104:107], v[72:75]
    ds_read_b128 v[128:131], v4 offset:0
    v_mfma_f32_16x16x32_bf16 v[76:79], a[0:3], a[108:111], v[76:79]
    ds_read_b128 v[144:147], v4 offset:4096
    v_mfma_f32_16x16x32_bf16 v[92:95], a[4:7], a[108:111], v[92:95]
    ds_read_b64_tr_b16 a[28:29], v15 offset:49152
    v_mfma_f32_16x16x32_bf16 v[88:91], a[4:7], a[104:107], v[88:91]
    ds_read_b64_tr_b16 a[30:31], v15 offset:53248
    v_mfma_f32_16x16x32_bf16 v[84:87], a[4:7], a[100:103], v[84:87]
    ds_read_b128 v[132:135], v4 offset:1024
    v_mfma_f32_16x16x32_bf16 v[80:83], a[4:7], a[96:99], v[80:83]
    ds_read_b128 v[148:151], v4 offset:5120
    v_mfma_f32_16x16x32_bf16 v[64:67], a[8:11], a[64:67], v[64:67]
    v_add_u32 v14, 0x10000, v14
    ds_read_b64_tr_b16 a[0:1], v14 offset:0
    v_mfma_f32_16x16x32_bf16 v[68:71], a[8:11], a[68:71], v[68:71]
    ds_read_b64_tr_b16 a[2:3], v14 offset:4096
    v_mfma_f32_16x16x32_bf16 v[72:75], a[8:11], a[72:75], v[72:75]
    ds_read_b128 v[136:139], v4 offset:2048
    v_mfma_f32_16x16x32_bf16 v[76:79], a[8:11], a[76:79], v[76:79]
    ds_read_b128 v[152:155], v4 offset:6144
    v_mfma_f32_16x16x32_bf16 v[92:95], a[12:15], a[76:79], v[92:95]
    v_add_u32 v15, 0x10000, v15
    ds_read_b64_tr_b16 a[4:5], v15 offset:0
    v_mfma_f32_16x16x32_bf16 v[88:91], a[12:15], a[72:75], v[88:91]
    ds_read_b64_tr_b16 a[6:7], v15 offset:4096
    v_mfma_f32_16x16x32_bf16 v[84:87], a[12:15], a[68:71], v[84:87]
    ds_read_b128 v[140:143], v4 offset:3072
    v_mfma_f32_16x16x32_bf16 v[80:83], a[12:15], a[64:67], v[80:83]
    ds_read_b128 v[156:159], v4 offset:7168
    s_waitcnt lgkmcnt(10)
    v_mfma_f32_16x16x32_bf16 v[64:67], a[16:19], v[192:195], v[64:67]
    ds_read_b64_tr_b16 a[8:9], v14 offset:16384
    v_mfma_f32_16x16x32_bf16 v[68:71], a[16:19], v[196:199], v[68:71]
    ds_read_b64_tr_b16 a[10:11], v14 offset:20480
    v_mfma_f32_16x16x32_bf16 v[72:75], a[16:19], v[200:203], v[72:75]
    s_waitcnt lgkmcnt(2)
    v_add_f32 v96, v96, v128
    v_add_f32 v97, v97, v129
    v_mfma_f32_16x16x32_bf16 v[76:79], a[16:19], v[204:207], v[76:79]
    v_add_f32 v98, v98, v130
    v_add_f32 v99, v99, v131
    v_add_f32 v112, v112, v144
    v_mfma_f32_16x16x32_bf16 v[92:95], a[20:23], v[204:207], v[92:95]
    ds_read_b64_tr_b16 a[12:13], v15 offset:16384
    v_add_f32 v113, v113, v145
    v_add_f32 v114, v114, v146
    v_mfma_f32_16x16x32_bf16 v[88:91], a[20:23], v[200:203], v[88:91]
    ds_read_b64_tr_b16 a[14:15], v15 offset:20480
    v_add_f32 v115, v115, v147
    v_cvt_pk_bf16_f32 v96, v96, v97
    v_mfma_f32_16x16x32_bf16 v[84:87], a[20:23], v[196:199], v[84:87]
    v_cvt_pk_bf16_f32 v97, v98, v99
    v_cvt_pk_bf16_f32 v98, v112, v113
    v_cvt_pk_bf16_f32 v99, v114, v115
    v_mfma_f32_16x16x32_bf16 v[80:83], a[20:23], v[192:195], v[80:83]
    buffer_store_dwordx4 v[96:99], v8, s[44:47], s78 offen sc1
    v_add_f32 v100, v100, v132
    v_add_f32 v101, v101, v133
    v_mfma_f32_16x16x32_bf16 v[64:67], a[24:27], a[112:115], v[64:67]
    ds_read_b64_tr_b16 a[16:17], v14 offset:32768
    v_add_f32 v102, v102, v134
    v_add_f32 v103, v103, v135
    v_mfma_f32_16x16x32_bf16 v[68:71], a[24:27], a[116:119], v[68:71]
    ds_read_b64_tr_b16 a[18:19], v14 offset:36864
    v_add_f32 v116, v116, v148
    v_add_f32 v117, v117, v149
    v_mfma_f32_16x16x32_bf16 v[72:75], a[24:27], a[120:123], v[72:75]
    v_add_f32 v118, v118, v150
    v_add_f32 v119, v119, v151
    v_cvt_pk_bf16_f32 v100, v100, v101
    v_mfma_f32_16x16x32_bf16 v[76:79], a[24:27], a[124:127], v[76:79]
    v_cvt_pk_bf16_f32 v101, v102, v103
    v_cvt_pk_bf16_f32 v102, v116, v117
    v_cvt_pk_bf16_f32 v103, v118, v119
    v_mfma_f32_16x16x32_bf16 v[92:95], a[28:31], a[124:127], v[92:95]
    ds_read_b64_tr_b16 a[20:21], v15 offset:32768
    buffer_store_dwordx4 v[100:103], v9, s[44:47], s78 offen sc1
    v_add_f32 v104, v104, v136
    v_mfma_f32_16x16x32_bf16 v[88:91], a[28:31], a[120:123], v[88:91]
    ds_read_b64_tr_b16 a[22:23], v15 offset:36864
    v_add_f32 v105, v105, v137
    v_add_f32 v106, v106, v138
    v_mfma_f32_16x16x32_bf16 v[84:87], a[28:31], a[116:119], v[84:87]
    v_add_f32 v107, v107, v139
    v_add_f32 v120, v120, v152
    v_add_f32 v121, v121, v153
    v_mfma_f32_16x16x32_bf16 v[80:83], a[28:31], a[112:115], v[80:83]
    v_add_f32 v122, v122, v154
    v_add_f32 v123, v123, v155
    v_cvt_pk_bf16_f32 v104, v104, v105
    s_waitcnt lgkmcnt(4)
    v_mfma_f32_16x16x32_bf16 v[64:67], a[0:3], a[80:83], v[64:67]
    ds_read_b64_tr_b16 a[24:25], v14 offset:49152
    v_cvt_pk_bf16_f32 v105, v106, v107
    v_cvt_pk_bf16_f32 v106, v120, v121
    v_mfma_f32_16x16x32_bf16 v[68:71], a[0:3], a[84:87], v[68:71]
    ds_read_b64_tr_b16 a[26:27], v14 offset:53248
    v_cvt_pk_bf16_f32 v107, v122, v123
    buffer_store_dwordx4 v[104:107], v10, s[44:47], s78 offen sc1
    v_mfma_f32_16x16x32_bf16 v[72:75], a[0:3], a[88:91], v[72:75]
    v_add_f32 v108, v108, v140
    v_add_f32 v109, v109, v141
    v_add_f32 v110, v110, v142
    v_mfma_f32_16x16x32_bf16 v[76:79], a[0:3], a[92:95], v[76:79]
    v_add_f32 v111, v111, v143
    v_add_f32 v124, v124, v156
    v_add_f32 v125, v125, v157
    v_mfma_f32_16x16x32_bf16 v[92:95], a[4:7], a[92:95], v[92:95]
    ds_read_b64_tr_b16 a[28:29], v15 offset:49152
    v_add_f32 v126, v126, v158
    v_add_f32 v127, v127, v159
    v_mfma_f32_16x16x32_bf16 v[88:91], a[4:7], a[88:91], v[88:91]
    ds_read_b64_tr_b16 a[30:31], v15 offset:53248
    v_cvt_pk_bf16_f32 v108, v108, v109
    v_cvt_pk_bf16_f32 v109, v110, v111
    v_mfma_f32_16x16x32_bf16 v[84:87], a[4:7], a[84:87], v[84:87]
    v_cvt_pk_bf16_f32 v110, v124, v125
    v_cvt_pk_bf16_f32 v111, v126, v127
    buffer_store_dwordx4 v[108:111], v11, s[44:47], s78 offen sc1
    v_mfma_f32_16x16x32_bf16 v[80:83], a[4:7], a[80:83], v[80:83]
    v_mfma_f32_16x16x32_bf16 v[64:67], a[8:11], v[208:211], v[64:67]
    v_add_u32 v12, 0xfffe0000, v12
    ds_read_b64_tr_b16 a[0:1], v12 offset:0
    v_mfma_f32_16x16x32_bf16 v[68:71], a[8:11], v[212:215], v[68:71]
    ds_read_b64_tr_b16 a[2:3], v12 offset:4096
    v_mfma_f32_16x16x32_bf16 v[72:75], a[8:11], v[216:219], v[72:75]
    v_mfma_f32_16x16x32_bf16 v[76:79], a[8:11], v[220:223], v[76:79]
    v_mfma_f32_16x16x32_bf16 v[92:95], a[12:15], v[220:223], v[92:95]
    v_add_u32 v13, 0xfffe0000, v13
    ds_read_b64_tr_b16 a[4:5], v13 offset:0
    v_mfma_f32_16x16x32_bf16 v[88:91], a[12:15], v[216:219], v[88:91]
    ds_read_b64_tr_b16 a[6:7], v13 offset:4096
    v_mfma_f32_16x16x32_bf16 v[84:87], a[12:15], v[212:215], v[84:87]
    v_mfma_f32_16x16x32_bf16 v[80:83], a[12:15], v[208:211], v[80:83]
    s_waitcnt lgkmcnt(4)
    v_mfma_f32_16x16x32_bf16 v[64:67], a[16:19], a[128:131], v[64:67]
    ds_read_b64_tr_b16 a[8:9], v12 offset:16384
    v_mfma_f32_16x16x32_bf16 v[68:71], a[16:19], a[132:135], v[68:71]
    ds_read_b64_tr_b16 a[10:11], v12 offset:20480
    v_mfma_f32_16x16x32_bf16 v[72:75], a[16:19], a[136:139], v[72:75]
    v_mfma_f32_16x16x32_bf16 v[76:79], a[16:19], a[140:143], v[76:79]
    v_mfma_f32_16x16x32_bf16 v[92:95], a[20:23], a[140:143], v[92:95]
    ds_read_b64_tr_b16 a[12:13], v13 offset:16384
    v_mfma_f32_16x16x32_bf16 v[88:91], a[20:23], a[136:139], v[88:91]
    ds_read_b64_tr_b16 a[14:15], v13 offset:20480
    v_mfma_f32_16x16x32_bf16 v[84:87], a[20:23], a[132:135], v[84:87]
    v_mfma_f32_16x16x32_bf16 v[80:83], a[20:23], a[128:131], v[80:83]
    v_mfma_f32_16x16x32_bf16 v[64:67], a[24:27], a[32:35], v[64:67]
    ds_read_b64_tr_b16 a[16:17], v12 offset:32768
    v_mfma_f32_16x16x32_bf16 v[68:71], a[24:27], a[36:39], v[68:71]
    ds_read_b64_tr_b16 a[18:19], v12 offset:36864
    v_mfma_f32_16x16x32_bf16 v[72:75], a[24:27], a[40:43], v[72:75]
    v_mfma_f32_16x16x32_bf16 v[76:79], a[24:27], a[44:47], v[76:79]
    v_mfma_f32_16x16x32_bf16 v[92:95], a[28:31], a[44:47], v[92:95]
    ds_read_b64_tr_b16 a[20:21], v13 offset:32768
    v_mfma_f32_16x16x32_bf16 v[88:91], a[28:31], a[40:43], v[88:91]
    ds_read_b64_tr_b16 a[22:23], v13 offset:36864
    v_mfma_f32_16x16x32_bf16 v[84:87], a[28:31], a[36:39], v[84:87]
    v_mfma_f32_16x16x32_bf16 v[80:83], a[28:31], a[32:35], v[80:83]
    s_waitcnt lgkmcnt(4)
    v_mfma_f32_16x16x32_bf16 v[32:35], a[0:3], a[96:99], v[32:35]
    ds_read_b64_tr_b16 a[24:25], v12 offset:49152
    v_mfma_f32_16x16x32_bf16 v[36:39], a[0:3], a[100:103], v[36:39]
    ds_read_b64_tr_b16 a[26:27], v12 offset:53248
    v_mfma_f32_16x16x32_bf16 v[40:43], a[0:3], a[104:107], v[40:43]
    v_mfma_f32_16x16x32_bf16 v[44:47], a[0:3], a[108:111], v[44:47]
    s_waitcnt vmcnt(0)
    s_barrier
    s_cmp_lg_u32 s5, 1
    s_cbranch_scc1 L_sig6
    s_mov_b64 exec, 1
    buffer_store_dword v28, off, s[44:47], s81 sc1
    s_mov_b64 exec, -1
L_sig6:
    v_mov_b32 v29, 0
    v_mfma_f32_16x16x32_bf16 v[60:63], a[4:7], a[108:111], v[60:63]
    ds_read_b64_tr_b16 a[28:29], v13 offset:49152
    v_mfma_f32_16x16x32_bf16 v[56:59], a[4:7], a[104:107], v[56:59]
    ds_read_b64_tr_b16 a[30:31], v13 offset:53248
    v_mfma_f32_16x16x32_bf16 v[52:55], a[4:7], a[100:103], v[52:55]
    ds_write_b128 v3, v[64:67] offset:0
    v_mfma_f32_16x16x32_bf16 v[48:51], a[4:7], a[96:99], v[48:51]
    ds_write_b128 v3, v[68:71] offset:1024
    v_mfma_f32_16x16x32_bf16 v[32:35], a[8:11], a[64:67], v[32:35]
    v_add_u32 v12, 0x10000, v12
    ds_read_b64_tr_b16 a[0:1], v12 offset:0
    v_mfma_f32_16x16x32_bf16 v[36:39], a[8:11], a[68:71], v[36:39]
    ds_read_b64_tr_b16 a[2:3], v12 offset:4096
    v_mfma_f32_16x16x32_bf16 v[40:43], a[8:11], a[72:75], v[40:43]
    v_mfma_f32_16x16x32_bf16 v[44:47], a[8:11], a[76:79], v[44:47]
    ds_write_b128 v3, v[72:75] offset:2048
    v_mfma_f32_16x16x32_bf16 v[60:63], a[12:15], a[76:79], v[60:63]
    v_add_u32 v13, 0x10000, v13
    ds_read_b64_tr_b16 a[4:5], v13 offset:0
    v_mfma_f32_16x16x32_bf16 v[56:59], a[12:15], a[72:75], v[56:59]
    ds_read_b64_tr_b16 a[6:7], v13 offset:4096
    v_mfma_f32_16x16x32_bf16 v[52:55], a[12:15], a[68:71], v[52:55]
    ds_write_b128 v3, v[76:79] offset:3072
    v_mfma_f32_16x16x32_bf16 v[48:51], a[12:15], a[64:67], v[48:51]
    s_waitcnt lgkmcnt(8)
    v_mfma_f32_16x16x32_bf16 v[32:35], a[16:19], v[192:195], v[32:35]
    buffer_load_dword v30, v29, s[44:47], s80 offen sc1
    ds_read_b64_tr_b16 a[8:9], v12 offset:16384
    v_mfma_f32_16x16x32_bf16 v[36:39], a[16:19], v[196:199], v[36:39]
    ds_read_b64_tr_b16 a[10:11], v12 offset:20480
    v_mfma_f32_16x16x32_bf16 v[40:43], a[16:19], v[200:203], v[40:43]
    ds_write_b128 v3, v[80:83] offset:4096
    v_mfma_f32_16x16x32_bf16 v[44:47], a[16:19], v[204:207], v[44:47]
    ds_write_b128 v3, v[84:87] offset:5120
    v_mfma_f32_16x16x32_bf16 v[60:63], a[20:23], v[204:207], v[60:63]
    ds_read_b64_tr_b16 a[12:13], v13 offset:16384
    v_mfma_f32_16x16x32_bf16 v[56:59], a[20:23], v[200:203], v[56:59]
    ds_read_b64_tr_b16 a[14:15], v13 offset:20480
    v_mfma_f32_16x16x32_bf16 v[52:55], a[20:23], v[196:199], v[52:55]
    v_mfma_f32_16x16x32_bf16 v[48:51], a[20:23], v[192:195], v[48:51]
    ds_write_b128 v3, v[88:91] offset:6144
    v_mfma_f32_16x16x32_bf16 v[32:35], a[24:27], a[112:115], v[32:35]
    ds_read_b64_tr_b16 a[16:17], v12 offset:32768
    v_mfma_f32_16x16x32_bf16 v[36:39], a[24:27], a[116:119], v[36:39]
    ds_read_b64_tr_b16 a[18:19], v12 offset:36864
    v_mfma_f32_16x16x32_bf16 v[40:43], a[24:27], a[120:123], v[40:43]
    ds_write_b128 v3, v[92:95] offset:7168
    v_mfma_f32_16x16x32_bf16 v[44:47], a[24:27], a[124:127], v[44:47]
    v_mfma_f32_16x16x32_bf16 v[60:63], a[28:31], a[124:127], v[60:63]
    ds_read_b64_tr_b16 a[20:21], v13 offset:32768
    v_mfma_f32_16x16x32_bf16 v[56:59], a[28:31], a[120:123], v[56:59]
    ds_read_b64_tr_b16 a[22:23], v13 offset:36864
    v_mfma_f32_16x16x32_bf16 v[52:55], a[28:31], a[116:119], v[52:55]
    v_mfma_f32_16x16x32_bf16 v[48:51], a[28:31], a[112:115], v[48:51]
    s_waitcnt lgkmcnt(6)
    v_mfma_f32_16x16x32_bf16 v[32:35], a[0:3], a[80:83], v[32:35]
    ds_read_b64_tr_b16 a[24:25], v12 offset:49152
    v_mfma_f32_16x16x32_bf16 v[36:39], a[0:3], a[84:87], v[36:39]
    ds_read_b64_tr_b16 a[26:27], v12 offset:53248
    v_mfma_f32_16x16x32_bf16 v[40:43], a[0:3], a[88:91], v[40:43]
    s_waitcnt lgkmcnt(4)
    s_barrier
    v_mfma_f32_16x16x32_bf16 v[44:47], a[0:3], a[92:95], v[44:47]
    ds_read_b128 v[128:131], v4 offset:0
    v_lshlrev_b32 v64, 16, v224
    v_mfma_f32_16x16x32_bf16 v[60:63], a[4:7], a[92:95], v[60:63]
    ds_read_b64_tr_b16 a[28:29], v13 offset:49152
    v_and_b32 v65, 0xffff0000, v224
    v_mfma_f32_16x16x32_bf16 v[56:59], a[4:7], a[88:91], v[56:59]
    ds_read_b64_tr_b16 a[30:31], v13 offset:53248
    v_lshlrev_b32 v66, 16, v225
    v_mfma_f32_16x16x32_bf16 v[52:55], a[4:7], a[84:87], v[52:55]
    s_mov_b32 s101, 0
    s_waitcnt vmcnt(0)
L_poll6:
    v_cmp_ne_u32 vcc, s34, v30
    s_nop 4
    s_cbranch_vccz L_got6
    buffer_load_dword v30, v29, s[44:47], s80 offen sc1
    s_add_u32 s101, s101, 1
    s_cmp_lt_u32 s101, 0x8000
    s_waitcnt vmcnt(0)
    s_cbranch_scc1 L_poll6
L_got6:
    buffer_load_dwordx4 v[112:115], v8, s[44:47], s79 offen sc1
    buffer_load_dwordx4 v[116:119], v9, s[44:47], s79 offen sc1
    buffer_load_dwordx4 v[120:123], v10, s[44:47], s79 offen sc1
    buffer_load_dwordx4 v[124:127], v11, s[44:47], s79 offen sc1
    ds_read_b128 v[144:147], v4 offset:4096
    v_mfma_f32_16x16x32_bf16 v[48:51], a[4:7], a[80:83], v[48:51]
    ds_read_b128 v[132:135], v4 offset:1024
    v_and_b32 v67, 0xffff0000, v225
    v_mfma_f32_16x16x32_bf16 v[32:35], a[8:11], v[208:211], v[32:35]
    v_lshlrev_b32 v68, 16, v226
    v_and_b32 v69, 0xffff0000, v226
    v_mfma_f32_16x16x32_bf16 v[36:39], a[8:11], v[212:215], v[36:39]
    v_lshlrev_b32 v70, 16, v227
    v_and_b32 v71, 0xffff0000, v227
    v_mfma_f32_16x16x32_bf16 v[40:43], a[8:11], v[216:219], v[40:43]
    ds_read_b128 v[148:151], v4 offset:5120
    v_lshlrev_b32 v72, 16, v228
    v_mfma_f32_16x16x32_bf16 v[44:47], a[8:11], v[220:223], v[44:47]
    ds_read_b128 v[136:139], v4 offset:2048
    v_and_b32 v73, 0xffff0000, v228
    v_mfma_f32_16x16x32_bf16 v[60:63], a[12:15], v[220:223], v[60:63]
    v_lshlrev_b32 v74, 16, v229
    v_and_b32 v75, 0xffff0000, v229
    v_mfma_f32_16x16x32_bf16 v[56:59], a[12:15], v[216:219], v[56:59]
    v_lshlrev_b32 v76, 16, v230
    v_and_b32 v77, 0xffff0000, v230
    v_mfma_f32_16x16x32_bf16 v[52:55], a[12:15], v[212:215], v[52:55]
    ds_read_b128 v[152:155], v4 offset:6144
    v_lshlrev_b32 v78, 16, v231
    v_mfma_f32_16x16x32_bf16 v[48:51], a[12:15], v[208:211], v[48:51]
    ds_read_b128 v[140:143], v4 offset:3072
    v_and_b32 v79, 0xffff0000, v231
    s_waitcnt lgkmcnt(6)
    v_mfma_f32_16x16x32_bf16 v[32:35], a[16:19], a[128:131], v[32:35]
    v_lshlrev_b32 v80, 16, v232
    v_and_b32 v81, 0xffff0000, v232
    v_mfma_f32_16x16x32_bf16 v[36:39], a[16:19], a[132:135], v[36:39]
    v_lshlrev_b32 v82, 16, v233
    v_and_b32 v83, 0xffff0000, v233
    v_mfma_f32_16x16x32_bf16 v[40:43], a[16:19], a[136:139], v[40:43]
    ds_read_b128 v[156:159], v4 offset:7168
    v_lshlrev_b32 v84, 16, v234
    v_mfma_f32_16x16x32_bf16 v[44:47], a[16:19], a[140:143], v[44:47]
    v_and_b32 v85, 0xffff0000, v234
    v_lshlrev_b32 v86, 16, v235
    v_mfma_f32_16x16x32_bf16 v[60:63], a[20:23], a[140:143], v[60:63]
    v_and_b32 v87, 0xffff0000, v235
    v_lshlrev_b32 v88, 16, v236
    v_mfma_f32_16x16x32_bf16 v[56:59], a[20:23], a[136:139], v[56:59]
    v_and_b32 v89, 0xffff0000, v236
    v_lshlrev_b32 v90, 16, v237
    v_mfma_f32_16x16x32_bf16 v[52:55], a[20:23], a[132:135], v[52:55]
    v_and_b32 v91, 0xffff0000, v237
    v_lshlrev_b32 v92, 16, v238
    v_mfma_f32_16x16x32_bf16 v[48:51], a[20:23], a[128:131], v[48:51]
    v_and_b32 v93, 0xffff0000, v238
    v_lshlrev_b32 v94, 16, v239
    v_mfma_f32_16x16x32_bf16 v[32:35], a[24:27], a[32:35], v[32:35]
    v_and_b32 v95, 0xffff0000, v239
    v_mfma_f32_16x16x32_bf16 v[36:39], a[24:27], a[36:39], v[36:39]
    v_mfma_f32_16x16x32_bf16 v[40:43], a[24:27], a[40:43], v[40:43]
    v_mfma_f32_16x16x32_bf16 v[44:47], a[24:27], a[44:47], v[44:47]
    v_mfma_f32_16x16x32_bf16 v[60:63], a[28:31], a[44:47], v[60:63]
    v_mfma_f32_16x16x32_bf16 v[56:59], a[28:31], a[40:43], v[56:59]
    v_mfma_f32_16x16x32_bf16 v[52:55], a[28:31], a[36:39], v[52:55]
    v_mfma_f32_16x16x32_bf16 v[48:51], a[28:31], a[32:35], v[48:51]
    s_waitcnt lgkmcnt(0)
    v_pk_add_f32 v[32:33], v[32:33], v[128:129]
    v_pk_add_f32 v[34:35], v[34:35], v[130:131]
    v_pk_add_f32 v[36:37], v[36:37], v[132:133]
    v_pk_add_f32 v[38:39], v[38:39], v[134:135]
    v_pk_add_f32 v[40:41], v[40:41], v[136:137]
    v_pk_add_f32 v[42:43], v[42:43], v[138:139]
    v_pk_add_f32 v[44:45], v[44:45], v[140:141]
    v_pk_add_f32 v[46:47], v[46:47], v[142:143]
    v_pk_add_f32 v[48:49], v[48:49], v[144:145]
    v_pk_add_f32 v[50:51], v[50:51], v[146:147]
    v_pk_add_f32 v[52:53], v[52:53], v[148:149]
    v_pk_add_f32 v[54:55], v[54:55], v[150:151]
    v_pk_add_f32 v[56:57], v[56:57], v[152:153]
    v_pk_add_f32 v[58:59], v[58:59], v[154:155]
    v_pk_add_f32 v[60:61], v[60:61], v[156:157]
    v_pk_add_f32 v[62:63], v[62:63], v[158:159]
    s_waitcnt vmcnt(3)
    v_lshlrev_b32 v96, 16, v112
    v_and_b32 v97, 0xffff0000, v112
    v_lshlrev_b32 v98, 16, v113
    v_and_b32 v99, 0xffff0000, v113
    v_lshlrev_b32 v100, 16, v114
    v_and_b32 v101, 0xffff0000, v114
    v_lshlrev_b32 v102, 16, v115
    v_and_b32 v103, 0xffff0000, v115
    v_pk_add_f32 v[32:33], v[32:33], v[96:97]
    v_pk_add_f32 v[34:35], v[34:35], v[98:99]
    v_pk_add_f32 v[48:49], v[48:49], v[100:101]
    v_pk_add_f32 v[50:51], v[50:51], v[102:103]
    s_nop 0
    v_permlane16_swap_b32 v32, v48
    v_permlane16_swap_b32 v33, v49
    v_permlane16_swap_b32 v34, v50
    v_permlane16_swap_b32 v35, v51
    v_pk_add_f32 v[32:33], v[32:33], v[64:65]
    v_pk_add_f32 v[34:35], v[34:35], v[66:67]
    v_pk_add_f32 v[48:49], v[48:49], v[68:69]
    v_pk_add_f32 v[50:51], v[50:51], v[70:71]
    v_cvt_pk_bf16_f32 v32, v32, v33
    v_cvt_pk_bf16_f32 v33, v34, v35
    v_cvt_pk_bf16_f32 v34, v48, v49
    v_cvt_pk_bf16_f32 v35, v50, v51
    buffer_store_dwordx4 v[32:35], v6, s[60:63], 0 offen
    s_waitcnt vmcnt(3)
    v_lshlrev_b32 v96, 16, v116
    v_and_b32 v97, 0xffff0000, v116
    v_lshlrev_b32 v98, 16, v117
    v_and_b32 v99, 0xffff0000, v117
    v_lshlrev_b32 v100, 16, v118
    v_and_b32 v101, 0xffff0000, v118
    v_lshlrev_b32 v102, 16, v119
    v_and_b32 v103, 0xffff0000, v119
    v_pk_add_f32 v[36:37], v[36:37], v[96:97]
    v_pk_add_f32 v[38:39], v[38:39], v[98:99]
    v_pk_add_f32 v[52:53], v[52:53], v[100:101]
    v_pk_add_f32 v[54:55], v[54:55], v[102:103]
    s_nop 0
    v_permlane16_swap_b32 v36, v52
    v_permlane16_swap_b32 v37, v53
    v_permlane16_swap_b32 v38, v54
    v_permlane16_swap_b32 v39, v55
    v_pk_add_f32 v[36:37], v[36:37], v[72:73]
    v_pk_add_f32 v[38:39], v[38:39], v[74:75]
    v_pk_add_f32 v[52:53], v[52:53], v[76:77]
    v_pk_add_f32 v[54:55], v[54:55], v[78:79]
    v_cvt_pk_bf16_f32 v36, v36, v37
    v_cvt_pk_bf16_f32 v37, v38, v39
    v_cvt_pk_bf16_f32 v38, v52, v53
    v_cvt_pk_bf16_f32 v39, v54, v55
    buffer_store_dwordx4 v[36:39], v6, s[60:63], s74 offen
    s_waitcnt vmcnt(3)
    v_lshlrev_b32 v96, 16, v120
    v_and_b32 v97, 0xffff0000, v120
    v_lshlrev_b32 v98, 16, v121
    v_and_b32 v99, 0xffff0000, v121
    v_lshlrev_b32 v100, 16, v122
    v_and_b32 v101, 0xffff0000, v122
    v_lshlrev_b32 v102, 16, v123
    v_and_b32 v103, 0xffff0000, v123
    v_pk_add_f32 v[40:41], v[40:41], v[96:97]
    v_pk_add_f32 v[42:43], v[42:43], v[98:99]
    v_pk_add_f32 v[56:57], v[56:57], v[100:101]
    v_pk_add_f32 v[58:59], v[58:59], v[102:103]
    s_nop 0
    v_permlane16_swap_b32 v40, v56
    v_permlane16_swap_b32 v41, v57
    v_permlane16_swap_b32 v42, v58
    v_permlane16_swap_b32 v43, v59
    v_pk_add_f32 v[40:41], v[40:41], v[80:81]
    v_pk_add_f32 v[42:43], v[42:43], v[82:83]
    v_pk_add_f32 v[56:57], v[56:57], v[84:85]
    v_pk_add_f32 v[58:59], v[58:59], v[86:87]
    v_cvt_pk_bf16_f32 v40, v40, v41
    v_cvt_pk_bf16_f32 v41, v42, v43
    v_cvt_pk_bf16_f32 v42, v56, v57
    v_cvt_pk_bf16_f32 v43, v58, v59
    buffer_store_dwordx4 v[40:43], v6, s[60:63], s75 offen
    s_waitcnt vmcnt(3)
    v_lshlrev_b32 v96, 16, v124
    v_and_b32 v97, 0xffff0000, v124
    v_lshlrev_b32 v98, 16, v125
    v_and_b32 v99, 0xffff0000, v125
    v_lshlrev_b32 v100, 16, v126
    v_and_b32 v101, 0xffff0000, v126
    v_lshlrev_b32 v102, 16, v127
    v_and_b32 v103, 0xffff0000, v127
    v_pk_add_f32 v[44:45], v[44:45], v[96:97]
    v_pk_add_f32 v[46:47], v[46:47], v[98:99]
    v_pk_add_f32 v[60:61], v[60:61], v[100:101]
    v_pk_add_f32 v[62:63], v[62:63], v[102:103]
    s_nop 0
    v_permlane16_swap_b32 v44, v60
    v_permlane16_swap_b32 v45, v61
    v_permlane16_swap_b32 v46, v62
    v_permlane16_swap_b32 v47, v63
    v_pk_add_f32 v[44:45], v[44:45], v[88:89]
    v_pk_add_f32 v[46:47], v[46:47], v[90:91]
    v_pk_add_f32 v[60:61], v[60:61], v[92:93]
    v_pk_add_f32 v[62:63], v[62:63], v[94:95]
    v_cvt_pk_bf16_f32 v44, v44, v45
    v_cvt_pk_bf16_f32 v45, v46, v47
    v_cvt_pk_bf16_f32 v46, v60, v61
    v_cvt_pk_bf16_f32 v47, v62, v63
    buffer_store_dwordx4 v[44:47], v6, s[60:63], s76 offen
L_end:
    s_endpgm
L_code_end:
.section .rodata,"a"
.p2align 6
.amdhsa_kernel sequential_preLN__ssm_conv_h3__glu_gated_geglu__prompt_kernel
  .amdhsa_next_free_vgpr 512
  .amdhsa_next_free_sgpr 102
  .amdhsa_accum_offset 256
  .amdhsa_group_segment_fixed_size 0
  .amdhsa_kernarg_size 104
  .amdhsa_user_sgpr_count 2
  .amdhsa_user_sgpr_kernarg_segment_ptr 1
  .amdhsa_system_sgpr_workgroup_id_x 1
.end_amdhsa_kernel
```
